```python
import torch

def _softmax(x, axis=-1):
    return torch.softmax(x, dim=axis)
def _gelu(x):
    return torch.nn.functional.gelu(x, approximate="tanh")
def _silu(x):
    return torch.nn.functional.silu(x)
def _sigmoid(x):
    return torch.sigmoid(x)
def _layernorm(x, axis=-1, eps=1e-5):
    m = x.mean(dim=axis, keepdim=True)
    v = x.var(dim=axis, keepdim=True, unbiased=False)
    return (x - m) / torch.sqrt(v + eps)
def _scatter_add(tgt, idx, src, axis=0):
    return tgt.clone().index_add_(axis, idx, src)
def _segment_sum(src, seg, n):
    out = torch.zeros((n,) + src.shape[1:], dtype=src.dtype)
    return out.index_add_(0, seg, src)
def _pad(x, pw):
    flat = tuple(v for pair in reversed(pw) for v in pair)
    return torch.nn.functional.pad(x, flat)

kernel_name = 'sequential_preLN__ssm_conv_s4__mixer_s_mlp__prompt'

def setup_inputs():

    _w = (lambda a: (lambda t: t.to(torch.bfloat16) if t.is_floating_point() else t)(torch.as_tensor(a)))
    def _A_setup():
        B, L, D, N = 1, 2048, 640, 192
        A_re = -(lambda _x: torch.exp(torch.as_tensor(_x)))((lambda *s: torch.randn(*s, dtype=torch.bfloat16) * 6.4)(D, N))
        A_im = torch.pi * (lambda *s: torch.randn(*s, dtype=torch.bfloat16) * 0.05)(D, N)
        B_re = (lambda *s: torch.randn(*s, dtype=torch.bfloat16) * 0.05)(D, N)
        B_im = (lambda *s: torch.randn(*s, dtype=torch.bfloat16) * 0.05)(D, N)
        C_re = (lambda *s: torch.randn(*s, dtype=torch.bfloat16) * 0.05)(D, N)
        C_im = (lambda *s: torch.randn(*s, dtype=torch.bfloat16) * 0.05)(D, N)
        log_dt = (lambda *s: torch.randn(*s, dtype=torch.bfloat16) * 0.05)(D) * 0.5 - 4.0
        Dskip = (lambda *s: torch.randn(*s, dtype=torch.bfloat16) * 0.05)(D)
        return {
            "u": _w((lambda *s: torch.randn(*s, dtype=torch.bfloat16) * 0.05)(B, L, D)),
            "A_re": _w(A_re),
            "A_im": _w(A_im),
            "B_re": _w(B_re),
            "B_im": _w(B_im),
            "C_re": _w(C_re),
            "C_im": _w(C_im),
            "log_dt": _w(log_dt),
            "Dskip": _w(Dskip),
        }
    _A_in = _A_setup()

    def _B_setup():
        B, S, D, F = 1, 2048, 640, 1536
        return {
            "x":  _w((lambda *s: torch.randn(*s, dtype=torch.bfloat16) * 0.05)(B, S, D)),
            "w1": _w((lambda *s: torch.randn(*s, dtype=torch.bfloat16) * 6.4)(D, D) * (D ** -0.5)),
            "w2": _w((lambda *s: torch.randn(*s, dtype=torch.bfloat16) * 6.4)(D, D) * (D ** -0.5)),
            "w3": _w((lambda *s: torch.randn(*s, dtype=torch.bfloat16) * 6.4)(D, F) * (D ** -0.5)),
            "w4": _w((lambda *s: torch.randn(*s, dtype=torch.bfloat16) * 6.4)(F, D) * (F ** -0.5)),
        }
    _B_in = _B_setup()

    return {
        "A_u": _A_in["u"],
        "A_A_re": _A_in["A_re"],
        "A_A_im": _A_in["A_im"],
        "A_B_re": _A_in["B_re"],
        "A_B_im": _A_in["B_im"],
        "A_C_re": _A_in["C_re"],
        "A_C_im": _A_in["C_im"],
        "A_log_dt": _A_in["log_dt"],
        "A_Dskip": _A_in["Dskip"],
        "B_x": _B_in["x"],
        "B_w1": _B_in["w1"],
        "B_w2": _B_in["w2"],
        "B_w3": _B_in["w3"],
        "B_w4": _B_in["w4"],
    }

def reference(A_u, A_A_re, A_A_im, A_B_re, A_B_im, A_C_re, A_C_im, A_log_dt, A_Dskip, B_x, B_w1, B_w2, B_w3, B_w4):
    def _A_ref(u, A_re, A_im, B_re, B_im, C_re, C_im, log_dt, Dskip):
        Bsz, L, D = u.shape
        dt = torch.exp(log_dt)[:, None]
        A = A_re + 1j * A_im
        Bc = B_re + 1j * B_im
        Cc = C_re + 1j * C_im
        logdA = dt * A
        dB = dt * Bc
        l = (lambda x, dt: x.to(dt))(torch.arange(L), A_re.dtype)
        P = torch.exp(logdA[:, :, None] * l[None, None, :])
        K = torch.einsum("dn,dnl,dn->dl", Cc, P, dB).real
        L2 = 2 * L
        Kp = _pad(K, ((0, 0), (0, L)))
        up = (lambda x, *d: x.permute(*d))(u, 0, 2, 1)
        up = _pad(up, ((0, 0), (0, 0), (0, L)))
        Kf = (lambda x, axes=(-2,-1): torch.fft.rfft2(x.float(), dim=axes))(Kp[:, None, :], axes=(-2, -1))
        Uf = (lambda x, axes=(-2,-1): torch.fft.rfft2(x.float(), dim=axes))(up[:, :, None, :], axes=(-2, -1))
        Yf = Uf * Kf[None, :, :, :]
        y = (lambda x, s, axes=(-2,-1): torch.fft.irfft2(x, s=s, dim=axes).to(torch.bfloat16))(Yf, (1, L2), axes=(-2, -1))[:, :, 0, :L]
        y = (lambda x, *d: x.permute(*d))(y, 0, 2, 1) + u * Dskip[None, None, :]
        return y

    def _B_ref(x, w1, w2, w3, w4):
        B, S, D = x.shape
        h = _gelu(_layernorm(x, axis=-1) @ w1)
        c = D // 4
        g0 = _pad(h[:, :, 0*c:1*c], ((0, 0), (1, 0), (0, 0)))[:, :S, :]
        g1 = _pad(h[:, :, 1*c:2*c], ((0, 0), (0, 1), (0, 0)))[:, 1:, :]
        g2 = _pad(h[:, :, 2*c:3*c], ((0, 0), (2, 0), (0, 0)))[:, :S, :]
        g3 = _pad(h[:, :, 3*c:   ], ((0, 0), (0, 2), (0, 0)))[:, 2:, :]
        hs = torch.concatenate([g0, g1, g2, g3], axis=-1) @ w2
        x1 = x + hs
        h2 = _gelu(_layernorm(x1, axis=-1) @ w3) @ w4
        return x1 + h2

    x = A_u
    h = x + _A_ref(_layernorm(x, axis=-1), A_A_re, A_A_im, A_B_re, A_B_im, A_C_re, A_C_im, A_log_dt, A_Dskip)
    h2 = h + _B_ref(_layernorm(h, axis=-1), B_w1, B_w2, B_w3, B_w4)
    return h2
```

```asm
; @launch grid=(256,1,1) block=(512,1,1) lds=161856
.amdgcn_target "amdgcn-amd-amdhsa--gfx950"
.text
.globl sequential_preLN__ssm_conv_s4__mixer_s_mlp__prompt_kernel
.p2align 8
.type sequential_preLN__ssm_conv_s4__mixer_s_mlp__prompt_kernel,@function
sequential_preLN__ssm_conv_s4__mixer_s_mlp__prompt_kernel:
  s_cmp_ge_u32 s2, 256
  s_cbranch_scc1 GG_done
  s_load_dwordx16 s[16:31], s[0:1], 0
  s_load_dwordx4 s[32:35], s[0:1], 120
  s_load_dwordx8 s[48:55], s[0:1], 80
  s_load_dwordx2 s[56:57], s[0:1], 64
  v_lshrrev_b32 v1, 6, v0
  v_and_b32 v2, 63, v0
  v_readfirstlane_b32 s3, v1
  v_lshlrev_b32 v3, 4, v2
  s_mov_b32 s40, 0xffff0000
  s_and_b32 s79, s2, 63
  s_lshl_b32 s79, s79, 7
  s_add_u32 s79, s79, 33161216
  v_mov_b32 v254, s79
  s_cmp_ge_u32 s2, 160
  s_cbranch_scc1 F_aux
  s_and_b32 s4, s2, 7
  s_mul_i32 s4, s4, 20
  s_lshr_b32 s5, s2, 3
  s_add_u32 s4, s4, s5
  s_lshl_b32 s4, s4, 2
  s_and_b32 s58, s3, 3
  s_lshr_b32 s59, s3, 2
  s_add_u32 s5, s4, s58
  s_mul_i32 s6, s58, 21248
  s_mul_i32 s11, s3, 8704
  s_add_u32 s11, s11, 84992
  s_and_b32 s60, s2, 7
  s_mul_i32 s61, s60, 1572864
  s_mul_i32 s10, s58, 1808
  s_add_u32 s65, s10, 154624
  v_mov_b32 v134, s65
  v_mov_b32 v96, 0
  v_mov_b32 v97, 0
  ds_write_b64 v134, v[96:97] offset:1792
  s_getpc_b64 s[8:9]
F_pc:
  s_add_u32 s8, s8, F_tab-F_pc
  s_addc_u32 s9, s9, 0
  s_cmp_lg_u32 s59, 0
  s_cbranch_scc1 F_nt
  global_load_dwordx4 v[176:179], v3, s[8:9] offset:0
  global_load_dwordx2 v[180:181], v3, s[8:9] offset:16
  global_load_dwordx4 v[182:185], v3, s[8:9] offset:1024
  global_load_dwordx2 v[186:187], v3, s[8:9] offset:1040
  global_load_dwordx4 v[188:191], v3, s[8:9] offset:2048
  global_load_dwordx2 v[192:193], v3, s[8:9] offset:2064
  global_load_dwordx4 v[194:197], v3, s[8:9] offset:3072
  global_load_dwordx2 v[198:199], v3, s[8:9] offset:3088
F_nt:
  s_mul_i32 s7, s5, 384
  s_lshl_b32 s10, s59, 8
  s_add_u32 s7, s7, s10
  v_lshl_add_u32 v5, v2, 1, s7
  v_add_u32 v6, s11, v3
  v_bfe_u32 v7, v2, 4, 1
  v_lshlrev_b32 v7, 1, v7
  v_bfe_u32 v8, v2, 1, 1
  v_add_u32 v7, v7, v8
  v_mul_u32_u24 v7, 1088, v7
  v_lshrrev_b32 v8, 5, v2
  v_lshl_add_u32 v7, v8, 7, v7
  v_bfe_u32 v9, v2, 2, 2
  v_lshl_add_u32 v7, v9, 4, v7
  v_and_b32 v9, 1, v2
  v_lshl_add_u32 v7, v9, 3, v7
  v_add_u32 v7, s11, v7
  v_and_b32 v130, 31, v2
  v_mul_u32_u24 v130, 56, v130
  v_lshl_add_u32 v130, v8, 3, v130
  v_add_u32 v130, s65, v130
  s_add_u32 s10, s58, 4
  s_mul_i32 s10, s10, 8704
  s_add_u32 s10, s10, 84992
  v_add_u32 v131, s10, v3
  s_lshr_b32 s12, s5, 1
  s_lshl_b32 s12, s12, 2
  s_and_b32 s13, s5, 1
  s_lshl_b32 s13, s13, 4
  v_and_b32 v4, 255, v0
  v_lshlrev_b32 v4, 4, v4
  s_lshl_b32 s10, s4, 1
  v_mul_u32_u24 v133, 160, v4
  v_add_u32 v133, s10, v133
  s_waitcnt lgkmcnt(0)
  s_mov_b64 s[36:37], s[34:35]
  s_mov_b64 s[34:35], s[32:33]
  s_mov_b64 s[32:33], s[36:37]
  s_mov_b32 s38, 33554432
  s_mov_b32 s39, 0x00020000
  s_barrier
  global_load_ushort v112, v5, s[18:19]
  global_load_ushort v113, v5, s[20:21]
  global_load_ushort v114, v5, s[22:23]
  global_load_ushort v115, v5, s[24:25]
  global_load_ushort v116, v5, s[26:27]
  global_load_ushort v117, v5, s[28:29]
  s_load_dword s14, s[30:31], s12
  s_load_dwordx2 s[62:63], s[56:57], s10
  s_cmp_lg_u32 s59, 0
  s_cbranch_scc1 F_hg
  global_load_ushort v118, v5, s[18:19] offset:128
  global_load_ushort v119, v5, s[20:21] offset:128
  global_load_ushort v120, v5, s[22:23] offset:128
  global_load_ushort v121, v5, s[24:25] offset:128
  global_load_ushort v122, v5, s[26:27] offset:128
  global_load_ushort v123, v5, s[28:29] offset:128
  s_mov_b64 exec, 1
  buffer_load_dword v255, v254, s[36:39], 0 offen sc1
  s_mov_b64 exec, -1
  s_waitcnt vmcnt(13)
  v_and_b32 v200, 0xffff, v176
  v_add_u32 v200, s65, v200
  v_lshrrev_b32 v201, 16, v176
  v_add_u32 v201, s65, v201
  v_and_b32 v202, 0xffff, v177
  v_add_u32 v202, s65, v202
  v_lshrrev_b32 v203, 16, v177
  v_add_u32 v203, s65, v203
  v_and_b32 v204, 0xffff, v178
  v_add_u32 v204, s65, v204
  v_lshrrev_b32 v205, 16, v178
  v_add_u32 v205, s65, v205
  v_and_b32 v206, 0xffff, v179
  v_add_u32 v206, s65, v206
  v_lshrrev_b32 v207, 16, v179
  v_add_u32 v207, s65, v207
  v_and_b32 v208, 0xffff, v180
  v_add_u32 v208, s65, v208
  v_lshrrev_b32 v209, 16, v180
  v_add_u32 v209, s65, v209
  v_and_b32 v210, 0xffff, v181
  v_add_u32 v210, s65, v210
  v_and_b32 v211, 0xffff, v182
  v_add_u32 v211, s65, v211
  v_lshrrev_b32 v212, 16, v182
  v_add_u32 v212, s65, v212
  v_and_b32 v213, 0xffff, v183
  v_add_u32 v213, s65, v213
  v_lshrrev_b32 v214, 16, v183
  v_add_u32 v214, s65, v214
  v_and_b32 v215, 0xffff, v184
  v_add_u32 v215, s65, v215
  v_lshrrev_b32 v216, 16, v184
  v_add_u32 v216, s65, v216
  v_and_b32 v217, 0xffff, v185
  v_add_u32 v217, s65, v217
  v_lshrrev_b32 v218, 16, v185
  v_add_u32 v218, s65, v218
  v_and_b32 v219, 0xffff, v186
  v_add_u32 v219, s65, v219
  v_lshrrev_b32 v220, 16, v186
  v_add_u32 v220, s65, v220
  v_and_b32 v221, 0xffff, v187
  v_add_u32 v221, s65, v221
  v_and_b32 v222, 0xffff, v188
  v_add_u32 v222, s65, v222
  v_lshrrev_b32 v223, 16, v188
  v_add_u32 v223, s65, v223
  v_and_b32 v224, 0xffff, v189
  v_add_u32 v224, s65, v224
  v_lshrrev_b32 v225, 16, v189
  v_add_u32 v225, s65, v225
  v_and_b32 v226, 0xffff, v190
  v_add_u32 v226, s65, v226
  v_lshrrev_b32 v227, 16, v190
  v_add_u32 v227, s65, v227
  v_and_b32 v228, 0xffff, v191
  v_add_u32 v228, s65, v228
  v_lshrrev_b32 v229, 16, v191
  v_add_u32 v229, s65, v229
  v_and_b32 v230, 0xffff, v192
  v_add_u32 v230, s65, v230
  v_lshrrev_b32 v231, 16, v192
  v_add_u32 v231, s65, v231
  v_and_b32 v232, 0xffff, v193
  v_add_u32 v232, s65, v232
  v_and_b32 v233, 0xffff, v194
  v_add_u32 v233, s65, v233
  v_lshrrev_b32 v234, 16, v194
  v_add_u32 v234, s65, v234
  v_and_b32 v235, 0xffff, v195
  v_add_u32 v235, s65, v235
  v_lshrrev_b32 v236, 16, v195
  v_add_u32 v236, s65, v236
  v_and_b32 v237, 0xffff, v196
  v_add_u32 v237, s65, v237
  v_lshrrev_b32 v238, 16, v196
  v_add_u32 v238, s65, v238
  v_and_b32 v239, 0xffff, v197
  v_add_u32 v239, s65, v239
  v_lshrrev_b32 v240, 16, v197
  v_add_u32 v240, s65, v240
  v_and_b32 v241, 0xffff, v198
  v_add_u32 v241, s65, v241
  v_lshrrev_b32 v242, 16, v198
  v_add_u32 v242, s65, v242
  v_and_b32 v243, 0xffff, v199
  v_add_u32 v243, s65, v243
  s_waitcnt vmcnt(0)
  s_branch F_hj
F_hg:
  v_add_u32 v208, 655360, v133
  v_add_u32 v209, 1310720, v133
  v_add_u32 v210, 1966080, v133
  global_load_dwordx2 v[176:177], v133, s[16:17] offset:0
  global_load_dwordx2 v[178:179], v133, s[16:17] offset:1280
  global_load_dwordx2 v[180:181], v208, s[16:17] offset:0
  s_waitcnt vmcnt(3)
F_hj:
  v_mov_b32 v96, 0
  v_mov_b32 v97, 0
  v_mov_b32 v98, 0
  v_mov_b32 v99, 0
  v_mov_b32 v100, 0
  v_mov_b32 v101, 0
  v_mov_b32 v102, 0
  v_mov_b32 v103, 0
  v_mov_b32 v104, 0
  v_mov_b32 v105, 0
  v_mov_b32 v106, 0
  v_mov_b32 v107, 0
  v_mov_b32 v108, 0
  v_mov_b32 v109, 0
  v_mov_b32 v110, 0
  v_mov_b32 v111, 0
  s_waitcnt lgkmcnt(0)
  s_lshr_b32 s14, s14, s13
  s_lshl_b32 s14, s14, 16
  v_mov_b32 v9, 0x3fb8aa3b
  v_mul_f32 v9, s14, v9
  v_exp_f32 v9, v9
  s_nop 0
  v_cvt_pk_bf16_f32 v9, v9, v9
  v_lshlrev_b32 v132, 16, v9
  s_mov_b32 s15, s59
F_unit:
  v_lshlrev_b32 v10, 16, v112
  v_lshlrev_b32 v11, 16, v113
  v_lshlrev_b32 v12, 16, v114
  v_lshlrev_b32 v13, 16, v115
  v_lshlrev_b32 v14, 16, v116
  v_lshlrev_b32 v15, 16, v117
  v_mov_b32 v112, v118
  v_mov_b32 v113, v119
  v_mov_b32 v114, v120
  v_mov_b32 v115, v121
  v_mov_b32 v116, v122
  v_mov_b32 v117, v123
F_unit2:
  v_mul_f32 v10, v132, v10
  v_mul_f32 v11, v132, v11
  v_mul_f32 v12, v132, v12
  v_mul_f32 v13, v132, v13
  v_mul_f32 v10, 0x3fb8aa3b, v10
  v_mul_f32 v11, 0.15915494, v11
  v_exp_f32 v22, v10
  v_fract_f32 v23, v11
  v_cos_f32 v16, v23
  v_sin_f32 v17, v23
  v_mul_f32 v16, v22, v16
  v_mul_f32 v17, v22, v17
  v_mul_f32 v22, 0x41000000, v10
  v_mul_f32 v23, 0x41000000, v11
  v_exp_f32 v22, v22
  v_fract_f32 v23, v23
  v_cos_f32 v18, v23
  v_sin_f32 v19, v23
  v_mul_f32 v18, v22, v18
  v_mul_f32 v19, v22, v19
  v_mul_f32 v22, 0x43800000, v10
  v_mul_f32 v23, 0x43800000, v11
  v_exp_f32 v22, v22
  v_fract_f32 v23, v23
  v_cos_f32 v20, v23
  v_sin_f32 v21, v23
  v_mul_f32 v20, v22, v20
  v_mul_f32 v21, v22, v21
  s_cmp_eq_u32 s59, 0
  s_cbranch_scc1 F_gp1
  global_load_dwordx2 v[182:183], v208, s[16:17] offset:1280
F_gp1:
  v_pk_mul_f32 v[24:25], v[14:15], v[12:13] op_sel:[0,0] op_sel_hi:[1,0]
  v_pk_fma_f32 v[24:25], v[14:15], v[12:13], v[24:25] op_sel:[1,1,0] op_sel_hi:[0,1,1] neg_lo:[1,0,0]
  v_pk_mul_f32 v[26:27], v[24:25], v[16:17] op_sel:[0,0] op_sel_hi:[1,0]
  v_pk_fma_f32 v[26:27], v[24:25], v[16:17], v[26:27] op_sel:[1,1,0] op_sel_hi:[0,1,1] neg_lo:[1,0,0]
  v_cvt_pk_bf16_f32 v88, v24, v26
  v_cvt_pk_bf16_f32 v92, -v25, -v27
  v_pk_mul_f32 v[28:29], v[26:27], v[16:17] op_sel:[0,0] op_sel_hi:[1,0]
  v_pk_fma_f32 v[28:29], v[26:27], v[16:17], v[28:29] op_sel:[1,1,0] op_sel_hi:[0,1,1] neg_lo:[1,0,0]
  v_pk_mul_f32 v[30:31], v[28:29], v[16:17] op_sel:[0,0] op_sel_hi:[1,0]
  v_pk_fma_f32 v[30:31], v[28:29], v[16:17], v[30:31] op_sel:[1,1,0] op_sel_hi:[0,1,1] neg_lo:[1,0,0]
  v_cvt_pk_bf16_f32 v89, v28, v30
  v_cvt_pk_bf16_f32 v93, -v29, -v31
  v_pk_mul_f32 v[32:33], v[30:31], v[16:17] op_sel:[0,0] op_sel_hi:[1,0]
  v_pk_fma_f32 v[32:33], v[30:31], v[16:17], v[32:33] op_sel:[1,1,0] op_sel_hi:[0,1,1] neg_lo:[1,0,0]
  v_pk_mul_f32 v[34:35], v[32:33], v[16:17] op_sel:[0,0] op_sel_hi:[1,0]
  v_pk_fma_f32 v[34:35], v[32:33], v[16:17], v[34:35] op_sel:[1,1,0] op_sel_hi:[0,1,1] neg_lo:[1,0,0]
  v_cvt_pk_bf16_f32 v90, v32, v34
  v_cvt_pk_bf16_f32 v94, -v33, -v35
  v_pk_mul_f32 v[36:37], v[34:35], v[16:17] op_sel:[0,0] op_sel_hi:[1,0]
  v_pk_fma_f32 v[36:37], v[34:35], v[16:17], v[36:37] op_sel:[1,1,0] op_sel_hi:[0,1,1] neg_lo:[1,0,0]
  v_pk_mul_f32 v[38:39], v[36:37], v[16:17] op_sel:[0,0] op_sel_hi:[1,0]
  v_pk_fma_f32 v[38:39], v[36:37], v[16:17], v[38:39] op_sel:[1,1,0] op_sel_hi:[0,1,1] neg_lo:[1,0,0]
  v_cvt_pk_bf16_f32 v91, v36, v38
  v_cvt_pk_bf16_f32 v95, -v37, -v39
  ds_write_b128 v6, v[88:91] offset:0
  ds_write_b128 v6, v[92:95] offset:4352
  v_pk_mul_f32 v[40:41], v[24:25], v[20:21] op_sel:[0,0] op_sel_hi:[1,0]
  v_pk_fma_f32 v[40:41], v[24:25], v[20:21], v[40:41] op_sel:[1,1,0] op_sel_hi:[0,1,1] neg_lo:[1,0,0]
  v_pk_mul_f32 v[42:43], v[28:29], v[20:21] op_sel:[0,0] op_sel_hi:[1,0]
  v_pk_fma_f32 v[42:43], v[28:29], v[20:21], v[42:43] op_sel:[1,1,0] op_sel_hi:[0,1,1] neg_lo:[1,0,0]
  v_cvt_pk_bf16_f32 v88, v40, v42
  v_cvt_pk_bf16_f32 v92, -v41, -v43
  v_pk_mul_f32 v[44:45], v[32:33], v[20:21] op_sel:[0,0] op_sel_hi:[1,0]
  v_pk_fma_f32 v[44:45], v[32:33], v[20:21], v[44:45] op_sel:[1,1,0] op_sel_hi:[0,1,1] neg_lo:[1,0,0]
  v_pk_mul_f32 v[46:47], v[36:37], v[20:21] op_sel:[0,0] op_sel_hi:[1,0]
  v_pk_fma_f32 v[46:47], v[36:37], v[20:21], v[46:47] op_sel:[1,1,0] op_sel_hi:[0,1,1] neg_lo:[1,0,0]
  v_cvt_pk_bf16_f32 v89, v44, v46
  v_cvt_pk_bf16_f32 v93, -v45, -v47
  s_cmp_eq_u32 s59, 0
  s_cbranch_scc1 F_gp2
  global_load_dwordx2 v[184:185], v209, s[16:17] offset:0
F_gp2:
  v_pk_mul_f32 v[48:49], v[40:41], v[20:21] op_sel:[0,0] op_sel_hi:[1,0]
  v_pk_fma_f32 v[48:49], v[40:41], v[20:21], v[48:49] op_sel:[1,1,0] op_sel_hi:[0,1,1] neg_lo:[1,0,0]
  v_pk_mul_f32 v[50:51], v[44:45], v[20:21] op_sel:[0,0] op_sel_hi:[1,0]
  v_pk_fma_f32 v[50:51], v[44:45], v[20:21], v[50:51] op_sel:[1,1,0] op_sel_hi:[0,1,1] neg_lo:[1,0,0]
  v_cvt_pk_bf16_f32 v90, v48, v50
  v_cvt_pk_bf16_f32 v94, -v49, -v51
  v_pk_mul_f32 v[52:53], v[48:49], v[20:21] op_sel:[0,0] op_sel_hi:[1,0]
  v_pk_fma_f32 v[52:53], v[48:49], v[20:21], v[52:53] op_sel:[1,1,0] op_sel_hi:[0,1,1] neg_lo:[1,0,0]
  v_pk_mul_f32 v[54:55], v[50:51], v[20:21] op_sel:[0,0] op_sel_hi:[1,0]
  v_pk_fma_f32 v[54:55], v[50:51], v[20:21], v[54:55] op_sel:[1,1,0] op_sel_hi:[0,1,1] neg_lo:[1,0,0]
  v_cvt_pk_bf16_f32 v91, v52, v54
  v_cvt_pk_bf16_f32 v95, -v53, -v55
  ds_write_b128 v6, v[88:91] offset:1088
  ds_write_b128 v6, v[92:95] offset:5440
  v_pk_mul_f32 v[24:25], v[52:53], v[20:21] op_sel:[0,0] op_sel_hi:[1,0]
  v_pk_fma_f32 v[24:25], v[52:53], v[20:21], v[24:25] op_sel:[1,1,0] op_sel_hi:[0,1,1] neg_lo:[1,0,0]
  v_pk_mul_f32 v[26:27], v[24:25], v[20:21] op_sel:[0,0] op_sel_hi:[1,0]
  v_pk_fma_f32 v[26:27], v[24:25], v[20:21], v[26:27] op_sel:[1,1,0] op_sel_hi:[0,1,1] neg_lo:[1,0,0]
  v_cvt_pk_bf16_f32 v88, v24, v26
  v_cvt_pk_bf16_f32 v92, -v25, -v27
  v_pk_mul_f32 v[28:29], v[26:27], v[20:21] op_sel:[0,0] op_sel_hi:[1,0]
  v_pk_fma_f32 v[28:29], v[26:27], v[20:21], v[28:29] op_sel:[1,1,0] op_sel_hi:[0,1,1] neg_lo:[1,0,0]
  v_pk_mul_f32 v[30:31], v[28:29], v[20:21] op_sel:[0,0] op_sel_hi:[1,0]
  v_pk_fma_f32 v[30:31], v[28:29], v[20:21], v[30:31] op_sel:[1,1,0] op_sel_hi:[0,1,1] neg_lo:[1,0,0]
  v_cvt_pk_bf16_f32 v89, v28, v30
  v_cvt_pk_bf16_f32 v93, -v29, -v31
  v_pk_mul_f32 v[32:33], v[30:31], v[20:21] op_sel:[0,0] op_sel_hi:[1,0]
  v_pk_fma_f32 v[32:33], v[30:31], v[20:21], v[32:33] op_sel:[1,1,0] op_sel_hi:[0,1,1] neg_lo:[1,0,0]
  v_cvt_pk_bf16_f32 v90, v32, v32
  v_cvt_pk_bf16_f32 v94, -v33, -v33
  ds_write_b128 v6, v[88:91] offset:2176
  ds_write_b128 v6, v[92:95] offset:6528
  ds_read_b64_tr_b16 v[136:137], v7 offset:0
  ds_read_b64_tr_b16 v[138:139], v7 offset:64
  ds_read_b64_tr_b16 v[140:141], v7 offset:256
  ds_read_b64_tr_b16 v[142:143], v7 offset:320
  ds_read_b64_tr_b16 v[144:145], v7 offset:512
  ds_read_b64_tr_b16 v[146:147], v7 offset:576
  ds_read_b64_tr_b16 v[148:149], v7 offset:768
  ds_read_b64_tr_b16 v[150:151], v7 offset:832
  ds_read_b64_tr_b16 v[152:153], v7 offset:4352
  ds_read_b64_tr_b16 v[154:155], v7 offset:4416
  ds_read_b64_tr_b16 v[156:157], v7 offset:4608
  ds_read_b64_tr_b16 v[158:159], v7 offset:4672
  ds_read_b64_tr_b16 v[160:161], v7 offset:4864
  ds_read_b64_tr_b16 v[162:163], v7 offset:4928
  ds_read_b64_tr_b16 v[164:165], v7 offset:5120
  ds_read_b64_tr_b16 v[166:167], v7 offset:5184
  v_mov_b32 v22, 1.0
  v_mov_b32 v23, 0
  v_cvt_pk_bf16_f32 v88, v22, v18
  v_cvt_pk_bf16_f32 v92, v23, v19
  v_pk_mul_f32 v[24:25], v[18:19], v[18:19] op_sel:[0,0] op_sel_hi:[1,0]
  v_pk_fma_f32 v[24:25], v[18:19], v[18:19], v[24:25] op_sel:[1,1,0] op_sel_hi:[0,1,1] neg_lo:[1,0,0]
  v_pk_mul_f32 v[26:27], v[24:25], v[18:19] op_sel:[0,0] op_sel_hi:[1,0]
  v_pk_fma_f32 v[26:27], v[24:25], v[18:19], v[26:27] op_sel:[1,1,0] op_sel_hi:[0,1,1] neg_lo:[1,0,0]
  v_cvt_pk_bf16_f32 v89, v24, v26
  v_cvt_pk_bf16_f32 v93, v25, v27
  v_pk_mul_f32 v[24:25], v[26:27], v[18:19] op_sel:[0,0] op_sel_hi:[1,0]
  v_pk_fma_f32 v[24:25], v[26:27], v[18:19], v[24:25] op_sel:[1,1,0] op_sel_hi:[0,1,1] neg_lo:[1,0,0]
  s_cmp_eq_u32 s59, 0
  s_cbranch_scc1 F_gp3
  global_load_dwordx2 v[186:187], v209, s[16:17] offset:1280
F_gp3:
  v_pk_mul_f32 v[26:27], v[24:25], v[18:19] op_sel:[0,0] op_sel_hi:[1,0]
  v_pk_fma_f32 v[26:27], v[24:25], v[18:19], v[26:27] op_sel:[1,1,0] op_sel_hi:[0,1,1] neg_lo:[1,0,0]
  v_cvt_pk_bf16_f32 v90, v24, v26
  v_cvt_pk_bf16_f32 v94, v25, v27
  v_pk_mul_f32 v[24:25], v[26:27], v[18:19] op_sel:[0,0] op_sel_hi:[1,0]
  v_pk_fma_f32 v[24:25], v[26:27], v[18:19], v[24:25] op_sel:[1,1,0] op_sel_hi:[0,1,1] neg_lo:[1,0,0]
  v_pk_mul_f32 v[26:27], v[24:25], v[18:19] op_sel:[0,0] op_sel_hi:[1,0]
  v_pk_fma_f32 v[26:27], v[24:25], v[18:19], v[26:27] op_sel:[1,1,0] op_sel_hi:[0,1,1] neg_lo:[1,0,0]
  v_cvt_pk_bf16_f32 v91, v24, v26
  v_cvt_pk_bf16_f32 v95, v25, v27
  ds_write_b128 v6, v[88:91] offset:0
  ds_write_b128 v6, v[92:95] offset:4352
  v_pk_mul_f32 v[24:25], v[26:27], v[18:19] op_sel:[0,0] op_sel_hi:[1,0]
  v_pk_fma_f32 v[24:25], v[26:27], v[18:19], v[24:25] op_sel:[1,1,0] op_sel_hi:[0,1,1] neg_lo:[1,0,0]
  v_pk_mul_f32 v[26:27], v[24:25], v[18:19] op_sel:[0,0] op_sel_hi:[1,0]
  v_pk_fma_f32 v[26:27], v[24:25], v[18:19], v[26:27] op_sel:[1,1,0] op_sel_hi:[0,1,1] neg_lo:[1,0,0]
  v_cvt_pk_bf16_f32 v88, v24, v26
  v_cvt_pk_bf16_f32 v92, v25, v27
  v_pk_mul_f32 v[24:25], v[26:27], v[18:19] op_sel:[0,0] op_sel_hi:[1,0]
  v_pk_fma_f32 v[24:25], v[26:27], v[18:19], v[24:25] op_sel:[1,1,0] op_sel_hi:[0,1,1] neg_lo:[1,0,0]
  v_pk_mul_f32 v[26:27], v[24:25], v[18:19] op_sel:[0,0] op_sel_hi:[1,0]
  v_pk_fma_f32 v[26:27], v[24:25], v[18:19], v[26:27] op_sel:[1,1,0] op_sel_hi:[0,1,1] neg_lo:[1,0,0]
  v_cvt_pk_bf16_f32 v89, v24, v26
  v_cvt_pk_bf16_f32 v93, v25, v27
  v_pk_mul_f32 v[24:25], v[26:27], v[18:19] op_sel:[0,0] op_sel_hi:[1,0]
  v_pk_fma_f32 v[24:25], v[26:27], v[18:19], v[24:25] op_sel:[1,1,0] op_sel_hi:[0,1,1] neg_lo:[1,0,0]
  v_pk_mul_f32 v[26:27], v[24:25], v[18:19] op_sel:[0,0] op_sel_hi:[1,0]
  v_pk_fma_f32 v[26:27], v[24:25], v[18:19], v[26:27] op_sel:[1,1,0] op_sel_hi:[0,1,1] neg_lo:[1,0,0]
  v_cvt_pk_bf16_f32 v90, v24, v26
  v_cvt_pk_bf16_f32 v94, v25, v27
  v_pk_mul_f32 v[24:25], v[26:27], v[18:19] op_sel:[0,0] op_sel_hi:[1,0]
  v_pk_fma_f32 v[24:25], v[26:27], v[18:19], v[24:25] op_sel:[1,1,0] op_sel_hi:[0,1,1] neg_lo:[1,0,0]
  s_cmp_eq_u32 s59, 0
  s_cbranch_scc1 F_gp4
  global_load_dwordx2 v[188:189], v210, s[16:17] offset:0
F_gp4:
  v_pk_mul_f32 v[26:27], v[24:25], v[18:19] op_sel:[0,0] op_sel_hi:[1,0]
  v_pk_fma_f32 v[26:27], v[24:25], v[18:19], v[26:27] op_sel:[1,1,0] op_sel_hi:[0,1,1] neg_lo:[1,0,0]
  v_cvt_pk_bf16_f32 v91, v24, v26
  v_cvt_pk_bf16_f32 v95, v25, v27
  ds_write_b128 v6, v[88:91] offset:1088
  ds_write_b128 v6, v[92:95] offset:5440
  v_pk_mul_f32 v[24:25], v[26:27], v[18:19] op_sel:[0,0] op_sel_hi:[1,0]
  v_pk_fma_f32 v[24:25], v[26:27], v[18:19], v[24:25] op_sel:[1,1,0] op_sel_hi:[0,1,1] neg_lo:[1,0,0]
  v_pk_mul_f32 v[26:27], v[24:25], v[18:19] op_sel:[0,0] op_sel_hi:[1,0]
  v_pk_fma_f32 v[26:27], v[24:25], v[18:19], v[26:27] op_sel:[1,1,0] op_sel_hi:[0,1,1] neg_lo:[1,0,0]
  v_cvt_pk_bf16_f32 v88, v24, v26
  v_cvt_pk_bf16_f32 v92, v25, v27
  v_pk_mul_f32 v[24:25], v[26:27], v[18:19] op_sel:[0,0] op_sel_hi:[1,0]
  v_pk_fma_f32 v[24:25], v[26:27], v[18:19], v[24:25] op_sel:[1,1,0] op_sel_hi:[0,1,1] neg_lo:[1,0,0]
  v_pk_mul_f32 v[26:27], v[24:25], v[18:19] op_sel:[0,0] op_sel_hi:[1,0]
  v_pk_fma_f32 v[26:27], v[24:25], v[18:19], v[26:27] op_sel:[1,1,0] op_sel_hi:[0,1,1] neg_lo:[1,0,0]
  v_cvt_pk_bf16_f32 v89, v24, v26
  v_cvt_pk_bf16_f32 v93, v25, v27
  v_pk_mul_f32 v[24:25], v[26:27], v[18:19] op_sel:[0,0] op_sel_hi:[1,0]
  v_pk_fma_f32 v[24:25], v[26:27], v[18:19], v[24:25] op_sel:[1,1,0] op_sel_hi:[0,1,1] neg_lo:[1,0,0]
  v_pk_mul_f32 v[26:27], v[24:25], v[18:19] op_sel:[0,0] op_sel_hi:[1,0]
  v_pk_fma_f32 v[26:27], v[24:25], v[18:19], v[26:27] op_sel:[1,1,0] op_sel_hi:[0,1,1] neg_lo:[1,0,0]
  v_cvt_pk_bf16_f32 v90, v24, v26
  v_cvt_pk_bf16_f32 v94, v25, v27
  v_pk_mul_f32 v[24:25], v[26:27], v[18:19] op_sel:[0,0] op_sel_hi:[1,0]
  v_pk_fma_f32 v[24:25], v[26:27], v[18:19], v[24:25] op_sel:[1,1,0] op_sel_hi:[0,1,1] neg_lo:[1,0,0]
  s_cmp_eq_u32 s59, 0
  s_cbranch_scc1 F_gp5
  global_load_dwordx2 v[190:191], v210, s[16:17] offset:1280
F_gp5:
  v_pk_mul_f32 v[26:27], v[24:25], v[18:19] op_sel:[0,0] op_sel_hi:[1,0]
  v_pk_fma_f32 v[26:27], v[24:25], v[18:19], v[26:27] op_sel:[1,1,0] op_sel_hi:[0,1,1] neg_lo:[1,0,0]
  v_cvt_pk_bf16_f32 v91, v24, v26
  v_cvt_pk_bf16_f32 v95, v25, v27
  ds_write_b128 v6, v[88:91] offset:2176
  ds_write_b128 v6, v[92:95] offset:6528
  v_pk_mul_f32 v[24:25], v[26:27], v[18:19] op_sel:[0,0] op_sel_hi:[1,0]
  v_pk_fma_f32 v[24:25], v[26:27], v[18:19], v[24:25] op_sel:[1,1,0] op_sel_hi:[0,1,1] neg_lo:[1,0,0]
  v_pk_mul_f32 v[26:27], v[24:25], v[18:19] op_sel:[0,0] op_sel_hi:[1,0]
  v_pk_fma_f32 v[26:27], v[24:25], v[18:19], v[26:27] op_sel:[1,1,0] op_sel_hi:[0,1,1] neg_lo:[1,0,0]
  v_cvt_pk_bf16_f32 v88, v24, v26
  v_cvt_pk_bf16_f32 v92, v25, v27
  v_pk_mul_f32 v[24:25], v[26:27], v[18:19] op_sel:[0,0] op_sel_hi:[1,0]
  v_pk_fma_f32 v[24:25], v[26:27], v[18:19], v[24:25] op_sel:[1,1,0] op_sel_hi:[0,1,1] neg_lo:[1,0,0]
  v_pk_mul_f32 v[26:27], v[24:25], v[18:19] op_sel:[0,0] op_sel_hi:[1,0]
  v_pk_fma_f32 v[26:27], v[24:25], v[18:19], v[26:27] op_sel:[1,1,0] op_sel_hi:[0,1,1] neg_lo:[1,0,0]
  v_cvt_pk_bf16_f32 v89, v24, v26
  v_cvt_pk_bf16_f32 v93, v25, v27
  v_pk_mul_f32 v[24:25], v[26:27], v[18:19] op_sel:[0,0] op_sel_hi:[1,0]
  v_pk_fma_f32 v[24:25], v[26:27], v[18:19], v[24:25] op_sel:[1,1,0] op_sel_hi:[0,1,1] neg_lo:[1,0,0]
  v_pk_mul_f32 v[26:27], v[24:25], v[18:19] op_sel:[0,0] op_sel_hi:[1,0]
  v_pk_fma_f32 v[26:27], v[24:25], v[18:19], v[26:27] op_sel:[1,1,0] op_sel_hi:[0,1,1] neg_lo:[1,0,0]
  v_cvt_pk_bf16_f32 v90, v24, v26
  v_cvt_pk_bf16_f32 v94, v25, v27
  v_pk_mul_f32 v[24:25], v[26:27], v[18:19] op_sel:[0,0] op_sel_hi:[1,0]
  v_pk_fma_f32 v[24:25], v[26:27], v[18:19], v[24:25] op_sel:[1,1,0] op_sel_hi:[0,1,1] neg_lo:[1,0,0]
  v_pk_mul_f32 v[26:27], v[24:25], v[18:19] op_sel:[0,0] op_sel_hi:[1,0]
  v_pk_fma_f32 v[26:27], v[24:25], v[18:19], v[26:27] op_sel:[1,1,0] op_sel_hi:[0,1,1] neg_lo:[1,0,0]
  v_cvt_pk_bf16_f32 v91, v24, v26
  v_cvt_pk_bf16_f32 v95, v25, v27
  ds_write_b128 v6, v[88:91] offset:3264
  ds_write_b128 v6, v[92:95] offset:7616
  ds_read_b64_tr_b16 v[56:57], v7 offset:0
  ds_read_b64_tr_b16 v[58:59], v7 offset:64
  ds_read_b64_tr_b16 v[60:61], v7 offset:256
  ds_read_b64_tr_b16 v[62:63], v7 offset:320
  ds_read_b64_tr_b16 v[64:65], v7 offset:512
  ds_read_b64_tr_b16 v[66:67], v7 offset:576
  ds_read_b64_tr_b16 v[68:69], v7 offset:768
  ds_read_b64_tr_b16 v[70:71], v7 offset:832
  ds_read_b64_tr_b16 v[72:73], v7 offset:4352
  ds_read_b64_tr_b16 v[74:75], v7 offset:4416
  ds_read_b64_tr_b16 v[76:77], v7 offset:4608
  ds_read_b64_tr_b16 v[78:79], v7 offset:4672
  ds_read_b64_tr_b16 v[80:81], v7 offset:4864
  ds_read_b64_tr_b16 v[82:83], v7 offset:4928
  ds_read_b64_tr_b16 v[84:85], v7 offset:5120
  ds_read_b64_tr_b16 v[86:87], v7 offset:5184
  s_waitcnt lgkmcnt(14)
  v_mfma_f32_32x32x16_bf16 v[96:111], v[136:139], v[56:59], v[96:111]
  s_waitcnt lgkmcnt(12)
  v_mfma_f32_32x32x16_bf16 v[96:111], v[140:143], v[60:63], v[96:111]
  s_waitcnt lgkmcnt(10)
  v_mfma_f32_32x32x16_bf16 v[96:111], v[144:147], v[64:67], v[96:111]
  s_waitcnt lgkmcnt(8)
  v_mfma_f32_32x32x16_bf16 v[96:111], v[148:151], v[68:71], v[96:111]
  s_waitcnt lgkmcnt(6)
  v_mfma_f32_32x32x16_bf16 v[96:111], v[152:155], v[72:75], v[96:111]
  s_waitcnt lgkmcnt(4)
  v_mfma_f32_32x32x16_bf16 v[96:111], v[156:159], v[76:79], v[96:111]
  s_waitcnt lgkmcnt(2)
  v_mfma_f32_32x32x16_bf16 v[96:111], v[160:163], v[80:83], v[96:111]
  s_waitcnt lgkmcnt(0)
  v_mfma_f32_32x32x16_bf16 v[96:111], v[164:167], v[84:87], v[96:111]
  s_add_u32 s15, s15, 1
  s_cmp_lt_u32 s15, 2
  s_cbranch_scc1 F_unit
  s_cmp_lg_u32 s59, 0
  s_cbranch_scc1 F_help
  s_mov_b32 s78, 0
F_pw:
  ds_read_b32 v9, v134 offset:1796
  s_add_u32 s78, s78, 1
  s_waitcnt lgkmcnt(0)
  v_readfirstlane_b32 s79, v9
  s_nop 0
  s_cmp_lg_u32 s79, 0
  s_cbranch_scc1 F_po
  s_cmp_lt_u32 s78, 8388608
  s_cbranch_scc1 F_pw
F_po:
  ds_read_b128 v[16:19], v131 offset:0
  ds_read_b128 v[20:23], v131 offset:1024
  ds_read_b128 v[24:27], v131 offset:2048
  s_waitcnt lgkmcnt(0)
  v_pk_add_f32 v[96:97], v[96:97], v[16:17]
  v_pk_add_f32 v[98:99], v[98:99], v[18:19]
  v_pk_add_f32 v[100:101], v[100:101], v[20:21]
  v_pk_add_f32 v[102:103], v[102:103], v[22:23]
  v_pk_add_f32 v[104:105], v[104:105], v[24:25]
  v_pk_add_f32 v[106:107], v[106:107], v[26:27]
  v_cvt_pk_bf16_f32 v10, v96, v97
  v_cvt_pk_bf16_f32 v11, v98, v99
  ds_write_b64 v130, v[10:11] offset:0
  v_cvt_pk_bf16_f32 v12, v100, v101
  v_cvt_pk_bf16_f32 v13, v102, v103
  ds_write_b64 v130, v[12:13] offset:16
  v_cvt_pk_bf16_f32 v14, v104, v105
  v_cvt_pk_bf16_f32 v15, v106, v107
  ds_write_b64 v130, v[14:15] offset:32
  v_add_u32 v52, s6, v3
  v_bfe_u32 v16, v2, 1, 2
  v_mul_u32_u24 v16, 4160, v16
  v_and_b32 v17, 1, v2
  v_lshl_add_u32 v16, v17, 4, v16
  v_add_u32 v16, s6, v16
  v_mov_b32 v20, 0
  v_mov_b32 v21, 0
  v_mov_b32 v22, 0
  v_mov_b32 v23, 0
  ds_write_b128 v16, v[20:23] offset:4096
  s_waitcnt lgkmcnt(0)
  ds_read_u16 v56, v200
  ds_read_u16 v57, v201
  ds_read_u16 v58, v202
  ds_read_u16 v59, v203
  ds_read_u16 v60, v204
  ds_read_u16 v61, v205
  ds_read_u16 v62, v206
  ds_read_u16 v63, v207
  ds_read_u16 v64, v208
  ds_read_u16 v65, v209
  ds_read_u16 v66, v210
  ds_read_u16 v68, v211
  ds_read_u16 v69, v212
  ds_read_u16 v70, v213
  ds_read_u16 v71, v214
  ds_read_u16 v72, v215
  ds_read_u16 v73, v216
  ds_read_u16 v74, v217
  ds_read_u16 v75, v218
  ds_read_u16 v76, v219
  ds_read_u16 v77, v220
  ds_read_u16 v78, v221
  s_waitcnt lgkmcnt(11)
  v_lshl_or_b32 v92, v57, 16, v56
  v_lshl_or_b32 v93, v59, 16, v58
  v_lshl_or_b32 v94, v61, 16, v60
  v_lshl_or_b32 v95, v63, 16, v62
  ds_write_b128 v52, v[92:95] offset:12480
  v_lshl_or_b32 v88, v58, 16, v57
  v_lshl_or_b32 v89, v60, 16, v59
  v_lshl_or_b32 v90, v62, 16, v61
  v_lshl_or_b32 v91, v64, 16, v63
  ds_write_b128 v52, v[88:91] offset:8320
  v_lshl_or_b32 v84, v59, 16, v58
  v_lshl_or_b32 v85, v61, 16, v60
  v_lshl_or_b32 v86, v63, 16, v62
  v_lshl_or_b32 v87, v65, 16, v64
  ds_write_b128 v52, v[84:87] offset:4160
  v_lshl_or_b32 v80, v60, 16, v59
  v_lshl_or_b32 v81, v62, 16, v61
  v_lshl_or_b32 v82, v64, 16, v63
  v_lshl_or_b32 v83, v66, 16, v65
  ds_write_b128 v52, v[80:83] offset:0
  ds_read_u16 v56, v222
  ds_read_u16 v57, v223
  ds_read_u16 v58, v224
  ds_read_u16 v59, v225
  ds_read_u16 v60, v226
  ds_read_u16 v61, v227
  ds_read_u16 v62, v228
  ds_read_u16 v63, v229
  ds_read_u16 v64, v230
  ds_read_u16 v65, v231
  ds_read_u16 v66, v232
  s_waitcnt lgkmcnt(11)
  v_lshl_or_b32 v92, v69, 16, v68
  v_lshl_or_b32 v93, v71, 16, v70
  v_lshl_or_b32 v94, v73, 16, v72
  v_lshl_or_b32 v95, v75, 16, v74
  ds_write_b128 v52, v[92:95] offset:13504
  v_lshl_or_b32 v88, v70, 16, v69
  v_lshl_or_b32 v89, v72, 16, v71
  v_lshl_or_b32 v90, v74, 16, v73
  v_lshl_or_b32 v91, v76, 16, v75
  ds_write_b128 v52, v[88:91] offset:9344
  v_lshl_or_b32 v84, v71, 16, v70
  v_lshl_or_b32 v85, v73, 16, v72
  v_lshl_or_b32 v86, v75, 16, v74
  v_lshl_or_b32 v87, v77, 16, v76
  ds_write_b128 v52, v[84:87] offset:5184
  v_lshl_or_b32 v80, v72, 16, v71
  v_lshl_or_b32 v81, v74, 16, v73
  v_lshl_or_b32 v82, v76, 16, v75
  v_lshl_or_b32 v83, v78, 16, v77
  ds_write_b128 v52, v[80:83] offset:1024
  ds_read_u16 v68, v233
  ds_read_u16 v69, v234
  ds_read_u16 v70, v235
  ds_read_u16 v71, v236
  ds_read_u16 v72, v237
  ds_read_u16 v73, v238
  ds_read_u16 v74, v239
  ds_read_u16 v75, v240
  ds_read_u16 v76, v241
  ds_read_u16 v77, v242
  ds_read_u16 v78, v243
  s_waitcnt lgkmcnt(11)
  v_lshl_or_b32 v92, v57, 16, v56
  v_lshl_or_b32 v93, v59, 16, v58
  v_lshl_or_b32 v94, v61, 16, v60
  v_lshl_or_b32 v95, v63, 16, v62
  ds_write_b128 v52, v[92:95] offset:14528
  v_lshl_or_b32 v88, v58, 16, v57
  v_lshl_or_b32 v89, v60, 16, v59
  v_lshl_or_b32 v90, v62, 16, v61
  v_lshl_or_b32 v91, v64, 16, v63
  ds_write_b128 v52, v[88:91] offset:10368
  v_lshl_or_b32 v84, v59, 16, v58
  v_lshl_or_b32 v85, v61, 16, v60
  v_lshl_or_b32 v86, v63, 16, v62
  v_lshl_or_b32 v87, v65, 16, v64
  ds_write_b128 v52, v[84:87] offset:6208
  v_lshl_or_b32 v80, v60, 16, v59
  v_lshl_or_b32 v81, v62, 16, v61
  v_lshl_or_b32 v82, v64, 16, v63
  v_lshl_or_b32 v83, v66, 16, v65
  ds_write_b128 v52, v[80:83] offset:2048
  s_waitcnt lgkmcnt(0)
  v_lshl_or_b32 v92, v69, 16, v68
  v_lshl_or_b32 v93, v71, 16, v70
  v_lshl_or_b32 v94, v73, 16, v72
  v_lshl_or_b32 v95, v75, 16, v74
  ds_write_b128 v52, v[92:95] offset:15552
  v_lshl_or_b32 v88, v70, 16, v69
  v_lshl_or_b32 v89, v72, 16, v71
  v_lshl_or_b32 v90, v74, 16, v73
  v_lshl_or_b32 v91, v76, 16, v75
  ds_write_b128 v52, v[88:91] offset:11392
  v_lshl_or_b32 v84, v71, 16, v70
  v_lshl_or_b32 v85, v73, 16, v72
  v_lshl_or_b32 v86, v75, 16, v74
  v_lshl_or_b32 v87, v77, 16, v76
  ds_write_b128 v52, v[84:87] offset:7232
  v_lshl_or_b32 v80, v72, 16, v71
  v_lshl_or_b32 v81, v74, 16, v73
  v_lshl_or_b32 v82, v76, 16, v75
  v_lshl_or_b32 v83, v78, 16, v77
  ds_write_b128 v52, v[80:83] offset:3072
  v_and_b32 v6, 15, v2
  v_lshrrev_b32 v7, 4, v2
  v_and_b32 v8, 3, v6
  v_mul_u32_u24 v8, 4160, v8
  v_lshrrev_b32 v9, 2, v6
  v_lshlrev_b32 v9, 3, v9
  v_sub_u32 v8, v8, v9
  v_lshl_add_u32 v8, v7, 4, v8
  v_add_u32 v8, 408, v8
  v_add_u32 v12, s6, v8
  v_lshlrev_b32 v8, 5, v6
  v_lshl_add_u32 v8, v7, 4, v8
  v_add_u32 v8, 17056, v8
  v_add_u32 v13, s6, v8
  s_lshl_b32 s10, s58, 12
  s_add_u32 s10, s10, 84992
  v_lshlrev_b32 v8, 5, v6
  v_lshl_add_u32 v8, v7, 3, v8
  v_add_u32 v14, s10, v8
  v_mov_b32 v16, 0
  v_mov_b32 v17, 0
  v_mov_b32 v18, 0
  v_mov_b32 v19, 0
  v_mov_b32 v20, 0
  v_mov_b32 v21, 0
  v_mov_b32 v22, 0
  v_mov_b32 v23, 0
  v_mov_b32 v24, 0
  v_mov_b32 v25, 0
  v_mov_b32 v26, 0
  v_mov_b32 v27, 0
  v_mov_b32 v28, 0
  v_mov_b32 v29, 0
  v_mov_b32 v30, 0
  v_mov_b32 v31, 0
  v_mov_b32 v32, 0
  v_mov_b32 v33, 0
  v_mov_b32 v34, 0
  v_mov_b32 v35, 0
  v_mov_b32 v36, 0
  v_mov_b32 v37, 0
  v_mov_b32 v38, 0
  v_mov_b32 v39, 0
  v_mov_b32 v40, 0
  v_mov_b32 v41, 0
  v_mov_b32 v42, 0
  v_mov_b32 v43, 0
  v_mov_b32 v44, 0
  v_mov_b32 v45, 0
  v_mov_b32 v46, 0
  v_mov_b32 v47, 0
  s_waitcnt lgkmcnt(0)
  s_barrier
  s_setprio 3
  ds_read_b64 v[48:49], v12 offset:3648
  ds_read_b64 v[50:51], v12 offset:3656
  ds_read_b128 v[80:83], v13 offset:64
  ds_read_b64 v[52:53], v12 offset:3136
  ds_read_b64 v[54:55], v12 offset:3144
  ds_read_b128 v[84:87], v13 offset:576
  ds_read_b64 v[56:57], v12 offset:2624
  ds_read_b64 v[58:59], v12 offset:2632
  ds_read_b128 v[88:91], v13 offset:1088
  ds_read_b64 v[60:61], v12 offset:2112
  ds_read_b64 v[62:63], v12 offset:2120
  ds_read_b128 v[92:95], v13 offset:1600
  ds_read_b64 v[64:65], v12 offset:1600
  ds_read_b64 v[66:67], v12 offset:1608
  ds_read_b128 v[96:99], v13 offset:2112
  ds_read_b64 v[68:69], v12 offset:1088
  ds_read_b64 v[70:71], v12 offset:1096
  ds_read_b128 v[100:103], v13 offset:2624
  ds_read_b64 v[72:73], v12 offset:576
  ds_read_b64 v[74:75], v12 offset:584
  ds_read_b128 v[104:107], v13 offset:3136
  ds_read_b64 v[76:77], v12 offset:64
  ds_read_b64 v[78:79], v12 offset:72
  ds_read_b128 v[108:111], v13 offset:3648
  s_mov_b32 s15, 0
F_loop:
  s_waitcnt lgkmcnt(0)
  v_mfma_f32_16x16x32_bf16 v[16:19], v[48:51], v[80:83], v[16:19]
  ds_read_b64 v[112:113], v12 offset:3584
  v_mfma_f32_16x16x32_bf16 v[20:23], v[48:51], v[84:87], v[20:23]
  ds_read_b64 v[114:115], v12 offset:3592
  v_mfma_f32_16x16x32_bf16 v[20:23], v[52:55], v[80:83], v[20:23]
  ds_read_b128 v[144:147], v13 offset:0
  v_mfma_f32_16x16x32_bf16 v[24:27], v[48:51], v[88:91], v[24:27]
  ds_read_b64 v[116:117], v12 offset:3072
  v_mfma_f32_16x16x32_bf16 v[24:27], v[52:55], v[84:87], v[24:27]
  ds_read_b64 v[118:119], v12 offset:3080
  v_mfma_f32_16x16x32_bf16 v[24:27], v[56:59], v[80:83], v[24:27]
  ds_read_b128 v[148:151], v13 offset:512
  v_mfma_f32_16x16x32_bf16 v[28:31], v[48:51], v[92:95], v[28:31]
  ds_read_b64 v[120:121], v12 offset:2560
  v_mfma_f32_16x16x32_bf16 v[28:31], v[52:55], v[88:91], v[28:31]
  ds_read_b64 v[122:123], v12 offset:2568
  v_mfma_f32_16x16x32_bf16 v[28:31], v[56:59], v[84:87], v[28:31]
  ds_read_b128 v[152:155], v13 offset:1024
  v_mfma_f32_16x16x32_bf16 v[28:31], v[60:63], v[80:83], v[28:31]
  ds_read_b64 v[124:125], v12 offset:2048
  v_mfma_f32_16x16x32_bf16 v[32:35], v[48:51], v[96:99], v[32:35]
  ds_read_b64 v[126:127], v12 offset:2056
  v_mfma_f32_16x16x32_bf16 v[32:35], v[52:55], v[92:95], v[32:35]
  ds_read_b128 v[156:159], v13 offset:1536
  v_mfma_f32_16x16x32_bf16 v[32:35], v[56:59], v[88:91], v[32:35]
  ds_read_b64 v[128:129], v12 offset:1536
  v_mfma_f32_16x16x32_bf16 v[32:35], v[60:63], v[84:87], v[32:35]
  ds_read_b64 v[130:131], v12 offset:1544
  v_mfma_f32_16x16x32_bf16 v[32:35], v[64:67], v[80:83], v[32:35]
  ds_read_b128 v[160:163], v13 offset:2048
  v_mfma_f32_16x16x32_bf16 v[36:39], v[48:51], v[100:103], v[36:39]
  ds_read_b64 v[132:133], v12 offset:1024
  v_mfma_f32_16x16x32_bf16 v[36:39], v[52:55], v[96:99], v[36:39]
  ds_read_b64 v[134:135], v12 offset:1032
  v_mfma_f32_16x16x32_bf16 v[36:39], v[56:59], v[92:95], v[36:39]
  ds_read_b128 v[164:167], v13 offset:2560
  v_mfma_f32_16x16x32_bf16 v[36:39], v[60:63], v[88:91], v[36:39]
  ds_read_b64 v[136:137], v12 offset:512
  v_mfma_f32_16x16x32_bf16 v[36:39], v[64:67], v[84:87], v[36:39]
  ds_read_b64 v[138:139], v12 offset:520
  v_mfma_f32_16x16x32_bf16 v[36:39], v[68:71], v[80:83], v[36:39]
  ds_read_b128 v[168:171], v13 offset:3072
  v_mfma_f32_16x16x32_bf16 v[40:43], v[48:51], v[104:107], v[40:43]
  ds_read_b64 v[140:141], v12 offset:0
  v_mfma_f32_16x16x32_bf16 v[40:43], v[52:55], v[100:103], v[40:43]
  ds_read_b64 v[142:143], v12 offset:8
  v_mfma_f32_16x16x32_bf16 v[40:43], v[56:59], v[96:99], v[40:43]
  ds_read_b128 v[172:175], v13 offset:3584
  v_mfma_f32_16x16x32_bf16 v[40:43], v[60:63], v[92:95], v[40:43]
  v_mfma_f32_16x16x32_bf16 v[40:43], v[64:67], v[88:91], v[40:43]
  v_mfma_f32_16x16x32_bf16 v[40:43], v[68:71], v[84:87], v[40:43]
  v_mfma_f32_16x16x32_bf16 v[40:43], v[72:75], v[80:83], v[40:43]
  v_mfma_f32_16x16x32_bf16 v[44:47], v[48:51], v[108:111], v[44:47]
  v_mfma_f32_16x16x32_bf16 v[44:47], v[52:55], v[104:107], v[44:47]
  v_mfma_f32_16x16x32_bf16 v[44:47], v[56:59], v[100:103], v[44:47]
  v_mfma_f32_16x16x32_bf16 v[44:47], v[60:63], v[96:99], v[44:47]
  v_mfma_f32_16x16x32_bf16 v[44:47], v[64:67], v[92:95], v[44:47]
  v_mfma_f32_16x16x32_bf16 v[44:47], v[68:71], v[88:91], v[44:47]
  v_mfma_f32_16x16x32_bf16 v[44:47], v[72:75], v[84:87], v[44:47]
  v_mfma_f32_16x16x32_bf16 v[44:47], v[76:79], v[80:83], v[44:47]
  v_subrev_u32 v12, 128, v12
  v_subrev_u32 v13, 128, v13
  s_waitcnt lgkmcnt(0)
  s_cmp_eq_u32 s15, 3
  s_cbranch_scc1 F_last
  v_mfma_f32_16x16x32_bf16 v[16:19], v[112:115], v[144:147], v[16:19]
  ds_read_b64 v[48:49], v12 offset:3648
  v_mfma_f32_16x16x32_bf16 v[20:23], v[112:115], v[148:151], v[20:23]
  ds_read_b64 v[50:51], v12 offset:3656
  v_mfma_f32_16x16x32_bf16 v[20:23], v[116:119], v[144:147], v[20:23]
  ds_read_b128 v[80:83], v13 offset:64
  v_mfma_f32_16x16x32_bf16 v[24:27], v[112:115], v[152:155], v[24:27]
  ds_read_b64 v[52:53], v12 offset:3136
  v_mfma_f32_16x16x32_bf16 v[24:27], v[116:119], v[148:151], v[24:27]
  ds_read_b64 v[54:55], v12 offset:3144
  v_mfma_f32_16x16x32_bf16 v[24:27], v[120:123], v[144:147], v[24:27]
  ds_read_b128 v[84:87], v13 offset:576
  v_mfma_f32_16x16x32_bf16 v[28:31], v[112:115], v[156:159], v[28:31]
  ds_read_b64 v[56:57], v12 offset:2624
  v_mfma_f32_16x16x32_bf16 v[28:31], v[116:119], v[152:155], v[28:31]
  ds_read_b64 v[58:59], v12 offset:2632
  v_mfma_f32_16x16x32_bf16 v[28:31], v[120:123], v[148:151], v[28:31]
  ds_read_b128 v[88:91], v13 offset:1088
  v_mfma_f32_16x16x32_bf16 v[28:31], v[124:127], v[144:147], v[28:31]
  ds_read_b64 v[60:61], v12 offset:2112
  v_mfma_f32_16x16x32_bf16 v[32:35], v[112:115], v[160:163], v[32:35]
  ds_read_b64 v[62:63], v12 offset:2120
  v_mfma_f32_16x16x32_bf16 v[32:35], v[116:119], v[156:159], v[32:35]
  ds_read_b128 v[92:95], v13 offset:1600
  v_mfma_f32_16x16x32_bf16 v[32:35], v[120:123], v[152:155], v[32:35]
  ds_read_b64 v[64:65], v12 offset:1600
  v_mfma_f32_16x16x32_bf16 v[32:35], v[124:127], v[148:151], v[32:35]
  ds_read_b64 v[66:67], v12 offset:1608
  v_mfma_f32_16x16x32_bf16 v[32:35], v[128:131], v[144:147], v[32:35]
  ds_read_b128 v[96:99], v13 offset:2112
  v_mfma_f32_16x16x32_bf16 v[36:39], v[112:115], v[164:167], v[36:39]
  ds_read_b64 v[68:69], v12 offset:1088
  v_mfma_f32_16x16x32_bf16 v[36:39], v[116:119], v[160:163], v[36:39]
  ds_read_b64 v[70:71], v12 offset:1096
  v_mfma_f32_16x16x32_bf16 v[36:39], v[120:123], v[156:159], v[36:39]
  ds_read_b128 v[100:103], v13 offset:2624
  v_mfma_f32_16x16x32_bf16 v[36:39], v[124:127], v[152:155], v[36:39]
  ds_read_b64 v[72:73], v12 offset:576
  v_mfma_f32_16x16x32_bf16 v[36:39], v[128:131], v[148:151], v[36:39]
  ds_read_b64 v[74:75], v12 offset:584
  v_mfma_f32_16x16x32_bf16 v[36:39], v[132:135], v[144:147], v[36:39]
  ds_read_b128 v[104:107], v13 offset:3136
  v_mfma_f32_16x16x32_bf16 v[40:43], v[112:115], v[168:171], v[40:43]
  ds_read_b64 v[76:77], v12 offset:64
  v_mfma_f32_16x16x32_bf16 v[40:43], v[116:119], v[164:167], v[40:43]
  ds_read_b64 v[78:79], v12 offset:72
  v_mfma_f32_16x16x32_bf16 v[40:43], v[120:123], v[160:163], v[40:43]
  ds_read_b128 v[108:111], v13 offset:3648
  v_mfma_f32_16x16x32_bf16 v[40:43], v[124:127], v[156:159], v[40:43]
  v_mfma_f32_16x16x32_bf16 v[40:43], v[128:131], v[152:155], v[40:43]
  v_mfma_f32_16x16x32_bf16 v[40:43], v[132:135], v[148:151], v[40:43]
  v_mfma_f32_16x16x32_bf16 v[40:43], v[136:139], v[144:147], v[40:43]
  v_mfma_f32_16x16x32_bf16 v[44:47], v[112:115], v[172:175], v[44:47]
  v_mfma_f32_16x16x32_bf16 v[44:47], v[116:119], v[168:171], v[44:47]
  v_mfma_f32_16x16x32_bf16 v[44:47], v[120:123], v[164:167], v[44:47]
  v_mfma_f32_16x16x32_bf16 v[44:47], v[124:127], v[160:163], v[44:47]
  v_mfma_f32_16x16x32_bf16 v[44:47], v[128:131], v[156:159], v[44:47]
  v_mfma_f32_16x16x32_bf16 v[44:47], v[132:135], v[152:155], v[44:47]
  v_mfma_f32_16x16x32_bf16 v[44:47], v[136:139], v[148:151], v[44:47]
  v_mfma_f32_16x16x32_bf16 v[44:47], v[140:143], v[144:147], v[44:47]
  s_add_u32 s15, s15, 1
  s_branch F_loop
F_last:
  v_mfma_f32_16x16x32_bf16 v[44:47], v[112:115], v[172:175], v[44:47]
  v_mfma_f32_16x16x32_bf16 v[44:47], v[116:119], v[168:171], v[44:47]
  v_mfma_f32_16x16x32_bf16 v[44:47], v[120:123], v[164:167], v[44:47]
  v_mfma_f32_16x16x32_bf16 v[44:47], v[124:127], v[160:163], v[44:47]
  v_mfma_f32_16x16x32_bf16 v[44:47], v[128:131], v[156:159], v[44:47]
  v_mfma_f32_16x16x32_bf16 v[44:47], v[132:135], v[152:155], v[44:47]
  v_mfma_f32_16x16x32_bf16 v[44:47], v[136:139], v[148:151], v[44:47]
  v_mfma_f32_16x16x32_bf16 v[44:47], v[140:143], v[144:147], v[44:47]
  v_mfma_f32_16x16x32_bf16 v[40:43], v[112:115], v[168:171], v[40:43]
  v_mfma_f32_16x16x32_bf16 v[40:43], v[116:119], v[164:167], v[40:43]
  v_mfma_f32_16x16x32_bf16 v[40:43], v[120:123], v[160:163], v[40:43]
  v_mfma_f32_16x16x32_bf16 v[40:43], v[124:127], v[156:159], v[40:43]
  v_mfma_f32_16x16x32_bf16 v[40:43], v[128:131], v[152:155], v[40:43]
  v_mfma_f32_16x16x32_bf16 v[40:43], v[132:135], v[148:151], v[40:43]
  s_nop 1
  v_cvt_pk_bf16_f32 v62, v44, v45
  v_cvt_pk_bf16_f32 v63, v46, v47
  v_mfma_f32_16x16x32_bf16 v[40:43], v[136:139], v[144:147], v[40:43]
  ds_write_b64 v14, v[62:63] offset:3584
  v_mfma_f32_16x16x32_bf16 v[36:39], v[112:115], v[164:167], v[36:39]
  v_mfma_f32_16x16x32_bf16 v[36:39], v[116:119], v[160:163], v[36:39]
  v_mfma_f32_16x16x32_bf16 v[36:39], v[120:123], v[156:159], v[36:39]
  v_mfma_f32_16x16x32_bf16 v[36:39], v[124:127], v[152:155], v[36:39]
  v_mfma_f32_16x16x32_bf16 v[36:39], v[128:131], v[148:151], v[36:39]
  v_mfma_f32_16x16x32_bf16 v[36:39], v[132:135], v[144:147], v[36:39]
  s_nop 0
  v_cvt_pk_bf16_f32 v60, v40, v41
  v_cvt_pk_bf16_f32 v61, v42, v43
  v_mfma_f32_16x16x32_bf16 v[32:35], v[112:115], v[160:163], v[32:35]
  ds_write_b64 v14, v[60:61] offset:3072
  v_mfma_f32_16x16x32_bf16 v[32:35], v[116:119], v[156:159], v[32:35]
  v_mfma_f32_16x16x32_bf16 v[32:35], v[120:123], v[152:155], v[32:35]
  v_mfma_f32_16x16x32_bf16 v[32:35], v[124:127], v[148:151], v[32:35]
  v_mfma_f32_16x16x32_bf16 v[32:35], v[128:131], v[144:147], v[32:35]
  v_mfma_f32_16x16x32_bf16 v[28:31], v[112:115], v[156:159], v[28:31]
  v_cvt_pk_bf16_f32 v58, v36, v37
  v_cvt_pk_bf16_f32 v59, v38, v39
  v_mfma_f32_16x16x32_bf16 v[28:31], v[116:119], v[152:155], v[28:31]
  ds_write_b64 v14, v[58:59] offset:2560
  v_mfma_f32_16x16x32_bf16 v[28:31], v[120:123], v[148:151], v[28:31]
  v_mfma_f32_16x16x32_bf16 v[28:31], v[124:127], v[144:147], v[28:31]
  v_mfma_f32_16x16x32_bf16 v[24:27], v[112:115], v[152:155], v[24:27]
  v_mfma_f32_16x16x32_bf16 v[24:27], v[116:119], v[148:151], v[24:27]
  v_cvt_pk_bf16_f32 v56, v32, v33
  v_cvt_pk_bf16_f32 v57, v34, v35
  v_mfma_f32_16x16x32_bf16 v[24:27], v[120:123], v[144:147], v[24:27]
  ds_write_b64 v14, v[56:57] offset:2048
  v_mfma_f32_16x16x32_bf16 v[20:23], v[112:115], v[148:151], v[20:23]
  v_mfma_f32_16x16x32_bf16 v[20:23], v[116:119], v[144:147], v[20:23]
  v_mfma_f32_16x16x32_bf16 v[16:19], v[112:115], v[144:147], v[16:19]
  v_cvt_pk_bf16_f32 v54, v28, v29
  v_cvt_pk_bf16_f32 v55, v30, v31
  ds_write_b64 v14, v[54:55] offset:1536
  s_nop 0
  v_cvt_pk_bf16_f32 v52, v24, v25
  v_cvt_pk_bf16_f32 v53, v26, v27
  ds_write_b64 v14, v[52:53] offset:1024
  v_cvt_pk_bf16_f32 v50, v20, v21
  v_cvt_pk_bf16_f32 v51, v22, v23
  ds_write_b64 v14, v[50:51] offset:512
  v_cvt_pk_bf16_f32 v48, v16, v17
  v_cvt_pk_bf16_f32 v49, v18, v19
  ds_write_b64 v14, v[48:49] offset:0
  s_waitcnt lgkmcnt(0)
  s_barrier
  s_setprio 0
  s_cmp_lg_u32 s3, 0
  s_cbranch_scc1 F_b5
  s_waitcnt vmcnt(0)
  v_readfirstlane_b32 s77, v255
  v_mov_b32 v250, 128
  s_mov_b32 s78, 0
  s_mov_b64 exec, 1
F_pl5:
  buffer_load_dword v251, v254, s[36:39], 0 offen sc1
  s_waitcnt vmcnt(0)
  v_readfirstlane_b32 s79, v251
  s_add_u32 s78, s78, 1
  s_cmp_lg_u32 s79, s77
  s_cbranch_scc1 F_pl5_ok
  s_sleep 2
  s_and_b32 s79, s78, 15
  s_cmp_lg_u32 s79, 1
  s_cbranch_scc1 F_pl5
  global_load_dword v251, v250, s[34:35] sc1
  s_waitcnt vmcnt(0)
  v_readfirstlane_b32 s79, v251
  s_nop 0
  s_cmp_lg_u32 s79, 0
  s_cbranch_scc1 F_pl5_ok
  s_cmp_lt_u32 s78, 400000
  s_cbranch_scc1 F_pl5
F_pl5_ok:
  s_mov_b64 exec, -1
F_b5:
  s_barrier
  s_cmp_lg_u32 s3, 0
  s_cbranch_scc1 F_fin
  s_lshl_b32 s10, s60, 7
  s_add_u32 s10, s10, 33075200
  v_mov_b32 v250, s10
  v_mov_b32 v251, 1
  s_mov_b64 exec, 1
  global_atomic_add v252, v250, v251, s[32:33] sc0 sc1
  s_waitcnt vmcnt(0)
  v_readfirstlane_b32 s79, v252
  s_mov_b64 exec, -1
  s_cmp_lg_u32 s79, 19
  s_cbranch_scc1 F_ar1
  v_lshlrev_b32 v250, 7, v2
  v_mov_b32 v251, 1
  s_lshl_b32 s79, s60, 2
  s_add_u32 s79, s79, 33079296
  buffer_store_dword v251, v250, s[36:39], s79 offen sc1
F_ar1:
  s_branch F_fin
F_help:
  v_mov_b32 v252, 0
  s_mov_b64 exec, 1
  global_load_dword v253, v252, s[34:35] sc1
  s_mov_b64 exec, -1
  v_and_b32 v9, 0x1f0, v3
  v_add_u32 v9, s6, v9
  v_mov_b32 v12, 0
  v_mov_b32 v13, 0
  v_mov_b32 v14, 0
  v_mov_b32 v15, 0
  ds_write_b128 v9, v[12:15] offset:16640
  s_nop 7
  ds_write_b128 v131, v[96:99] offset:0
  ds_write_b128 v131, v[100:103] offset:1024
  ds_write_b128 v131, v[104:107] offset:2048
  v_mov_b32 v9, 1
  s_waitcnt lgkmcnt(0)
  ds_write_b32 v134, v9 offset:1796
  s_waitcnt vmcnt(0)
  v_readfirstlane_b32 s79, v253
  s_nop 0
  s_cmp_ge_u32 s79, 64
  s_cbranch_scc1 F_st
  v_mov_b32 v250, 0
  s_mov_b32 s78, 0
  s_mov_b64 exec, 1
F_pl1:
  global_load_dword v251, v250, s[34:35] sc1
  s_waitcnt vmcnt(0)
  v_readfirstlane_b32 s79, v251
  s_add_u32 s78, s78, 1
  s_cmp_ge_u32 s79, 64
  s_cbranch_scc1 F_pl1_ok
  s_sleep 16
  s_cmp_lt_u32 s78, 400000
  s_cbranch_scc1 F_pl1
F_pl1_ok:
  s_mov_b64 exec, -1
F_st:
  s_mov_b32 s10, 32636928
  buffer_load_dwordx4 v[192:195], v4, s[36:39], s10 offen sc1
  s_add_u32 s10, s10, 4096
  buffer_load_dwordx4 v[196:199], v4, s[36:39], s10 offen sc1
  s_add_u32 s10, s10, 4096
  buffer_load_dwordx4 v[200:203], v4, s[36:39], s10 offen sc1
  s_add_u32 s10, s10, 4096
  buffer_load_dwordx4 v[204:207], v4, s[36:39], s10 offen sc1
  s_add_u32 s10, s10, 4096
  v_lshlrev_b32 v64, 16, v176
  v_and_b32 v65, s40, v176
  v_lshlrev_b32 v66, 16, v177
  v_and_b32 v67, s40, v177
  v_lshlrev_b32 v68, 16, v178
  v_and_b32 v69, s40, v178
  v_lshlrev_b32 v70, 16, v179
  v_and_b32 v71, s40, v179
  v_lshlrev_b32 v72, 16, v180
  v_and_b32 v73, s40, v180
  v_lshlrev_b32 v74, 16, v181
  v_and_b32 v75, s40, v181
  v_lshlrev_b32 v76, 16, v182
  v_and_b32 v77, s40, v182
  v_lshlrev_b32 v78, 16, v183
  v_and_b32 v79, s40, v183
  v_lshlrev_b32 v80, 16, v184
  v_and_b32 v81, s40, v184
  v_lshlrev_b32 v82, 16, v185
  v_and_b32 v83, s40, v185
  v_lshlrev_b32 v84, 16, v186
  v_and_b32 v85, s40, v186
  v_lshlrev_b32 v86, 16, v187
  v_and_b32 v87, s40, v187
  v_lshlrev_b32 v88, 16, v188
  v_and_b32 v89, s40, v188
  v_lshlrev_b32 v90, 16, v189
  v_and_b32 v91, s40, v189
  v_lshlrev_b32 v92, 16, v190
  v_and_b32 v93, s40, v190
  v_lshlrev_b32 v94, 16, v191
  v_and_b32 v95, s40, v191
  v_lshrrev_b32 v5, 2, v4
  v_add_u32 v6, 17152, v5
  v_add_u32 v7, 42496, v6
  v_add_u32 v5, 84992, v5
  v_lshlrev_b32 v8, 1, v4
  s_lshl_b32 s66, s62, 16
  s_and_b32 s67, s62, s40
  s_lshl_b32 s68, s63, 16
  s_and_b32 s69, s63, s40
  s_mov_b32 s41, 0x07060302
  s_waitcnt vmcnt(0)
  v_pk_add_f32 v[96:97], v[64:65], v[192:193] op_sel_hi:[1,0] neg_lo:[0,1] neg_hi:[0,1]
  v_cvt_pk_bf16_f32 v9, v96, v97
  v_lshlrev_b32 v96, 16, v9
  v_and_b32 v97, s40, v9
  v_pk_mul_f32 v[96:97], v[96:97], v[192:193] op_sel:[0,1] op_sel_hi:[1,1]
  v_pk_add_f32 v[98:99], v[66:67], v[192:193] op_sel_hi:[1,0] neg_lo:[0,1] neg_hi:[0,1]
  v_cvt_pk_bf16_f32 v9, v98, v99
  v_lshlrev_b32 v98, 16, v9
  v_and_b32 v99, s40, v9
  v_pk_mul_f32 v[98:99], v[98:99], v[192:193] op_sel:[0,1] op_sel_hi:[1,1]
  v_pk_add_f32 v[100:101], v[68:69], v[194:195] op_sel_hi:[1,0] neg_lo:[0,1] neg_hi:[0,1]
  v_cvt_pk_bf16_f32 v9, v100, v101
  v_lshlrev_b32 v100, 16, v9
  v_and_b32 v101, s40, v9
  v_pk_mul_f32 v[100:101], v[100:101], v[194:195] op_sel:[0,1] op_sel_hi:[1,1]
  v_pk_add_f32 v[102:103], v[70:71], v[194:195] op_sel_hi:[1,0] neg_lo:[0,1] neg_hi:[0,1]
  v_cvt_pk_bf16_f32 v9, v102, v103
  v_lshlrev_b32 v102, 16, v9
  v_and_b32 v103, s40, v9
  v_pk_mul_f32 v[102:103], v[102:103], v[194:195] op_sel:[0,1] op_sel_hi:[1,1]
  v_cvt_pk_bf16_f32 v48, v96, v100
  ds_write_b32 v6, v48 offset:0
  v_cvt_pk_bf16_f32 v49, v97, v101
  ds_write_b32 v6, v49 offset:21248
  v_cvt_pk_bf16_f32 v50, v98, v102
  ds_write_b32 v7, v50 offset:0
  v_cvt_pk_bf16_f32 v51, v99, v103
  ds_write_b32 v7, v51 offset:21248
  v_pk_add_f32 v[104:105], v[72:73], v[196:197] op_sel_hi:[1,0] neg_lo:[0,1] neg_hi:[0,1]
  v_cvt_pk_bf16_f32 v9, v104, v105
  v_lshlrev_b32 v104, 16, v9
  v_and_b32 v105, s40, v9
  v_pk_mul_f32 v[104:105], v[104:105], v[196:197] op_sel:[0,1] op_sel_hi:[1,1]
  v_pk_add_f32 v[106:107], v[74:75], v[196:197] op_sel_hi:[1,0] neg_lo:[0,1] neg_hi:[0,1]
  v_cvt_pk_bf16_f32 v9, v106, v107
  v_lshlrev_b32 v106, 16, v9
  v_and_b32 v107, s40, v9
  v_pk_mul_f32 v[106:107], v[106:107], v[196:197] op_sel:[0,1] op_sel_hi:[1,1]
  v_pk_add_f32 v[108:109], v[76:77], v[198:199] op_sel_hi:[1,0] neg_lo:[0,1] neg_hi:[0,1]
  v_cvt_pk_bf16_f32 v9, v108, v109
  v_lshlrev_b32 v108, 16, v9
  v_and_b32 v109, s40, v9
  v_pk_mul_f32 v[108:109], v[108:109], v[198:199] op_sel:[0,1] op_sel_hi:[1,1]
  v_pk_add_f32 v[110:111], v[78:79], v[198:199] op_sel_hi:[1,0] neg_lo:[0,1] neg_hi:[0,1]
  v_cvt_pk_bf16_f32 v9, v110, v111
  v_lshlrev_b32 v110, 16, v9
  v_and_b32 v111, s40, v9
  v_pk_mul_f32 v[110:111], v[110:111], v[198:199] op_sel:[0,1] op_sel_hi:[1,1]
  v_cvt_pk_bf16_f32 v52, v104, v108
  ds_write_b32 v6, v52 offset:1024
  v_cvt_pk_bf16_f32 v53, v105, v109
  ds_write_b32 v6, v53 offset:22272
  v_cvt_pk_bf16_f32 v54, v106, v110
  ds_write_b32 v7, v54 offset:1024
  v_cvt_pk_bf16_f32 v55, v107, v111
  ds_write_b32 v7, v55 offset:22272
  v_pk_add_f32 v[112:113], v[80:81], v[200:201] op_sel_hi:[1,0] neg_lo:[0,1] neg_hi:[0,1]
  v_cvt_pk_bf16_f32 v9, v112, v113
  v_lshlrev_b32 v112, 16, v9
  v_and_b32 v113, s40, v9
  v_pk_mul_f32 v[112:113], v[112:113], v[200:201] op_sel:[0,1] op_sel_hi:[1,1]
  v_pk_add_f32 v[114:115], v[82:83], v[200:201] op_sel_hi:[1,0] neg_lo:[0,1] neg_hi:[0,1]
  v_cvt_pk_bf16_f32 v9, v114, v115
  v_lshlrev_b32 v114, 16, v9
  v_and_b32 v115, s40, v9
  v_pk_mul_f32 v[114:115], v[114:115], v[200:201] op_sel:[0,1] op_sel_hi:[1,1]
  v_pk_add_f32 v[116:117], v[84:85], v[202:203] op_sel_hi:[1,0] neg_lo:[0,1] neg_hi:[0,1]
  v_cvt_pk_bf16_f32 v9, v116, v117
  v_lshlrev_b32 v116, 16, v9
  v_and_b32 v117, s40, v9
  v_pk_mul_f32 v[116:117], v[116:117], v[202:203] op_sel:[0,1] op_sel_hi:[1,1]
  v_pk_add_f32 v[118:119], v[86:87], v[202:203] op_sel_hi:[1,0] neg_lo:[0,1] neg_hi:[0,1]
  v_cvt_pk_bf16_f32 v9, v118, v119
  v_lshlrev_b32 v118, 16, v9
  v_and_b32 v119, s40, v9
  v_pk_mul_f32 v[118:119], v[118:119], v[202:203] op_sel:[0,1] op_sel_hi:[1,1]
  v_cvt_pk_bf16_f32 v56, v112, v116
  ds_write_b32 v6, v56 offset:2048
  v_cvt_pk_bf16_f32 v57, v113, v117
  ds_write_b32 v6, v57 offset:23296
  v_cvt_pk_bf16_f32 v58, v114, v118
  ds_write_b32 v7, v58 offset:2048
  v_cvt_pk_bf16_f32 v59, v115, v119
  ds_write_b32 v7, v59 offset:23296
  v_pk_add_f32 v[120:121], v[88:89], v[204:205] op_sel_hi:[1,0] neg_lo:[0,1] neg_hi:[0,1]
  v_cvt_pk_bf16_f32 v9, v120, v121
  v_lshlrev_b32 v120, 16, v9
  v_and_b32 v121, s40, v9
  v_pk_mul_f32 v[120:121], v[120:121], v[204:205] op_sel:[0,1] op_sel_hi:[1,1]
  v_pk_add_f32 v[122:123], v[90:91], v[204:205] op_sel_hi:[1,0] neg_lo:[0,1] neg_hi:[0,1]
  v_cvt_pk_bf16_f32 v9, v122, v123
  v_lshlrev_b32 v122, 16, v9
  v_and_b32 v123, s40, v9
  v_pk_mul_f32 v[122:123], v[122:123], v[204:205] op_sel:[0,1] op_sel_hi:[1,1]
  v_pk_add_f32 v[124:125], v[92:93], v[206:207] op_sel_hi:[1,0] neg_lo:[0,1] neg_hi:[0,1]
  v_cvt_pk_bf16_f32 v9, v124, v125
  v_lshlrev_b32 v124, 16, v9
  v_and_b32 v125, s40, v9
  v_pk_mul_f32 v[124:125], v[124:125], v[206:207] op_sel:[0,1] op_sel_hi:[1,1]
  v_pk_add_f32 v[126:127], v[94:95], v[206:207] op_sel_hi:[1,0] neg_lo:[0,1] neg_hi:[0,1]
  v_cvt_pk_bf16_f32 v9, v126, v127
  v_lshlrev_b32 v126, 16, v9
  v_and_b32 v127, s40, v9
  v_pk_mul_f32 v[126:127], v[126:127], v[206:207] op_sel:[0,1] op_sel_hi:[1,1]
  v_cvt_pk_bf16_f32 v60, v120, v124
  ds_write_b32 v6, v60 offset:3072
  v_cvt_pk_bf16_f32 v61, v121, v125
  ds_write_b32 v6, v61 offset:24320
  v_cvt_pk_bf16_f32 v62, v122, v126
  ds_write_b32 v7, v62 offset:3072
  v_cvt_pk_bf16_f32 v63, v123, v127
  ds_write_b32 v7, v63 offset:24320
  s_waitcnt lgkmcnt(0)
  s_barrier
  v_lshlrev_b32 v96, 16, v48
  v_lshlrev_b32 v97, 16, v49
  v_lshlrev_b32 v98, 16, v50
  v_lshlrev_b32 v99, 16, v51
  v_mul_f32 v96, s66, v96
  v_mul_f32 v97, s67, v97
  v_cvt_pk_bf16_f32 v9, v96, v97
  v_lshlrev_b32 v96, 16, v9
  v_and_b32 v97, s40, v9
  v_mul_f32 v98, s68, v98
  v_mul_f32 v99, s69, v99
  v_cvt_pk_bf16_f32 v9, v98, v99
  v_lshlrev_b32 v98, 16, v9
  v_and_b32 v99, s40, v9
  v_and_b32 v100, s40, v48
  v_and_b32 v101, s40, v49
  v_and_b32 v102, s40, v50
  v_and_b32 v103, s40, v51
  v_mul_f32 v100, s66, v100
  v_mul_f32 v101, s67, v101
  v_cvt_pk_bf16_f32 v9, v100, v101
  v_lshlrev_b32 v100, 16, v9
  v_and_b32 v101, s40, v9
  v_mul_f32 v102, s68, v102
  v_mul_f32 v103, s69, v103
  v_cvt_pk_bf16_f32 v9, v102, v103
  v_lshlrev_b32 v102, 16, v9
  v_and_b32 v103, s40, v9
  v_lshlrev_b32 v104, 16, v52
  v_lshlrev_b32 v105, 16, v53
  v_lshlrev_b32 v106, 16, v54
  v_lshlrev_b32 v107, 16, v55
  v_mul_f32 v104, s66, v104
  v_mul_f32 v105, s67, v105
  v_cvt_pk_bf16_f32 v9, v104, v105
  v_lshlrev_b32 v104, 16, v9
  v_and_b32 v105, s40, v9
  v_mul_f32 v106, s68, v106
  v_mul_f32 v107, s69, v107
  v_cvt_pk_bf16_f32 v9, v106, v107
  v_lshlrev_b32 v106, 16, v9
  v_and_b32 v107, s40, v9
  v_and_b32 v108, s40, v52
  v_and_b32 v109, s40, v53
  v_and_b32 v110, s40, v54
  v_and_b32 v111, s40, v55
  v_mul_f32 v108, s66, v108
  v_mul_f32 v109, s67, v109
  v_cvt_pk_bf16_f32 v9, v108, v109
  v_lshlrev_b32 v108, 16, v9
  v_and_b32 v109, s40, v9
  v_mul_f32 v110, s68, v110
  v_mul_f32 v111, s69, v111
  v_cvt_pk_bf16_f32 v9, v110, v111
  v_lshlrev_b32 v110, 16, v9
  v_and_b32 v111, s40, v9
  v_lshlrev_b32 v112, 16, v56
  v_lshlrev_b32 v113, 16, v57
  v_lshlrev_b32 v114, 16, v58
  v_lshlrev_b32 v115, 16, v59
  v_mul_f32 v112, s66, v112
  v_mul_f32 v113, s67, v113
  v_cvt_pk_bf16_f32 v9, v112, v113
  v_lshlrev_b32 v112, 16, v9
  v_and_b32 v113, s40, v9
  v_mul_f32 v114, s68, v114
  v_mul_f32 v115, s69, v115
  v_cvt_pk_bf16_f32 v9, v114, v115
  v_lshlrev_b32 v114, 16, v9
  v_and_b32 v115, s40, v9
  v_and_b32 v116, s40, v56
  v_and_b32 v117, s40, v57
  v_and_b32 v118, s40, v58
  v_and_b32 v119, s40, v59
  v_mul_f32 v116, s66, v116
  v_mul_f32 v117, s67, v117
  v_cvt_pk_bf16_f32 v9, v116, v117
  v_lshlrev_b32 v116, 16, v9
  v_and_b32 v117, s40, v9
  v_mul_f32 v118, s68, v118
  v_mul_f32 v119, s69, v119
  v_cvt_pk_bf16_f32 v9, v118, v119
  v_lshlrev_b32 v118, 16, v9
  v_and_b32 v119, s40, v9
  v_lshlrev_b32 v120, 16, v60
  v_lshlrev_b32 v121, 16, v61
  v_lshlrev_b32 v122, 16, v62
  v_lshlrev_b32 v123, 16, v63
  v_mul_f32 v120, s66, v120
  v_mul_f32 v121, s67, v121
  v_cvt_pk_bf16_f32 v9, v120, v121
  v_lshlrev_b32 v120, 16, v9
  v_and_b32 v121, s40, v9
  v_mul_f32 v122, s68, v122
  v_mul_f32 v123, s69, v123
  v_cvt_pk_bf16_f32 v9, v122, v123
  v_lshlrev_b32 v122, 16, v9
  v_and_b32 v123, s40, v9
  v_and_b32 v124, s40, v60
  v_and_b32 v125, s40, v61
  v_and_b32 v126, s40, v62
  v_and_b32 v127, s40, v63
  v_mul_f32 v124, s66, v124
  v_mul_f32 v125, s67, v125
  v_cvt_pk_bf16_f32 v9, v124, v125
  v_lshlrev_b32 v124, 16, v9
  v_and_b32 v125, s40, v9
  v_mul_f32 v126, s68, v126
  v_mul_f32 v127, s69, v127
  v_cvt_pk_bf16_f32 v9, v126, v127
  v_lshlrev_b32 v126, 16, v9
  v_and_b32 v127, s40, v9
  s_lshr_b32 s64, s4, 2
  s_mul_i32 s64, s64, 16640
  s_add_u32 s64, s64, 12587008
  s_cmp_ge_u32 s2, 120
  s_cbranch_scc1 F_np
  s_lshl_b32 s75, s2, 2
  s_add_u32 s75, s75, s58
  s_add_u32 s75, s75, 0
  s_mov_b32 s46, 1966080
  s_mov_b32 s47, 0x00020000
  s_cmp_lt_u32 s75, 240
  s_cbranch_scc0 F_c4
  s_mov_b32 s44, s52
  s_mov_b32 s45, s53
  s_mov_b32 s8, 28311552
  s_movk_i32 s6, 3072
  s_mov_b32 s12, 0
  s_movk_i32 s13, 2731
  s_mov_b32 s15, 24
  s_mov_b32 s9, 122880
  s_movk_i32 s10, 1024
  s_movk_i32 s7, 24576
  s_movk_i32 s41, 6144
  s_mov_b32 s42, 6
  s_movk_i32 s43, 171
  s_branch F_cgo
F_c4:
  s_mov_b32 s44, s54
  s_mov_b32 s45, s55
  s_sub_u32 s75, s75, 240
  s_mov_b32 s8, 30408704
  s_movk_i32 s6, 1280
  s_mov_b32 s12, 1
  s_movk_i32 s13, 6554
  s_mov_b32 s15, 10
  s_mov_b32 s9, 245760
  s_movk_i32 s10, 4096
  s_movk_i32 s7, 20480
  s_movk_i32 s41, 1024
  s_mov_b32 s42, 5
  s_movk_i32 s43, 205
F_cgo:
  s_mul_i32 s11, s75, s13
  s_lshr_b32 s11, s11, 16
  s_mul_i32 s13, s11, s15
  s_sub_u32 s5, s75, s13
  s_lshl_b32 s72, s58, 13
  s_add_u32 s72, s72, 101376
  v_lshrrev_b32 v244, 3, v2
  v_mul_lo_u32 v244, s6, v244
  v_and_b32 v245, 7, v2
  v_lshl_add_u32 v244, v245, 4, v244
  s_lshl_b32 s13, s6, 3
  s_lshl_b32 s14, s13, 3
  s_mul_i32 s14, s14, s11
  s_lshl_b32 s15, s5, 7
  s_add_u32 s14, s14, s15
  s_add_u32 m0, s72, 0
  s_nop 0
  buffer_load_dwordx4 v244, s[44:47], s14 offen lds
  s_add_u32 s14, s14, s13
  s_add_u32 m0, s72, 1024
  s_nop 0
  buffer_load_dwordx4 v244, s[44:47], s14 offen lds
  s_add_u32 s14, s14, s13
  s_add_u32 m0, s72, 2048
  s_nop 0
  buffer_load_dwordx4 v244, s[44:47], s14 offen lds
  s_add_u32 s14, s14, s13
  s_add_u32 m0, s72, 3072
  s_nop 0
  buffer_load_dwordx4 v244, s[44:47], s14 offen lds
  s_add_u32 s14, s14, s13
  s_add_u32 m0, s72, 4096
  s_nop 0
  buffer_load_dwordx4 v244, s[44:47], s14 offen lds
  s_add_u32 s14, s14, s13
  s_add_u32 m0, s72, 5120
  s_nop 0
  buffer_load_dwordx4 v244, s[44:47], s14 offen lds
  s_add_u32 s14, s14, s13
  s_add_u32 m0, s72, 6144
  s_nop 0
  buffer_load_dwordx4 v244, s[44:47], s14 offen lds
  s_add_u32 s14, s14, s13
  s_add_u32 m0, s72, 7168
  s_nop 0
  buffer_load_dwordx4 v244, s[44:47], s14 offen lds
  v_lshrrev_b32 v245, 4, v2
  v_bfe_u32 v246, v2, 2, 2
  v_lshl_add_u32 v245, v245, 3, v246
  v_lshlrev_b32 v245, 7, v245
  v_and_b32 v246, 3, v2
  v_lshl_add_u32 v245, v246, 4, v245
  v_add_u32 v245, s72, v245
  v_lshlrev_b32 v246, 4, v2
  v_add_u32 v247, s41, v246
  s_lshr_b32 s14, s11, 1
  s_mul_i32 s14, s14, s7
  s_and_b32 s15, s11, 1
  s_mul_i32 s15, s15, s41
  s_lshl_b32 s15, s15, 1
  s_add_u32 s14, s14, s15
  s_add_u32 s14, s14, s8
  s_lshl_b32 s15, s5, 2
  s_add_u32 s15, s15, 0
  s_mul_i32 s13, s15, s43
  s_lshr_b32 s13, s13, 10
  s_mul_i32 s66, s13, s42
  s_sub_u32 s15, s15, s66
  s_and_b32 s66, s13, s12
  s_sub_u32 s15, s15, s66
  s_cmp_lt_i32 s15, 0
  s_cselect_b32 s15, 4, s15
  s_mul_i32 s13, s13, s9
  s_mul_i32 s15, s15, s10
  s_add_u32 s66, s15, s13
  s_add_u32 s66, s66, s14
  s_lshl_b32 s15, s5, 2
  s_add_u32 s15, s15, 1
  s_mul_i32 s13, s15, s43
  s_lshr_b32 s13, s13, 10
  s_mul_i32 s67, s13, s42
  s_sub_u32 s15, s15, s67
  s_and_b32 s67, s13, s12
  s_sub_u32 s15, s15, s67
  s_cmp_lt_i32 s15, 0
  s_cselect_b32 s15, 4, s15
  s_mul_i32 s13, s13, s9
  s_mul_i32 s15, s15, s10
  s_add_u32 s67, s15, s13
  s_add_u32 s67, s67, s14
  s_lshl_b32 s15, s5, 2
  s_add_u32 s15, s15, 2
  s_mul_i32 s13, s15, s43
  s_lshr_b32 s13, s13, 10
  s_mul_i32 s68, s13, s42
  s_sub_u32 s15, s15, s68
  s_and_b32 s68, s13, s12
  s_sub_u32 s15, s15, s68
  s_cmp_lt_i32 s15, 0
  s_cselect_b32 s15, 4, s15
  s_mul_i32 s13, s13, s9
  s_mul_i32 s15, s15, s10
  s_add_u32 s68, s15, s13
  s_add_u32 s68, s68, s14
  s_lshl_b32 s15, s5, 2
  s_add_u32 s15, s15, 3
  s_mul_i32 s13, s15, s43
  s_lshr_b32 s13, s13, 10
  s_mul_i32 s69, s13, s42
  s_sub_u32 s15, s15, s69
  s_and_b32 s69, s13, s12
  s_sub_u32 s15, s15, s69
  s_cmp_lt_i32 s15, 0
  s_cselect_b32 s15, 4, s15
  s_mul_i32 s13, s13, s9
  s_mul_i32 s15, s15, s10
  s_add_u32 s69, s15, s13
  s_add_u32 s69, s69, s14
  s_waitcnt vmcnt(0)
  ds_read_b64_tr_b16 v[144:145], v245 offset:0
  ds_read_b64_tr_b16 v[146:147], v245 offset:512
  ds_read_b64_tr_b16 v[148:149], v245 offset:4096
  ds_read_b64_tr_b16 v[150:151], v245 offset:4608
  ds_read_b64_tr_b16 v[152:153], v245 offset:8
  ds_read_b64_tr_b16 v[154:155], v245 offset:520
  ds_read_b64_tr_b16 v[156:157], v245 offset:4104
  ds_read_b64_tr_b16 v[158:159], v245 offset:4616
  ds_read_b64_tr_b16 v[160:161], v245 offset:64
  ds_read_b64_tr_b16 v[162:163], v245 offset:576
  ds_read_b64_tr_b16 v[164:165], v245 offset:4160
  ds_read_b64_tr_b16 v[166:167], v245 offset:4672
  ds_read_b64_tr_b16 v[168:169], v245 offset:72
  ds_read_b64_tr_b16 v[170:171], v245 offset:584
  ds_read_b64_tr_b16 v[172:173], v245 offset:4168
  ds_read_b64_tr_b16 v[174:175], v245 offset:4680
  s_waitcnt lgkmcnt(14)
  buffer_store_dwordx4 v[144:147], v246, s[36:39], s66 offen sc1
  s_waitcnt lgkmcnt(12)
  buffer_store_dwordx4 v[148:151], v247, s[36:39], s66 offen sc1
  s_waitcnt lgkmcnt(10)
  buffer_store_dwordx4 v[152:155], v246, s[36:39], s67 offen sc1
  s_waitcnt lgkmcnt(8)
  buffer_store_dwordx4 v[156:159], v247, s[36:39], s67 offen sc1
  s_waitcnt lgkmcnt(6)
  buffer_store_dwordx4 v[160:163], v246, s[36:39], s68 offen sc1
  s_waitcnt lgkmcnt(4)
  buffer_store_dwordx4 v[164:167], v247, s[36:39], s68 offen sc1
  s_waitcnt lgkmcnt(2)
  buffer_store_dwordx4 v[168:171], v246, s[36:39], s69 offen sc1
  s_waitcnt lgkmcnt(0)
  buffer_store_dwordx4 v[172:175], v247, s[36:39], s69 offen sc1
F_np:
  s_barrier
  ds_read_b32 v48, v5 offset:0
  ds_read_b32 v49, v5 offset:4096
  ds_read_b32 v50, v5 offset:8192
  ds_read_b32 v51, v5 offset:12288
  ds_read_b32 v52, v5 offset:1024
  ds_read_b32 v53, v5 offset:5120
  ds_read_b32 v54, v5 offset:9216
  ds_read_b32 v55, v5 offset:13312
  ds_read_b32 v56, v5 offset:2048
  ds_read_b32 v57, v5 offset:6144
  ds_read_b32 v58, v5 offset:10240
  ds_read_b32 v59, v5 offset:14336
  ds_read_b32 v60, v5 offset:3072
  ds_read_b32 v61, v5 offset:7168
  ds_read_b32 v62, v5 offset:11264
  ds_read_b32 v63, v5 offset:15360
  s_waitcnt lgkmcnt(12)
  v_lshlrev_b32 v128, 16, v48
  v_lshlrev_b32 v129, 16, v49
  v_lshlrev_b32 v130, 16, v50
  v_lshlrev_b32 v131, 16, v51
  v_pk_add_f32 v[128:129], v[128:129], v[96:97]
  v_cvt_pk_bf16_f32 v9, v128, v129
  v_lshlrev_b32 v128, 16, v9
  v_and_b32 v129, s40, v9
  v_pk_add_f32 v[128:129], v[128:129], v[64:65]
  v_cvt_pk_bf16_f32 v136, v128, v129
  v_pk_add_f32 v[130:131], v[130:131], v[98:99]
  v_cvt_pk_bf16_f32 v9, v130, v131
  v_lshlrev_b32 v130, 16, v9
  v_and_b32 v131, s40, v9
  v_pk_add_f32 v[130:131], v[130:131], v[66:67]
  v_cvt_pk_bf16_f32 v137, v130, v131
  v_and_b32 v132, s40, v48
  v_and_b32 v133, s40, v49
  v_and_b32 v134, s40, v50
  v_and_b32 v135, s40, v51
  v_pk_add_f32 v[132:133], v[132:133], v[100:101]
  v_cvt_pk_bf16_f32 v9, v132, v133
  v_lshlrev_b32 v132, 16, v9
  v_and_b32 v133, s40, v9
  v_pk_add_f32 v[132:133], v[132:133], v[68:69]
  v_cvt_pk_bf16_f32 v138, v132, v133
  v_pk_add_f32 v[134:135], v[134:135], v[102:103]
  v_cvt_pk_bf16_f32 v9, v134, v135
  v_lshlrev_b32 v134, 16, v9
  v_and_b32 v135, s40, v9
  v_pk_add_f32 v[134:135], v[134:135], v[70:71]
  v_cvt_pk_bf16_f32 v139, v134, v135
  buffer_store_dwordx4 v[136:139], v4, s[36:39], s64 offen sc1
  s_add_u32 s64, s64, 4096
  s_waitcnt lgkmcnt(8)
  v_lshlrev_b32 v128, 16, v52
  v_lshlrev_b32 v129, 16, v53
  v_lshlrev_b32 v130, 16, v54
  v_lshlrev_b32 v131, 16, v55
  v_pk_add_f32 v[128:129], v[128:129], v[104:105]
  v_cvt_pk_bf16_f32 v9, v128, v129
  v_lshlrev_b32 v128, 16, v9
  v_and_b32 v129, s40, v9
  v_pk_add_f32 v[128:129], v[128:129], v[72:73]
  v_cvt_pk_bf16_f32 v140, v128, v129
  v_pk_add_f32 v[130:131], v[130:131], v[106:107]
  v_cvt_pk_bf16_f32 v9, v130, v131
  v_lshlrev_b32 v130, 16, v9
  v_and_b32 v131, s40, v9
  v_pk_add_f32 v[130:131], v[130:131], v[74:75]
  v_cvt_pk_bf16_f32 v141, v130, v131
  v_and_b32 v132, s40, v52
  v_and_b32 v133, s40, v53
  v_and_b32 v134, s40, v54
  v_and_b32 v135, s40, v55
  v_pk_add_f32 v[132:133], v[132:133], v[108:109]
  v_cvt_pk_bf16_f32 v9, v132, v133
  v_lshlrev_b32 v132, 16, v9
  v_and_b32 v133, s40, v9
  v_pk_add_f32 v[132:133], v[132:133], v[76:77]
  v_cvt_pk_bf16_f32 v142, v132, v133
  v_pk_add_f32 v[134:135], v[134:135], v[110:111]
  v_cvt_pk_bf16_f32 v9, v134, v135
  v_lshlrev_b32 v134, 16, v9
  v_and_b32 v135, s40, v9
  v_pk_add_f32 v[134:135], v[134:135], v[78:79]
  v_cvt_pk_bf16_f32 v143, v134, v135
  buffer_store_dwordx4 v[140:143], v4, s[36:39], s64 offen sc1
  s_add_u32 s64, s64, 4096
  s_waitcnt lgkmcnt(4)
  v_lshlrev_b32 v128, 16, v56
  v_lshlrev_b32 v129, 16, v57
  v_lshlrev_b32 v130, 16, v58
  v_lshlrev_b32 v131, 16, v59
  v_pk_add_f32 v[128:129], v[128:129], v[112:113]
  v_cvt_pk_bf16_f32 v9, v128, v129
  v_lshlrev_b32 v128, 16, v9
  v_and_b32 v129, s40, v9
  v_pk_add_f32 v[128:129], v[128:129], v[80:81]
  v_cvt_pk_bf16_f32 v144, v128, v129
  v_pk_add_f32 v[130:131], v[130:131], v[114:115]
  v_cvt_pk_bf16_f32 v9, v130, v131
  v_lshlrev_b32 v130, 16, v9
  v_and_b32 v131, s40, v9
  v_pk_add_f32 v[130:131], v[130:131], v[82:83]
  v_cvt_pk_bf16_f32 v145, v130, v131
  v_and_b32 v132, s40, v56
  v_and_b32 v133, s40, v57
  v_and_b32 v134, s40, v58
  v_and_b32 v135, s40, v59
  v_pk_add_f32 v[132:133], v[132:133], v[116:117]
  v_cvt_pk_bf16_f32 v9, v132, v133
  v_lshlrev_b32 v132, 16, v9
  v_and_b32 v133, s40, v9
  v_pk_add_f32 v[132:133], v[132:133], v[84:85]
  v_cvt_pk_bf16_f32 v146, v132, v133
  v_pk_add_f32 v[134:135], v[134:135], v[118:119]
  v_cvt_pk_bf16_f32 v9, v134, v135
  v_lshlrev_b32 v134, 16, v9
  v_and_b32 v135, s40, v9
  v_pk_add_f32 v[134:135], v[134:135], v[86:87]
  v_cvt_pk_bf16_f32 v147, v134, v135
  buffer_store_dwordx4 v[144:147], v4, s[36:39], s64 offen sc1
  s_add_u32 s64, s64, 4096
  s_waitcnt lgkmcnt(0)
  v_lshlrev_b32 v128, 16, v60
  v_lshlrev_b32 v129, 16, v61
  v_lshlrev_b32 v130, 16, v62
  v_lshlrev_b32 v131, 16, v63
  v_pk_add_f32 v[128:129], v[128:129], v[120:121]
  v_cvt_pk_bf16_f32 v9, v128, v129
  v_lshlrev_b32 v128, 16, v9
  v_and_b32 v129, s40, v9
  v_pk_add_f32 v[128:129], v[128:129], v[88:89]
  v_cvt_pk_bf16_f32 v148, v128, v129
  v_pk_add_f32 v[130:131], v[130:131], v[122:123]
  v_cvt_pk_bf16_f32 v9, v130, v131
  v_lshlrev_b32 v130, 16, v9
  v_and_b32 v131, s40, v9
  v_pk_add_f32 v[130:131], v[130:131], v[90:91]
  v_cvt_pk_bf16_f32 v149, v130, v131
  v_and_b32 v132, s40, v60
  v_and_b32 v133, s40, v61
  v_and_b32 v134, s40, v62
  v_and_b32 v135, s40, v63
  v_pk_add_f32 v[132:133], v[132:133], v[124:125]
  v_cvt_pk_bf16_f32 v9, v132, v133
  v_lshlrev_b32 v132, 16, v9
  v_and_b32 v133, s40, v9
  v_pk_add_f32 v[132:133], v[132:133], v[92:93]
  v_cvt_pk_bf16_f32 v150, v132, v133
  v_pk_add_f32 v[134:135], v[134:135], v[126:127]
  v_cvt_pk_bf16_f32 v9, v134, v135
  v_lshlrev_b32 v134, 16, v9
  v_and_b32 v135, s40, v9
  v_pk_add_f32 v[134:135], v[134:135], v[94:95]
  v_cvt_pk_bf16_f32 v151, v134, v135
  buffer_store_dwordx4 v[148:151], v4, s[36:39], s64 offen sc1
  s_add_u32 s64, s64, 4096
  v_mov_b32 v248, 143360
  v_mov_b32 v244, 0
  v_mov_b32 v245, 0
  v_mov_b32 v246, 0
  v_mov_b32 v247, 0
  ds_write_b128 v248, v[244:247]
  ds_write_b128 v248, v[244:247] offset:16
  s_waitcnt vmcnt(0) lgkmcnt(0)
  s_barrier
  s_branch F_fin
F_aux:
  s_mov_b32 s71, 0
  s_cmp_lt_u32 s2, 248
  s_cbranch_scc1 F_ncw
  s_getpc_b64 s[8:9]
F_pc2:
  s_sub_u32 s8, s8, F_pc2-sequential_preLN__ssm_conv_s4__mixer_s_mlp__prompt_kernel
  s_subb_u32 s9, s9, 0
  v_lshlrev_b32 v10, 7, v0
  s_mov_b32 s10, F_tab-sequential_preLN__ssm_conv_s4__mixer_s_mlp__prompt_kernel
  v_min_u32 v10, s10, v10
  global_load_dword v11, v10, s[8:9]
F_ncw:
  s_sub_u32 s72, s2, 160
  s_cmp_ge_u32 s72, 64
  s_cbranch_scc1 F_pk0
  s_and_b32 s5, s72, 7
  s_lshl_b32 s5, s5, 3
  s_lshr_b32 s4, s72, 3
  s_add_u32 s4, s4, s5
  v_lshrrev_b32 v4, 4, v0
  v_and_b32 v5, 15, v0
  v_mul_u32_u24 v6, 1280, v4
  v_lshl_add_u32 v6, v5, 4, v6
  s_mul_i32 s5, s4, 40960
  v_add_u32 v6, s5, v6
  s_waitcnt lgkmcnt(0)
  s_mov_b64 s[36:37], s[34:35]
  s_mov_b64 s[34:35], s[32:33]
  s_mov_b64 s[32:33], s[36:37]
  s_mov_b32 s38, 33554432
  s_mov_b32 s39, 0x00020000
  global_load_dwordx4 v[12:15], v6, s[16:17] offset:0
  global_load_dwordx4 v[16:19], v6, s[16:17] offset:256
  global_load_dwordx4 v[20:23], v6, s[16:17] offset:512
  global_load_dwordx4 v[24:27], v6, s[16:17] offset:768
  global_load_dwordx4 v[28:31], v6, s[16:17] offset:1024
  s_mov_b64 exec, 1
  buffer_load_dword v255, v254, s[36:39], 0 offen sc1
  s_mov_b64 exec, -1
  s_lshl_b32 s5, s4, 8
  s_add_u32 s5, s5, 32636928
  v_lshlrev_b32 v7, 3, v4
  v_lshlrev_b32 v8, 3, v2
  s_waitcnt vmcnt(5)
  v_lshlrev_b32 v32, 16, v12
  v_and_b32 v33, s40, v12
  v_lshlrev_b32 v34, 16, v13
  v_and_b32 v35, s40, v13
  v_lshlrev_b32 v36, 16, v14
  v_and_b32 v37, s40, v14
  v_lshlrev_b32 v38, 16, v15
  v_and_b32 v39, s40, v15
  s_waitcnt vmcnt(4)
  v_lshlrev_b32 v40, 16, v16
  v_and_b32 v41, s40, v16
  v_lshlrev_b32 v42, 16, v17
  v_and_b32 v43, s40, v17
  v_lshlrev_b32 v44, 16, v18
  v_and_b32 v45, s40, v18
  v_lshlrev_b32 v46, 16, v19
  v_and_b32 v47, s40, v19
  s_waitcnt vmcnt(3)
  v_lshlrev_b32 v48, 16, v20
  v_and_b32 v49, s40, v20
  v_lshlrev_b32 v50, 16, v21
  v_and_b32 v51, s40, v21
  v_lshlrev_b32 v52, 16, v22
  v_and_b32 v53, s40, v22
  v_lshlrev_b32 v54, 16, v23
  v_and_b32 v55, s40, v23
  s_waitcnt vmcnt(2)
  v_lshlrev_b32 v56, 16, v24
  v_and_b32 v57, s40, v24
  v_lshlrev_b32 v58, 16, v25
  v_and_b32 v59, s40, v25
  v_lshlrev_b32 v60, 16, v26
  v_and_b32 v61, s40, v26
  v_lshlrev_b32 v62, 16, v27
  v_and_b32 v63, s40, v27
  s_waitcnt vmcnt(1)
  v_lshlrev_b32 v64, 16, v28
  v_and_b32 v65, s40, v28
  v_lshlrev_b32 v66, 16, v29
  v_and_b32 v67, s40, v29
  v_lshlrev_b32 v68, 16, v30
  v_and_b32 v69, s40, v30
  v_lshlrev_b32 v70, 16, v31
  v_and_b32 v71, s40, v31
  v_pk_add_f32 v[72:73], v[32:33], v[34:35]
  v_pk_add_f32 v[72:73], v[72:73], v[36:37]
  v_pk_add_f32 v[72:73], v[72:73], v[38:39]
  v_pk_add_f32 v[72:73], v[72:73], v[40:41]
  v_pk_add_f32 v[72:73], v[72:73], v[42:43]
  v_pk_add_f32 v[72:73], v[72:73], v[44:45]
  v_pk_add_f32 v[72:73], v[72:73], v[46:47]
  v_pk_add_f32 v[72:73], v[72:73], v[48:49]
  v_pk_add_f32 v[72:73], v[72:73], v[50:51]
  v_pk_add_f32 v[72:73], v[72:73], v[52:53]
  v_pk_add_f32 v[72:73], v[72:73], v[54:55]
  v_pk_add_f32 v[72:73], v[72:73], v[56:57]
  v_pk_add_f32 v[72:73], v[72:73], v[58:59]
  v_pk_add_f32 v[72:73], v[72:73], v[60:61]
  v_pk_add_f32 v[72:73], v[72:73], v[62:63]
  v_pk_add_f32 v[72:73], v[72:73], v[64:65]
  v_pk_add_f32 v[72:73], v[72:73], v[66:67]
  v_pk_add_f32 v[72:73], v[72:73], v[68:69]
  v_pk_add_f32 v[72:73], v[72:73], v[70:71]
  v_add_f32 v72, v72, v73
  s_nop 1
  v_add_f32_dpp v72, v72, v72 row_ror:8 row_mask:0xf bank_mask:0xf
  s_nop 1
  v_add_f32_dpp v72, v72, v72 row_ror:4 row_mask:0xf bank_mask:0xf
  s_nop 1
  v_add_f32_dpp v72, v72, v72 row_ror:2 row_mask:0xf bank_mask:0xf
  s_nop 1
  v_add_f32_dpp v72, v72, v72 row_ror:1 row_mask:0xf bank_mask:0xf
  v_mul_f32 v72, 0x3acccccd, v72
  v_mov_b32 v73, v72
  v_mov_b32 v74, 0
  v_mov_b32 v75, 0
  v_pk_add_f32 v[76:77], v[32:33], v[72:73] neg_lo:[0,1] neg_hi:[0,1]
  v_pk_fma_f32 v[74:75], v[76:77], v[76:77], v[74:75]
  v_pk_add_f32 v[76:77], v[34:35], v[72:73] neg_lo:[0,1] neg_hi:[0,1]
  v_pk_fma_f32 v[74:75], v[76:77], v[76:77], v[74:75]
  v_pk_add_f32 v[76:77], v[36:37], v[72:73] neg_lo:[0,1] neg_hi:[0,1]
  v_pk_fma_f32 v[74:75], v[76:77], v[76:77], v[74:75]
  v_pk_add_f32 v[76:77], v[38:39], v[72:73] neg_lo:[0,1] neg_hi:[0,1]
  v_pk_fma_f32 v[74:75], v[76:77], v[76:77], v[74:75]
  v_pk_add_f32 v[76:77], v[40:41], v[72:73] neg_lo:[0,1] neg_hi:[0,1]
  v_pk_fma_f32 v[74:75], v[76:77], v[76:77], v[74:75]
  v_pk_add_f32 v[76:77], v[42:43], v[72:73] neg_lo:[0,1] neg_hi:[0,1]
  v_pk_fma_f32 v[74:75], v[76:77], v[76:77], v[74:75]
  v_pk_add_f32 v[76:77], v[44:45], v[72:73] neg_lo:[0,1] neg_hi:[0,1]
  v_pk_fma_f32 v[74:75], v[76:77], v[76:77], v[74:75]
  v_pk_add_f32 v[76:77], v[46:47], v[72:73] neg_lo:[0,1] neg_hi:[0,1]
  v_pk_fma_f32 v[74:75], v[76:77], v[76:77], v[74:75]
  v_pk_add_f32 v[76:77], v[48:49], v[72:73] neg_lo:[0,1] neg_hi:[0,1]
  v_pk_fma_f32 v[74:75], v[76:77], v[76:77], v[74:75]
  v_pk_add_f32 v[76:77], v[50:51], v[72:73] neg_lo:[0,1] neg_hi:[0,1]
  v_pk_fma_f32 v[74:75], v[76:77], v[76:77], v[74:75]
  v_pk_add_f32 v[76:77], v[52:53], v[72:73] neg_lo:[0,1] neg_hi:[0,1]
  v_pk_fma_f32 v[74:75], v[76:77], v[76:77], v[74:75]
  v_pk_add_f32 v[76:77], v[54:55], v[72:73] neg_lo:[0,1] neg_hi:[0,1]
  v_pk_fma_f32 v[74:75], v[76:77], v[76:77], v[74:75]
  v_pk_add_f32 v[76:77], v[56:57], v[72:73] neg_lo:[0,1] neg_hi:[0,1]
  v_pk_fma_f32 v[74:75], v[76:77], v[76:77], v[74:75]
  v_pk_add_f32 v[76:77], v[58:59], v[72:73] neg_lo:[0,1] neg_hi:[0,1]
  v_pk_fma_f32 v[74:75], v[76:77], v[76:77], v[74:75]
  v_pk_add_f32 v[76:77], v[60:61], v[72:73] neg_lo:[0,1] neg_hi:[0,1]
  v_pk_fma_f32 v[74:75], v[76:77], v[76:77], v[74:75]
  v_pk_add_f32 v[76:77], v[62:63], v[72:73] neg_lo:[0,1] neg_hi:[0,1]
  v_pk_fma_f32 v[74:75], v[76:77], v[76:77], v[74:75]
  v_pk_add_f32 v[76:77], v[64:65], v[72:73] neg_lo:[0,1] neg_hi:[0,1]
  v_pk_fma_f32 v[74:75], v[76:77], v[76:77], v[74:75]
  v_pk_add_f32 v[76:77], v[66:67], v[72:73] neg_lo:[0,1] neg_hi:[0,1]
  v_pk_fma_f32 v[74:75], v[76:77], v[76:77], v[74:75]
  v_pk_add_f32 v[76:77], v[68:69], v[72:73] neg_lo:[0,1] neg_hi:[0,1]
  v_pk_fma_f32 v[74:75], v[76:77], v[76:77], v[74:75]
  v_pk_add_f32 v[76:77], v[70:71], v[72:73] neg_lo:[0,1] neg_hi:[0,1]
  v_pk_fma_f32 v[74:75], v[76:77], v[76:77], v[74:75]
  v_add_f32 v74, v74, v75
  s_nop 1
  v_add_f32_dpp v74, v74, v74 row_ror:8 row_mask:0xf bank_mask:0xf
  s_nop 1
  v_add_f32_dpp v74, v74, v74 row_ror:4 row_mask:0xf bank_mask:0xf
  s_nop 1
  v_add_f32_dpp v74, v74, v74 row_ror:2 row_mask:0xf bank_mask:0xf
  s_nop 1
  v_add_f32_dpp v74, v74, v74 row_ror:1 row_mask:0xf bank_mask:0xf
  v_mul_f32 v74, 0x3acccccd, v74
  v_cvt_pk_bf16_f32 v76, v72, v74
  v_lshlrev_b32 v72, 16, v76
  v_and_b32 v74, s40, v76
  v_mov_b32 v73, v72
  v_add_f32 v74, 0x3727c5ac, v74
  v_cvt_pk_bf16_f32 v74, v74, v74
  v_lshlrev_b32 v74, 16, v74
  v_sqrt_f32 v74, v74
  s_nop 0
  v_cvt_pk_bf16_f32 v74, v74, v74
  v_lshlrev_b32 v74, 16, v74
  v_rcp_f32 v73, v74
  s_nop 0
  ds_write_b64 v7, v[72:73]
  s_waitcnt lgkmcnt(0)
  s_barrier
  s_cmp_lg_u32 s3, 0
  s_cbranch_scc1 F_ln2
  s_mov_b32 exec_hi, 0
  ds_read_b64 v[72:73], v8
  s_waitcnt lgkmcnt(0)
  buffer_store_dwordx2 v[72:73], v8, s[36:39], s5 offen sc1
  s_mov_b64 exec, -1
F_ln2:
  s_waitcnt vmcnt(0)
  s_barrier
  s_cmp_lg_u32 s3, 0
  s_cbranch_scc1 F_ln3
  v_mov_b32 v250, 0
  v_mov_b32 v251, 1
  s_mov_b64 exec, 1
  global_atomic_add v250, v251, s[34:35] sc1
  s_mov_b64 exec, -1
F_ln3:
  s_add_u32 s75, s72, 7
  s_branch F_cs
F_pk0:
  s_waitcnt lgkmcnt(0)
  s_mov_b64 s[36:37], s[34:35]
  s_mov_b64 s[34:35], s[32:33]
  s_mov_b64 s[32:33], s[36:37]
  s_mov_b32 s38, 33554432
  s_mov_b32 s39, 0x00020000
  s_mov_b64 exec, 1
  buffer_load_dword v255, v254, s[36:39], 0 offen sc1
  s_mov_b64 exec, -1
  s_sub_u32 s73, s72, 64
  s_sub_u32 s75, s73, 25
  s_cmp_ge_u32 s73, 25
  s_cbranch_scc1 F_cs
  s_lshl_b32 s4, s73, 3
  s_add_u32 s4, s4, s3
  s_mov_b32 s44, s48
  s_mov_b32 s45, s49
  s_mov_b32 s46, 819200
  s_mov_b32 s47, 0x00020000
  s_mov_b32 s8, 26214400
  s_movk_i32 s6, 1280
  s_mov_b32 s12, 1
  s_mov_b32 s9, 102400
  s_movk_i32 s10, 1024
  s_movk_i32 s7, 20480
  s_movk_i32 s41, 5120
  s_mov_b32 s42, 5
  s_movk_i32 s43, 205
  s_cmp_lt_u32 s4, 100
  s_cbranch_scc1 F_go
  s_mov_b32 s44, s50
  s_mov_b32 s45, s51
  s_sub_u32 s4, s4, 100
  s_mov_b32 s8, 27262976
F_go:
  s_mul_i32 s11, s4, 6554
  s_lshr_b32 s11, s11, 16
  s_mul_i32 s13, s11, 10
  s_sub_u32 s5, s4, s13
F_go2:
  s_lshl_b32 s74, s3, 13
  v_lshrrev_b32 v6, 3, v2
  v_mul_lo_u32 v6, s6, v6
  v_and_b32 v4, 7, v2
  v_lshl_add_u32 v6, v4, 4, v6
  s_lshl_b32 s13, s6, 3
  s_lshl_b32 s14, s13, 3
  s_mul_i32 s14, s14, s11
  s_lshl_b32 s15, s5, 7
  s_add_u32 s14, s14, s15
  s_add_u32 m0, s74, 0
  s_nop 0
  buffer_load_dwordx4 v6, s[44:47], s14 offen lds
  s_add_u32 s14, s14, s13
  s_add_u32 m0, s74, 1024
  s_nop 0
  buffer_load_dwordx4 v6, s[44:47], s14 offen lds
  s_add_u32 s14, s14, s13
  s_add_u32 m0, s74, 2048
  s_nop 0
  buffer_load_dwordx4 v6, s[44:47], s14 offen lds
  s_add_u32 s14, s14, s13
  s_add_u32 m0, s74, 3072
  s_nop 0
  buffer_load_dwordx4 v6, s[44:47], s14 offen lds
  s_add_u32 s14, s14, s13
  s_add_u32 m0, s74, 4096
  s_nop 0
  buffer_load_dwordx4 v6, s[44:47], s14 offen lds
  s_add_u32 s14, s14, s13
  s_add_u32 m0, s74, 5120
  s_nop 0
  buffer_load_dwordx4 v6, s[44:47], s14 offen lds
  s_add_u32 s14, s14, s13
  s_add_u32 m0, s74, 6144
  s_nop 0
  buffer_load_dwordx4 v6, s[44:47], s14 offen lds
  s_add_u32 s14, s14, s13
  s_add_u32 m0, s74, 7168
  s_nop 0
  buffer_load_dwordx4 v6, s[44:47], s14 offen lds
  v_lshrrev_b32 v4, 4, v2
  v_bfe_u32 v5, v2, 2, 2
  v_lshl_add_u32 v4, v4, 3, v5
  v_lshlrev_b32 v4, 7, v4
  v_and_b32 v5, 3, v2
  v_lshl_add_u32 v4, v5, 4, v4
  v_add_u32 v4, s74, v4
  v_lshlrev_b32 v5, 4, v2
  v_add_u32 v7, s41, v5
  s_lshr_b32 s14, s11, 1
  s_mul_i32 s14, s14, s7
  s_and_b32 s15, s11, 1
  s_mul_i32 s15, s15, s41
  s_lshl_b32 s15, s15, 1
  s_add_u32 s14, s14, s15
  s_add_u32 s14, s14, s8
  s_lshl_b32 s15, s5, 2
  s_add_u32 s15, s15, 0
  s_mul_i32 s13, s15, s43
  s_lshr_b32 s13, s13, 10
  s_mul_i32 s56, s13, s42
  s_sub_u32 s15, s15, s56
  s_and_b32 s56, s13, s12
  s_sub_u32 s15, s15, s56
  s_cmp_lt_i32 s15, 0
  s_cselect_b32 s15, 4, s15
  s_mul_i32 s13, s13, s9
  s_mul_i32 s15, s15, s10
  s_add_u32 s56, s15, s13
  s_add_u32 s56, s56, s14
  s_lshl_b32 s15, s5, 2
  s_add_u32 s15, s15, 1
  s_mul_i32 s13, s15, s43
  s_lshr_b32 s13, s13, 10
  s_mul_i32 s57, s13, s42
  s_sub_u32 s15, s15, s57
  s_and_b32 s57, s13, s12
  s_sub_u32 s15, s15, s57
  s_cmp_lt_i32 s15, 0
  s_cselect_b32 s15, 4, s15
  s_mul_i32 s13, s13, s9
  s_mul_i32 s15, s15, s10
  s_add_u32 s57, s15, s13
  s_add_u32 s57, s57, s14
  s_lshl_b32 s15, s5, 2
  s_add_u32 s15, s15, 2
  s_mul_i32 s13, s15, s43
  s_lshr_b32 s13, s13, 10
  s_mul_i32 s58, s13, s42
  s_sub_u32 s15, s15, s58
  s_and_b32 s58, s13, s12
  s_sub_u32 s15, s15, s58
  s_cmp_lt_i32 s15, 0
  s_cselect_b32 s15, 4, s15
  s_mul_i32 s13, s13, s9
  s_mul_i32 s15, s15, s10
  s_add_u32 s58, s15, s13
  s_add_u32 s58, s58, s14
  s_lshl_b32 s15, s5, 2
  s_add_u32 s15, s15, 3
  s_mul_i32 s13, s15, s43
  s_lshr_b32 s13, s13, 10
  s_mul_i32 s59, s13, s42
  s_sub_u32 s15, s15, s59
  s_and_b32 s59, s13, s12
  s_sub_u32 s15, s15, s59
  s_cmp_lt_i32 s15, 0
  s_cselect_b32 s15, 4, s15
  s_mul_i32 s13, s13, s9
  s_mul_i32 s15, s15, s10
  s_add_u32 s59, s15, s13
  s_add_u32 s59, s59, s14
  s_waitcnt vmcnt(0)
  ds_read_b64_tr_b16 v[16:17], v4 offset:0
  ds_read_b64_tr_b16 v[18:19], v4 offset:512
  ds_read_b64_tr_b16 v[20:21], v4 offset:4096
  ds_read_b64_tr_b16 v[22:23], v4 offset:4608
  ds_read_b64_tr_b16 v[24:25], v4 offset:8
  ds_read_b64_tr_b16 v[26:27], v4 offset:520
  ds_read_b64_tr_b16 v[28:29], v4 offset:4104
  ds_read_b64_tr_b16 v[30:31], v4 offset:4616
  ds_read_b64_tr_b16 v[32:33], v4 offset:64
  ds_read_b64_tr_b16 v[34:35], v4 offset:576
  ds_read_b64_tr_b16 v[36:37], v4 offset:4160
  ds_read_b64_tr_b16 v[38:39], v4 offset:4672
  ds_read_b64_tr_b16 v[40:41], v4 offset:72
  ds_read_b64_tr_b16 v[42:43], v4 offset:584
  ds_read_b64_tr_b16 v[44:45], v4 offset:4168
  ds_read_b64_tr_b16 v[46:47], v4 offset:4680
  s_waitcnt lgkmcnt(14)
  buffer_store_dwordx4 v[16:19], v5, s[36:39], s56 offen sc1
  s_waitcnt lgkmcnt(12)
  buffer_store_dwordx4 v[20:23], v7, s[36:39], s56 offen sc1
  s_waitcnt lgkmcnt(10)
  buffer_store_dwordx4 v[24:27], v5, s[36:39], s57 offen sc1
  s_waitcnt lgkmcnt(8)
  buffer_store_dwordx4 v[28:31], v7, s[36:39], s57 offen sc1
  s_waitcnt lgkmcnt(6)
  buffer_store_dwordx4 v[32:35], v5, s[36:39], s58 offen sc1
  s_waitcnt lgkmcnt(4)
  buffer_store_dwordx4 v[36:39], v7, s[36:39], s58 offen sc1
  s_waitcnt lgkmcnt(2)
  buffer_store_dwordx4 v[40:43], v5, s[36:39], s59 offen sc1
  s_waitcnt lgkmcnt(0)
  buffer_store_dwordx4 v[44:47], v7, s[36:39], s59 offen sc1
F_aw:
  s_waitcnt vmcnt(0)
  s_barrier
  s_cmp_lg_u32 s3, 0
  s_cbranch_scc1 F_ax
  v_mov_b32 v250, 192
  v_mov_b32 v251, 1
  s_mov_b64 exec, 1
  global_atomic_add v252, v250, v251, s[34:35] sc0 sc1
  s_waitcnt vmcnt(0)
  v_readfirstlane_b32 s79, v252
  s_mov_b64 exec, -1
  s_cmp_lg_u32 s79, 30
  s_cbranch_scc1 F_ar2
  v_lshlrev_b32 v250, 7, v2
  s_mov_b32 s79, 33161216
  buffer_load_dword v251, v250, s[36:39], s79 offen sc1
  s_waitcnt vmcnt(0)
  v_add_u32 v251, 1, v251
  buffer_store_dword v251, v250, s[36:39], s79 offen sc1
  v_mov_b32 v250, 128
  v_mov_b32 v251, 1
  s_mov_b64 exec, 1
  global_store_dword v250, v251, s[34:35] sc1
  s_mov_b64 exec, -1
F_ar2:
  s_branch F_ax
F_cs:
  s_cmp_lt_u32 s75, 34
  s_cbranch_scc0 F_fl
  s_mov_b32 s4, s75
  s_mov_b32 s44, s48
  s_mov_b32 s45, s49
  s_mov_b32 s46, 819200
  s_mov_b32 s47, 0x00020000
  s_mov_b32 s5, s4
  s_movk_i32 s6, 1280
  s_mov_b32 s11, 32505856
  s_cmp_lt_u32 s4, 10
  s_cbranch_scc1 F_cg
  s_mov_b32 s44, s52
  s_mov_b32 s45, s53
  s_mov_b32 s46, 1966080
  s_sub_u32 s5, s4, 10
  s_movk_i32 s6, 3072
  s_mov_b32 s11, 32571392
F_cg:
  v_lshrrev_b32 v4, 3, v0
  v_and_b32 v5, 7, v2
  v_mul_lo_u32 v6, s6, v4
  s_lshl_b32 s14, s5, 7
  v_lshl_add_u32 v6, v5, 4, v6
  v_add_u32 v6, s14, v6
  s_lshl_b32 s15, s6, 6
  s_mov_b32 s29, 0
  buffer_load_dwordx4 v[32:35], v6, s[44:47], s29 offen
  s_add_u32 s29, s29, s15
  buffer_load_dwordx4 v[36:39], v6, s[44:47], s29 offen
  s_add_u32 s29, s29, s15
  buffer_load_dwordx4 v[40:43], v6, s[44:47], s29 offen
  s_add_u32 s29, s29, s15
  buffer_load_dwordx4 v[44:47], v6, s[44:47], s29 offen
  s_add_u32 s29, s29, s15
  buffer_load_dwordx4 v[48:51], v6, s[44:47], s29 offen
  s_add_u32 s29, s29, s15
  buffer_load_dwordx4 v[52:55], v6, s[44:47], s29 offen
  s_add_u32 s29, s29, s15
  buffer_load_dwordx4 v[56:59], v6, s[44:47], s29 offen
  s_add_u32 s29, s29, s15
  buffer_load_dwordx4 v[60:63], v6, s[44:47], s29 offen
  s_add_u32 s29, s29, s15
  buffer_load_dwordx4 v[64:67], v6, s[44:47], s29 offen
  s_add_u32 s29, s29, s15
  buffer_load_dwordx4 v[68:71], v6, s[44:47], s29 offen
  s_add_u32 s29, s29, s15
  s_mov_b32 s41, 0x00003f80
  s_mov_b32 s42, 0x3f800000
  v_mov_b32 v16, 0
  v_mov_b32 v17, 0
  v_mov_b32 v18, 0
  v_mov_b32 v19, 0
  v_mov_b32 v20, 0
  v_mov_b32 v21, 0
  v_mov_b32 v22, 0
  v_mov_b32 v23, 0
  s_waitcnt vmcnt(9)
  v_dot2_f32_bf16 v16, v32, s41, v16
  v_dot2_f32_bf16 v17, v32, s42, v17
  v_dot2_f32_bf16 v18, v33, s41, v18
  v_dot2_f32_bf16 v19, v33, s42, v19
  v_dot2_f32_bf16 v20, v34, s41, v20
  v_dot2_f32_bf16 v21, v34, s42, v21
  v_dot2_f32_bf16 v22, v35, s41, v22
  v_dot2_f32_bf16 v23, v35, s42, v23
  s_waitcnt vmcnt(8)
  v_dot2_f32_bf16 v16, v36, s41, v16
  v_dot2_f32_bf16 v17, v36, s42, v17
  v_dot2_f32_bf16 v18, v37, s41, v18
  v_dot2_f32_bf16 v19, v37, s42, v19
  v_dot2_f32_bf16 v20, v38, s41, v20
  v_dot2_f32_bf16 v21, v38, s42, v21
  v_dot2_f32_bf16 v22, v39, s41, v22
  v_dot2_f32_bf16 v23, v39, s42, v23
  s_waitcnt vmcnt(7)
  v_dot2_f32_bf16 v16, v40, s41, v16
  v_dot2_f32_bf16 v17, v40, s42, v17
  v_dot2_f32_bf16 v18, v41, s41, v18
  v_dot2_f32_bf16 v19, v41, s42, v19
  v_dot2_f32_bf16 v20, v42, s41, v20
  v_dot2_f32_bf16 v21, v42, s42, v21
  v_dot2_f32_bf16 v22, v43, s41, v22
  v_dot2_f32_bf16 v23, v43, s42, v23
  s_waitcnt vmcnt(6)
  v_dot2_f32_bf16 v16, v44, s41, v16
  v_dot2_f32_bf16 v17, v44, s42, v17
  v_dot2_f32_bf16 v18, v45, s41, v18
  v_dot2_f32_bf16 v19, v45, s42, v19
  v_dot2_f32_bf16 v20, v46, s41, v20
  v_dot2_f32_bf16 v21, v46, s42, v21
  v_dot2_f32_bf16 v22, v47, s41, v22
  v_dot2_f32_bf16 v23, v47, s42, v23
  s_waitcnt vmcnt(5)
  v_dot2_f32_bf16 v16, v48, s41, v16
  v_dot2_f32_bf16 v17, v48, s42, v17
  v_dot2_f32_bf16 v18, v49, s41, v18
  v_dot2_f32_bf16 v19, v49, s42, v19
  v_dot2_f32_bf16 v20, v50, s41, v20
  v_dot2_f32_bf16 v21, v50, s42, v21
  v_dot2_f32_bf16 v22, v51, s41, v22
  v_dot2_f32_bf16 v23, v51, s42, v23
  s_waitcnt vmcnt(4)
  v_dot2_f32_bf16 v16, v52, s41, v16
  v_dot2_f32_bf16 v17, v52, s42, v17
  v_dot2_f32_bf16 v18, v53, s41, v18
  v_dot2_f32_bf16 v19, v53, s42, v19
  v_dot2_f32_bf16 v20, v54, s41, v20
  v_dot2_f32_bf16 v21, v54, s42, v21
  v_dot2_f32_bf16 v22, v55, s41, v22
  v_dot2_f32_bf16 v23, v55, s42, v23
  s_waitcnt vmcnt(3)
  v_dot2_f32_bf16 v16, v56, s41, v16
  v_dot2_f32_bf16 v17, v56, s42, v17
  v_dot2_f32_bf16 v18, v57, s41, v18
  v_dot2_f32_bf16 v19, v57, s42, v19
  v_dot2_f32_bf16 v20, v58, s41, v20
  v_dot2_f32_bf16 v21, v58, s42, v21
  v_dot2_f32_bf16 v22, v59, s41, v22
  v_dot2_f32_bf16 v23, v59, s42, v23
  s_waitcnt vmcnt(2)
  v_dot2_f32_bf16 v16, v60, s41, v16
  v_dot2_f32_bf16 v17, v60, s42, v17
  v_dot2_f32_bf16 v18, v61, s41, v18
  v_dot2_f32_bf16 v19, v61, s42, v19
  v_dot2_f32_bf16 v20, v62, s41, v20
  v_dot2_f32_bf16 v21, v62, s42, v21
  v_dot2_f32_bf16 v22, v63, s41, v22
  v_dot2_f32_bf16 v23, v63, s42, v23
  s_waitcnt vmcnt(1)
  v_dot2_f32_bf16 v16, v64, s41, v16
  v_dot2_f32_bf16 v17, v64, s42, v17
  v_dot2_f32_bf16 v18, v65, s41, v18
  v_dot2_f32_bf16 v19, v65, s42, v19
  v_dot2_f32_bf16 v20, v66, s41, v20
  v_dot2_f32_bf16 v21, v66, s42, v21
  v_dot2_f32_bf16 v22, v67, s41, v22
  v_dot2_f32_bf16 v23, v67, s42, v23
  s_waitcnt vmcnt(0)
  v_dot2_f32_bf16 v16, v68, s41, v16
  v_dot2_f32_bf16 v17, v68, s42, v17
  v_dot2_f32_bf16 v18, v69, s41, v18
  v_dot2_f32_bf16 v19, v69, s42, v19
  v_dot2_f32_bf16 v20, v70, s41, v20
  v_dot2_f32_bf16 v21, v70, s42, v21
  v_dot2_f32_bf16 v22, v71, s41, v22
  v_dot2_f32_bf16 v23, v71, s42, v23
  v_add_f32_dpp v16, v16, v16 row_ror:8 row_mask:0xf bank_mask:0xf
  v_mov_b32 v24, v16
  s_nop 1
  v_permlane16_swap_b32 v16, v24
  v_add_f32 v16, v16, v24
  v_mov_b32 v24, v16
  s_nop 1
  v_permlane32_swap_b32 v16, v24
  v_add_f32 v16, v16, v24
  v_add_f32_dpp v17, v17, v17 row_ror:8 row_mask:0xf bank_mask:0xf
  v_mov_b32 v24, v17
  s_nop 1
  v_permlane16_swap_b32 v17, v24
  v_add_f32 v17, v17, v24
  v_mov_b32 v24, v17
  s_nop 1
  v_permlane32_swap_b32 v17, v24
  v_add_f32 v17, v17, v24
  v_add_f32_dpp v18, v18, v18 row_ror:8 row_mask:0xf bank_mask:0xf
  v_mov_b32 v24, v18
  s_nop 1
  v_permlane16_swap_b32 v18, v24
  v_add_f32 v18, v18, v24
  v_mov_b32 v24, v18
  s_nop 1
  v_permlane32_swap_b32 v18, v24
  v_add_f32 v18, v18, v24
  v_add_f32_dpp v19, v19, v19 row_ror:8 row_mask:0xf bank_mask:0xf
  v_mov_b32 v24, v19
  s_nop 1
  v_permlane16_swap_b32 v19, v24
  v_add_f32 v19, v19, v24
  v_mov_b32 v24, v19
  s_nop 1
  v_permlane32_swap_b32 v19, v24
  v_add_f32 v19, v19, v24
  v_add_f32_dpp v20, v20, v20 row_ror:8 row_mask:0xf bank_mask:0xf
  v_mov_b32 v24, v20
  s_nop 1
  v_permlane16_swap_b32 v20, v24
  v_add_f32 v20, v20, v24
  v_mov_b32 v24, v20
  s_nop 1
  v_permlane32_swap_b32 v20, v24
  v_add_f32 v20, v20, v24
  v_add_f32_dpp v21, v21, v21 row_ror:8 row_mask:0xf bank_mask:0xf
  v_mov_b32 v24, v21
  s_nop 1
  v_permlane16_swap_b32 v21, v24
  v_add_f32 v21, v21, v24
  v_mov_b32 v24, v21
  s_nop 1
  v_permlane32_swap_b32 v21, v24
  v_add_f32 v21, v21, v24
  v_add_f32_dpp v22, v22, v22 row_ror:8 row_mask:0xf bank_mask:0xf
  v_mov_b32 v24, v22
  s_nop 1
  v_permlane16_swap_b32 v22, v24
  v_add_f32 v22, v22, v24
  v_mov_b32 v24, v22
  s_nop 1
  v_permlane32_swap_b32 v22, v24
  v_add_f32 v22, v22, v24
  v_add_f32_dpp v23, v23, v23 row_ror:8 row_mask:0xf bank_mask:0xf
  v_mov_b32 v24, v23
  s_nop 1
  v_permlane16_swap_b32 v23, v24
  v_add_f32 v23, v23, v24
  v_mov_b32 v24, v23
  s_nop 1
  v_permlane32_swap_b32 v23, v24
  v_add_f32 v23, v23, v24
  s_lshl_b32 s12, s3, 8
  v_lshlrev_b32 v9, 5, v5
  v_add_u32 v9, s12, v9
  ds_write_b128 v9, v[16:19]
  ds_write_b128 v9, v[20:23] offset:16
  s_waitcnt lgkmcnt(0)
  s_barrier
  s_cmp_lg_u32 s3, 3
  s_cbranch_scc1 F_ax
  v_lshlrev_b32 v9, 2, v2
  ds_read_b32 v16, v9 offset:0
  ds_read_b32 v17, v9 offset:256
  ds_read_b32 v18, v9 offset:512
  ds_read_b32 v19, v9 offset:768
  ds_read_b32 v20, v9 offset:1024
  ds_read_b32 v21, v9 offset:1280
  ds_read_b32 v22, v9 offset:1536
  ds_read_b32 v23, v9 offset:1792
  s_lshl_b32 s12, s5, 8
  s_add_u32 s12, s12, s11
  s_waitcnt lgkmcnt(0)
  v_add_f32 v16, v16, v17
  v_add_f32 v16, v16, v18
  v_add_f32 v16, v16, v19
  v_add_f32 v16, v16, v20
  v_add_f32 v16, v16, v21
  v_add_f32 v16, v16, v22
  v_add_f32 v16, v16, v23
  buffer_store_dword v16, v9, s[36:39], s12 offen sc1
  s_mov_b32 s71, 1
  s_branch F_ax
F_fl:
  s_cmp_lt_u32 s72, 58
  s_cbranch_scc1 F_ax
  s_sub_u32 s5, s72, 58
  s_lshl_b32 s5, s5, 14
  v_mov_b32 v16, 0
  v_mov_b32 v17, 0
  v_mov_b32 v18, 0
  v_mov_b32 v19, 0
  s_lshl_b32 s4, s3, 11
  s_add_u32 s4, s4, s5
  s_add_u32 s4, s4, 33030144
  buffer_store_dwordx4 v[16:19], v3, s[36:39], s4 offen sc1
  buffer_store_dwordx4 v[16:19], v3, s[36:39], s4 offen offset:1024 sc1
  s_branch F_aw
F_ax:
  s_cmp_lg_u32 s3, 0
  s_cbranch_scc1 F_a2
  s_waitcnt vmcnt(0)
  v_readfirstlane_b32 s77, v255
  v_mov_b32 v250, 128
  s_mov_b32 s78, 0
  s_mov_b64 exec, 1
F_pl6:
  buffer_load_dword v251, v254, s[36:39], 0 offen sc1
  s_waitcnt vmcnt(0)
  v_readfirstlane_b32 s79, v251
  s_add_u32 s78, s78, 1
  s_cmp_lg_u32 s79, s77
  s_cbranch_scc1 F_pl6_ok
  s_sleep 8
  s_and_b32 s79, s78, 15
  s_cmp_lg_u32 s79, 10
  s_cbranch_scc1 F_pl6
  global_load_dword v251, v250, s[34:35] sc1
  s_waitcnt vmcnt(0)
  v_readfirstlane_b32 s79, v251
  s_nop 0
  s_cmp_lg_u32 s79, 0
  s_cbranch_scc1 F_pl6_ok
  s_cmp_lt_u32 s78, 400000
  s_cbranch_scc1 F_pl6
F_pl6_ok:
  s_mov_b64 exec, -1
F_a2:
  v_mov_b32 v248, 143360
  v_mov_b32 v244, 0
  v_mov_b32 v245, 0
  v_mov_b32 v246, 0
  v_mov_b32 v247, 0
  ds_write_b128 v248, v[244:247]
  ds_write_b128 v248, v[244:247] offset:16
  s_waitcnt lgkmcnt(0)
  s_barrier
  s_cmp_eq_u32 s71, 0
  s_cbranch_scc1 F_a3
  s_waitcnt vmcnt(0)
  v_mov_b32 v250, 33076224
  v_mov_b32 v251, 1
  s_mov_b64 exec, 1
  global_atomic_add v252, v250, v251, s[32:33] sc0 sc1
  s_waitcnt vmcnt(0)
  v_readfirstlane_b32 s79, v252
  s_mov_b64 exec, -1
  s_cmp_lg_u32 s79, 33
  s_cbranch_scc1 F_ar3
  v_lshlrev_b32 v250, 7, v2
  v_mov_b32 v251, 1
  s_lshl_b32 s79, 8, 2
  s_add_u32 s79, s79, 33079296
  buffer_store_dword v251, v250, s[36:39], s79 offen sc1
F_ar3:
F_a3:
F_fin:
  s_load_dwordx2 s[44:45], s[0:1], 112
  v_lshlrev_b32 v3, 4, v2
  v_mov_b32 v153, 143360
  s_and_b32 s19, s2, 7
  s_lshl_b32 s4, s19, 2
  s_bfe_u32 s5, s2, 0x20003
  s_add_u32 s4, s4, s5
  s_lshr_b32 s5, s2, 5
  s_lshr_b32 s25, s2, 4
  s_and_b32 s74, s4, 3
  s_lshl_b32 s74, s74, 1
  s_add_u32 s74, s74, s5
  s_mul_i32 s74, s74, 3
  s_lshr_b32 s74, s74, 1
  s_sub_u32 s12, s74, 12
  s_cmp_ge_u32 s74, 12
  s_cselect_b32 s74, s12, s74
  s_add_u32 s65, s4, s5
  s_and_b32 s65, s65, 3
  s_bfe_u32 s66, s2, 0x10003
  s_lshl_b32 s66, s66, 1
  s_add_u32 s66, s66, s25
  s_and_b32 s66, s66, 3
  s_mov_b32 s76, 0
  s_cmp_ge_u32 s3, 4
  s_cbranch_scc0 GG_comp
GG_loader:
  s_sub_u32 s3, s3, 4
  s_mul_i32 s9, s3, 5120
  s_lshl_b32 s12, s3, 2
  s_add_u32 s12, s12, 143360
  v_mov_b32 v12, s12
  s_mul_i32 s8, s5, 102400
  s_mul_i32 s12, s65, 25600
  s_add_u32 s12, s12, s9
  s_add_u32 s12, s12, s8
  s_add_u32 s20, s12, 26214400
  s_add_u32 s21, s12, 27262976
  s_add_u32 s28, s8, 26316800
  s_add_u32 s29, s8, 27365376
  s_mul_i32 s8, s25, 122880
  s_mul_i32 s12, s66, 30720
  s_add_u32 s12, s12, s9
  s_add_u32 s12, s12, s8
  s_add_u32 s22, s12, 28311552
  s_add_u32 s30, s8, 28434432
  s_mul_i32 s8, s5, 245760
  s_mul_i32 s12, s74, 20480
  s_add_u32 s12, s12, s9
  s_add_u32 s12, s12, s8
  s_add_u32 s23, s12, 30408704
  s_add_u32 s31, s8, 30654464
  s_add_u32 s16, s9, 143360
  s_mov_b32 s10, s20
  s_mov_b32 s17, s28
  s_mov_b32 s18, 102400
  s_mov_b32 s11, s9
  s_mov_b32 s12, 0
  s_mov_b32 s13, 0
GG_ld:
  s_cmp_lt_u32 s12, 7
  s_cbranch_scc1 GG_ld_go
  s_sub_u32 s15, s12, 6
  s_max_u32 s15, s15, 1
  s_max_u32 s14, s15, 1
  s_cmp_ge_u32 s12, 12
  s_cselect_b32 s15, s14, s15
  s_cmp_ge_u32 s13, s15
  s_cbranch_scc1 GG_ld_go
  ds_read_b128 v[8:11], v153 offset:16
  s_waitcnt lgkmcnt(0)
  v_min_u32 v8, v8, v9
  v_min3_u32 v8, v8, v10, v11
  s_nop 0
  v_readfirstlane_b32 s13, v8
  s_add_u32 s76, s76, 1
  s_cmp_ge_u32 s13, s15
  s_cbranch_scc1 GG_ld_go
  s_waitcnt vmcnt(0)
  v_mov_b32 v14, s12
  ds_write_b32 v12, v14
GG_ld_sp:
  s_sleep 1
  ds_read_b128 v[8:11], v153 offset:16
  s_waitcnt lgkmcnt(0)
  v_min_u32 v8, v8, v9
  v_min3_u32 v8, v8, v10, v11
  s_nop 0
  v_readfirstlane_b32 s13, v8
  s_add_u32 s76, s76, 1
  s_cmp_ge_u32 s13, s15
  s_cbranch_scc1 GG_ld_go
  s_cmp_lt_u32 s76, 8388608
  s_cbranch_scc1 GG_ld_sp
GG_ld_go:
  s_mov_b32 m0, s11
  s_add_u32 s14, s10, 4096
  buffer_load_dwordx4 v3, s[36:39], s10 offen offset:0 sc1 lds
  buffer_load_dwordx4 v3, s[36:39], s10 offen offset:1024 sc1 lds
  buffer_load_dwordx4 v3, s[36:39], s10 offen offset:2048 sc1 lds
  buffer_load_dwordx4 v3, s[36:39], s10 offen offset:3072 sc1 lds
  s_add_u32 m0, s11, 4096
  v_mov_b32 v14, s12
  buffer_load_dwordx4 v3, s[36:39], s14 offen sc1 lds
  s_waitcnt vmcnt(5)
  ds_write_b32 v12, v14
  s_add_u32 s12, s12, 1
  s_add_u32 s11, s11, 20480
  s_cmp_eq_u32 s11, s16
  s_cselect_b32 s11, s9, s11
  s_add_u32 s10, s10, 20480
  s_sub_u32 s14, s10, s18
  s_cmp_ge_u32 s10, s17
  s_cselect_b32 s10, s14, s10
  s_cmp_eq_u32 s12, 5
  s_cselect_b32 s10, s21, s10
  s_cselect_b32 s17, s29, s17
  s_cselect_b32 s18, 102400, s18
  s_cmp_eq_u32 s12, 10
  s_cselect_b32 s10, s22, s10
  s_cselect_b32 s17, s30, s17
  s_cselect_b32 s18, 122880, s18
  s_cmp_eq_u32 s12, 16
  s_cselect_b32 s10, s23, s10
  s_cselect_b32 s17, s31, s17
  s_cselect_b32 s18, 245760, s18
  s_cmp_lt_u32 s12, 28
  s_cbranch_scc1 GG_ld
  v_add_u32 v4, s9, v3
  v_add_u32 v5, 0x10000, v4
  v_add_u32 v6, 0x20000, v4
  v_mov_b32 v14, 28
  s_waitcnt vmcnt(0)
  ds_write_b32 v12, v14
  s_waitcnt lgkmcnt(0)
GG_done:
  s_endpgm
GG_comp:
  v_and_b32 v6, 15, v2
  v_lshrrev_b32 v7, 4, v2
  v_add_u32 v1, 0x10000, v3
  v_add_u32 v152, 0x20000, v3
  s_lshl_b32 s12, s3, 2
  s_add_u32 s12, s12, 143376
  v_mov_b32 v0, s12
  v_mul_u32_u24 v4, 33280, v7
  v_lshl_add_u32 v4, v6, 3, v4
  v_add_u32 v15, 16640, v4
  v_mul_u32_u24 v5, 4224, v7
  v_lshl_add_u32 v5, v6, 4, v5
  s_mov_b32 s40, 0xffff0000
  s_mov_b32 s41, 0x3f803f80
  v_mov_b32 v8, s41
  v_mov_b32 v9, s41
  v_mov_b32 v10, s41
  v_mov_b32 v11, s41
  s_mul_i32 s67, s19, 1572864
  s_mul_i32 s20, s5, 5
  s_add_u32 s20, s20, 1
  s_lshr_b32 s20, s20, 1
  s_lshr_b32 s21, s5, 1
  s_mul_i32 s21, s21, 5
  s_add_u32 s21, s21, 2
  s_and_b32 s22, s5, 1
  s_mul_i32 s48, s20, 133120
  s_add_u32 s49, s48, 133120
  s_mul_i32 s50, s21, 133120
  s_lshl_b32 s23, s22, 3
  s_mul_i32 s12, s22, 16640
  s_add_u32 s50, s50, s12
  s_mul_i32 s62, s20, 16896
  s_add_u32 s63, s62, 16896
  s_mul_i32 s64, s21, 16896
  s_lshl_b32 s12, s22, 11
  s_add_u32 s64, s64, s12
  s_lshl_b32 s6, s4, 2
  s_add_u32 s6, s6, s3
  s_lshl_b32 s18, s6, 7
  s_and_b32 s68, s6, 15
  s_lshl_b32 s69, s68, 8
  s_add_u32 s69, s69, s67
  s_lshl_b32 s12, s68, 7
  s_sub_u32 s64, s64, s12
  v_mul_u32_u24 v151, 4224, v7
  v_lshl_add_u32 v151, v6, 3, v151
  s_lshl_b32 s24, s19, 1
  s_bfe_u32 s27, s2, 0x10003
  s_add_u32 s24, s24, s27
  s_lshl_b32 s26, s24, 3
  s_lshl_b32 s12, s3, 1
  s_add_u32 s26, s26, s12
  s_and_b32 s27, s26, 15
  s_sub_u32 s31, s74, 1
  s_lshr_b32 s12, s5, 1
  s_lshr_b32 s13, s12, 1
  s_add_u32 s13, s13, 1
  s_sub_u32 s14, 0, s13
  s_and_b32 s12, s12, 1
  s_cmp_eq_u32 s12, 0
  s_cselect_b32 s13, s14, s13
  s_lshl_b32 s12, s13, 3
  s_add_u32 s7, s18, s12
  s_add_u32 s7, s7, 12587008
  s_mov_b32 s8, s7
  s_add_u32 s9, s7, 2662400
  s_mul_i32 s12, s65, 665600
  s_add_u32 s7, s7, s12
  s_sub_u32 s7, s7, 133120
  s_lshl_b32 s12, s6, 4
  s_add_u32 s12, s12, s13
  v_add_u32 v129, s12, v6
  s_movk_i32 s12, 0x800
  v_cmp_gt_u32 s[60:61], s12, v129
  v_lshlrev_b32 v88, 3, v6
  s_and_b32 s12, s5, 5
  s_cmp_eq_u32 s12, 0
  s_cselect_b32 s70, 0xffff, 0
  s_mov_b32 s71, 0
  s_lshl_b32 s12, s5, 6
  v_add_u32 v88, s12, v88
  v_lshlrev_b32 v128, 5, v7
  s_lshl_b32 s51, s20, 7
  s_add_u32 s51, s51, 32505856
  s_lshl_b32 s52, s21, 7
  s_lshl_b32 s12, s22, 4
  s_add_u32 s52, s52, s12
  s_add_u32 s52, s52, 32505856
  v_and_b32 v120, 3, v6
  v_cmp_eq_u32 s[42:43], 1, v120
  v_cmp_eq_u32 s[58:59], 2, v120
  v_cmp_eq_u32 s[78:79], 3, v120
  v_lshrrev_b32 v120, 2, v6
  v_cmp_eq_u32 s[56:57], v7, v120
  s_add_u32 s17, s69, 337920
  s_add_u32 s53, s62, s17
  s_add_u32 s54, s63, s17
  s_add_u32 s55, s64, s17
  s_add_u32 s16, s18, 12587008
  s_add_u32 s72, s16, s48
  s_add_u32 s73, s16, s49
  s_add_u32 s74, s16, s50
  s_getreg_b32 s30, hwreg(HW_REG_XCC_ID, 0, 4)
  s_or_b32 s30, s30, 0x100
  s_lshl_b32 s75, s19, 7
  s_add_u32 s75, s75, 33071104
  s_lshr_b32 s14, s2, 3
  s_lshl_b32 s14, s14, 2
  v_mov_b32 v130, s14
  v_mov_b32 v131, s30
  s_cmp_eq_u32 s3, 0
  s_cselect_b32 s10, 1, 0
  s_mov_b32 s11, 0
  v_and_b32 v89, 31, v2
  v_lshlrev_b32 v89, 2, v89
  s_waitcnt lgkmcnt(0)
  s_mov_b32 s46, 2621440
  s_mov_b32 s47, 0x00020000
  v_and_b32 v132, 15, v2
  v_lshrrev_b32 v133, 4, v2
  v_min_u32 v133, 2, v133
  v_lshrrev_b32 v134, 1, v133
  s_lshl_b32 s12, s19, 4
  v_add_u32 v132, s12, v132
  v_lshrrev_b32 v132, v134, v132
  v_lshlrev_b32 v132, 7, v132
  v_lshl_add_u32 v132, v133, 14, v132
  s_mov_b32 s12, 33030144
  buffer_load_dword v149, v132, s[36:39], s12 offen sc1
  s_mov_b64 exec, s[10:11]
  buffer_store_dword v131, v130, s[36:39], s75 offen sc1
  s_mov_b64 exec, -1
  s_setprio 2
  s_waitcnt lgkmcnt(0)
  s_mov_b32 s77, 0
  s_cmp_ge_u32 s77, 1
  s_cbranch_scc1 GG_ro1
GG_rd1:
  ds_read_b128 v[140:143], v153
  s_add_u32 s76, s76, 1
  s_waitcnt lgkmcnt(0)
  v_min_u32 v140, v140, v141
  v_min3_u32 v140, v140, v142, v143
  s_nop 0
  v_readfirstlane_b32 s77, v140
  s_nop 0
  s_cmp_ge_u32 s77, 1
  s_cbranch_scc1 GG_ro1
  s_cmp_lt_u32 s76, 8388608
  s_cbranch_scc1 GG_rd1
GG_ro1:
  ds_read_b128 v[16:19], v3 offset:0
  ds_read_b128 v[20:23], v3 offset:1024
  ds_read_b128 v[24:27], v3 offset:2048
  ds_read_b128 v[28:31], v3 offset:3072
  ds_read_b128 v[32:35], v3 offset:4096
  ds_read_b128 v[36:39], v3 offset:5120
  ds_read_b128 v[40:43], v3 offset:6144
  ds_read_b128 v[44:47], v3 offset:7168
  ds_read_b128 v[76:79], v3 offset:8192
  ds_read_b128 v[80:83], v3 offset:9216
  ds_read_b128 v[84:87], v3 offset:10240
  ds_read_b128 v[92:95], v3 offset:11264
  ds_read_b128 v[164:167], v3 offset:12288
  s_and_b32 s12, s2, 63
  s_lshl_b32 s12, s12, 7
  s_add_u32 s12, s12, 33079296
  v_lshl_add_u32 v148, v2, 2, s12
  s_mov_b32 s13, 0
  s_mov_b64 exec, 0x1ff
GG_gh:
  buffer_load_dword v149, v148, s[36:39], 0 offen sc1
  s_waitcnt vmcnt(0)
  v_cmp_ne_u32 vcc, 0, v149
  s_add_u32 s13, s13, 1
  s_cmp_eq_u64 vcc, exec
  s_cbranch_scc1 GG_go
  s_sleep 4
  s_cmp_lt_u32 s13, 400000
  s_cbranch_scc1 GG_gh
GG_go:
  s_mov_b64 exec, -1
  s_add_u32 s7, s7, 133120
  buffer_load_dwordx2 v[176:177], v4, s[36:39], s7 offen sc1
  buffer_load_dwordx2 v[178:179], v15, s[36:39], s7 offen sc1
  s_add_u32 s7, s7, 133120
  buffer_load_dwordx2 v[180:181], v4, s[36:39], s7 offen sc1
  buffer_load_dwordx2 v[182:183], v15, s[36:39], s7 offen sc1
  s_add_u32 s7, s7, 133120
  buffer_load_dwordx2 v[184:185], v4, s[36:39], s7 offen sc1
  buffer_load_dwordx2 v[186:187], v15, s[36:39], s7 offen sc1
  s_add_u32 s7, s7, 133120
  buffer_load_dwordx2 v[188:189], v4, s[36:39], s7 offen sc1
  buffer_load_dwordx2 v[190:191], v15, s[36:39], s7 offen sc1
  s_add_u32 s7, s7, 133120
  buffer_load_dwordx2 v[192:193], v4, s[36:39], s7 offen sc1
  buffer_load_dwordx2 v[194:195], v15, s[36:39], s7 offen sc1
  s_waitcnt lgkmcnt(9)
  s_waitcnt vmcnt(8)
  v_mfma_f32_16x16x32_bf16 v[48:51], v[16:19], v[176:179], 0
  ds_read_b128 v[168:171], v3 offset:13312
  v_mfma_f32_16x16x32_bf16 v[68:71], v[8:11], v[176:179], 0
  s_add_u32 s7, s7, 133120
  s_cmp_eq_u32 s7, s9
  s_cselect_b32 s7, s8, s7
  buffer_load_dwordx2 v[196:197], v4, s[36:39], s7 offen sc1
  v_mfma_f32_16x16x32_bf16 v[52:55], v[20:23], v[176:179], 0
  ds_read_b128 v[16:19], v3 offset:14336
  v_mfma_f32_16x16x32_bf16 v[72:75], v[176:179], v[176:179], 0
  buffer_load_dwordx2 v[198:199], v15, s[36:39], s7 offen sc1
  v_mfma_f32_16x16x32_bf16 v[56:59], v[24:27], v[176:179], 0
  ds_read_b128 v[20:23], v3 offset:15360
  s_add_u32 s7, s7, 133120
  buffer_load_dwordx2 v[200:201], v4, s[36:39], s7 offen sc1
  v_mfma_f32_16x16x32_bf16 v[60:63], v[28:31], v[176:179], 0
  ds_read_b128 v[24:27], v3 offset:16384
  buffer_load_dwordx2 v[202:203], v15, s[36:39], s7 offen sc1
  s_waitcnt lgkmcnt(9)
  v_mfma_f32_16x16x32_bf16 v[64:67], v[32:35], v[176:179], 0
  ds_read_b128 v[28:31], v3 offset:17408
  s_add_u32 s7, s7, 133120
  buffer_load_dwordx2 v[204:205], v4, s[36:39], s7 offen sc1
  s_waitcnt vmcnt(11)
  v_mfma_f32_16x16x32_bf16 v[48:51], v[36:39], v[180:183], v[48:51]
  ds_read_b128 v[32:35], v3 offset:18432
  v_mfma_f32_16x16x32_bf16 v[68:71], v[8:11], v[180:183], v[68:71]
  buffer_load_dwordx2 v[206:207], v15, s[36:39], s7 offen sc1
  v_mfma_f32_16x16x32_bf16 v[52:55], v[40:43], v[180:183], v[52:55]
  ds_read_b128 v[36:39], v3 offset:19456
  v_mfma_f32_16x16x32_bf16 v[72:75], v[180:183], v[180:183], v[72:75]
  s_add_u32 s7, s7, 133120
  buffer_load_dwordx2 v[208:209], v4, s[36:39], s7 offen sc1
  v_mfma_f32_16x16x32_bf16 v[56:59], v[44:47], v[180:183], v[56:59]
  s_cmp_ge_u32 s77, 2
  s_cbranch_scc1 GG_ro2
GG_rd2:
  ds_read_b128 v[140:143], v153
  s_add_u32 s76, s76, 1
  s_waitcnt lgkmcnt(0)
  v_min_u32 v140, v140, v141
  v_min3_u32 v140, v140, v142, v143
  s_nop 0
  v_readfirstlane_b32 s77, v140
  s_nop 0
  s_cmp_ge_u32 s77, 2
  s_cbranch_scc1 GG_ro2
  s_cmp_lt_u32 s76, 8388608
  s_cbranch_scc1 GG_rd2
GG_ro2:
  ds_read_b128 v[40:43], v3 offset:20480
  buffer_load_dwordx2 v[210:211], v15, s[36:39], s7 offen sc1
  s_waitcnt lgkmcnt(9)
  v_mfma_f32_16x16x32_bf16 v[60:63], v[76:79], v[180:183], v[60:63]
  ds_read_b128 v[44:47], v3 offset:21504
  s_add_u32 s7, s7, 133120
  buffer_load_dwordx2 v[212:213], v4, s[36:39], s7 offen sc1
  v_mfma_f32_16x16x32_bf16 v[64:67], v[80:83], v[180:183], v[64:67]
  ds_read_b128 v[76:79], v3 offset:22528
  buffer_load_dwordx2 v[214:215], v15, s[36:39], s7 offen sc1
  s_waitcnt vmcnt(14)
  v_mfma_f32_16x16x32_bf16 v[48:51], v[84:87], v[184:187], v[48:51]
  ds_read_b128 v[80:83], v3 offset:23552
  v_mfma_f32_16x16x32_bf16 v[68:71], v[8:11], v[184:187], v[68:71]
  s_add_u32 s7, s7, 133120
  s_cmp_eq_u32 s7, s9
  s_cselect_b32 s7, s8, s7
  buffer_load_dwordx2 v[216:217], v4, s[36:39], s7 offen sc1
  v_mfma_f32_16x16x32_bf16 v[52:55], v[92:95], v[184:187], v[52:55]
  ds_read_b128 v[84:87], v3 offset:24576
  v_mfma_f32_16x16x32_bf16 v[72:75], v[184:187], v[184:187], v[72:75]
  buffer_load_dwordx2 v[218:219], v15, s[36:39], s7 offen sc1
  s_waitcnt lgkmcnt(9)
  v_mfma_f32_16x16x32_bf16 v[56:59], v[164:167], v[184:187], v[56:59]
  ds_read_b128 v[92:95], v3 offset:25600
  v_mfma_f32_16x16x32_bf16 v[60:63], v[168:171], v[184:187], v[60:63]
  ds_read_b128 v[164:167], v3 offset:26624
  v_mfma_f32_16x16x32_bf16 v[64:67], v[16:19], v[184:187], v[64:67]
  ds_read_b128 v[168:171], v3 offset:27648
  s_waitcnt vmcnt(14)
  v_mfma_f32_16x16x32_bf16 v[48:51], v[20:23], v[188:191], v[48:51]
  ds_read_b128 v[16:19], v3 offset:28672
  v_mfma_f32_16x16x32_bf16 v[68:71], v[8:11], v[188:191], v[68:71]
  s_add_u32 s7, s7, 133120
  buffer_load_dwordx2 v[220:221], v4, s[36:39], s7 offen sc1
  s_waitcnt lgkmcnt(9)
  v_mfma_f32_16x16x32_bf16 v[52:55], v[24:27], v[188:191], v[52:55]
  ds_read_b128 v[20:23], v3 offset:29696
  v_mfma_f32_16x16x32_bf16 v[72:75], v[188:191], v[188:191], v[72:75]
  buffer_load_dwordx2 v[222:223], v15, s[36:39], s7 offen sc1
  v_mfma_f32_16x16x32_bf16 v[56:59], v[28:31], v[188:191], v[56:59]
  ds_read_b128 v[24:27], v3 offset:30720
  v_mfma_f32_16x16x32_bf16 v[60:63], v[32:35], v[188:191], v[60:63]
  ds_read_b128 v[28:31], v3 offset:31744
  v_mfma_f32_16x16x32_bf16 v[64:67], v[36:39], v[188:191], v[64:67]
  ds_read_b128 v[32:35], v3 offset:32768
  s_waitcnt lgkmcnt(9)
  s_waitcnt vmcnt(14)
  v_mfma_f32_16x16x32_bf16 v[48:51], v[40:43], v[192:195], v[48:51]
  ds_read_b128 v[36:39], v3 offset:33792
  v_mfma_f32_16x16x32_bf16 v[68:71], v[8:11], v[192:195], v[68:71]
  s_add_u32 s7, s7, 133120
  buffer_load_dwordx2 v[224:225], v4, s[36:39], s7 offen sc1
  v_mfma_f32_16x16x32_bf16 v[52:55], v[44:47], v[192:195], v[52:55]
  ds_read_b128 v[40:43], v3 offset:34816
  v_mfma_f32_16x16x32_bf16 v[72:75], v[192:195], v[192:195], v[72:75]
  buffer_load_dwordx2 v[226:227], v15, s[36:39], s7 offen sc1
  v_mfma_f32_16x16x32_bf16 v[56:59], v[76:79], v[192:195], v[56:59]
  ds_read_b128 v[44:47], v3 offset:35840
  v_mov_b32 v91, 1
  ds_write_b32 v0, v91
  v_mfma_f32_16x16x32_bf16 v[60:63], v[80:83], v[192:195], v[60:63]
  ds_read_b128 v[76:79], v3 offset:36864
  s_waitcnt lgkmcnt(10)
  v_mfma_f32_16x16x32_bf16 v[64:67], v[84:87], v[192:195], v[64:67]
  ds_read_b128 v[80:83], v3 offset:37888
  s_waitcnt vmcnt(14)
  v_mfma_f32_16x16x32_bf16 v[48:51], v[92:95], v[196:199], v[48:51]
  ds_read_b128 v[84:87], v3 offset:38912
  v_mfma_f32_16x16x32_bf16 v[68:71], v[8:11], v[196:199], v[68:71]
  s_add_u32 s7, s7, 133120
  buffer_load_dwordx2 v[228:229], v4, s[36:39], s7 offen sc1
  v_mfma_f32_16x16x32_bf16 v[52:55], v[164:167], v[196:199], v[52:55]
  ds_read_b128 v[92:95], v3 offset:39936
  v_mfma_f32_16x16x32_bf16 v[72:75], v[196:199], v[196:199], v[72:75]
  buffer_load_dwordx2 v[230:231], v15, s[36:39], s7 offen sc1
  v_mfma_f32_16x16x32_bf16 v[56:59], v[168:171], v[196:199], v[56:59]
  s_cmp_ge_u32 s77, 3
  s_cbranch_scc1 GG_ro3
GG_rd3:
  ds_read_b128 v[140:143], v153
  s_add_u32 s76, s76, 1
  s_waitcnt lgkmcnt(0)
  v_min_u32 v140, v140, v141
  v_min3_u32 v140, v140, v142, v143
  s_nop 0
  v_readfirstlane_b32 s77, v140
  s_nop 0
  s_cmp_ge_u32 s77, 3
  s_cbranch_scc1 GG_ro3
  s_cmp_lt_u32 s76, 8388608
  s_cbranch_scc1 GG_rd3
GG_ro3:
  ds_read_b128 v[164:167], v3 offset:40960
  s_waitcnt lgkmcnt(10)
  v_mfma_f32_16x16x32_bf16 v[60:63], v[16:19], v[196:199], v[60:63]
  ds_read_b128 v[168:171], v3 offset:41984
  v_mfma_f32_16x16x32_bf16 v[64:67], v[20:23], v[196:199], v[64:67]
  ds_read_b128 v[16:19], v3 offset:43008
  s_waitcnt vmcnt(14)
  v_mfma_f32_16x16x32_bf16 v[48:51], v[24:27], v[200:203], v[48:51]
  ds_read_b128 v[20:23], v3 offset:44032
  v_mfma_f32_16x16x32_bf16 v[68:71], v[8:11], v[200:203], v[68:71]
  s_add_u32 s7, s7, 133120
  buffer_load_dwordx2 v[232:233], v4, s[36:39], s7 offen sc1
  v_mfma_f32_16x16x32_bf16 v[52:55], v[28:31], v[200:203], v[52:55]
  ds_read_b128 v[24:27], v3 offset:45056
  v_mfma_f32_16x16x32_bf16 v[72:75], v[200:203], v[200:203], v[72:75]
  buffer_load_dwordx2 v[234:235], v15, s[36:39], s7 offen sc1
  s_waitcnt lgkmcnt(10)
  v_mfma_f32_16x16x32_bf16 v[56:59], v[32:35], v[200:203], v[56:59]
  ds_read_b128 v[28:31], v3 offset:46080
  v_mfma_f32_16x16x32_bf16 v[60:63], v[36:39], v[200:203], v[60:63]
  ds_read_b128 v[32:35], v3 offset:47104
  v_mfma_f32_16x16x32_bf16 v[64:67], v[40:43], v[200:203], v[64:67]
  ds_read_b128 v[36:39], v3 offset:48128
  s_waitcnt vmcnt(14)
  v_mfma_f32_16x16x32_bf16 v[48:51], v[44:47], v[204:207], v[48:51]
  ds_read_b128 v[40:43], v3 offset:49152
  v_mfma_f32_16x16x32_bf16 v[68:71], v[8:11], v[204:207], v[68:71]
  s_add_u32 s7, s7, 133120
  s_cmp_eq_u32 s7, s9
  s_cselect_b32 s7, s8, s7
  buffer_load_dwordx2 v[236:237], v4, s[36:39], s7 offen sc1
  s_waitcnt lgkmcnt(9)
  v_mfma_f32_16x16x32_bf16 v[52:55], v[76:79], v[204:207], v[52:55]
  ds_read_b128 v[44:47], v3 offset:50176
  v_mfma_f32_16x16x32_bf16 v[72:75], v[204:207], v[204:207], v[72:75]
  buffer_load_dwordx2 v[238:239], v15, s[36:39], s7 offen sc1
  v_mfma_f32_16x16x32_bf16 v[56:59], v[80:83], v[204:207], v[56:59]
  ds_read_b128 v[76:79], v3 offset:51200
  v_mfma_f32_16x16x32_bf16 v[60:63], v[84:87], v[204:207], v[60:63]
  ds_read_b128 v[80:83], v3 offset:52224
  v_mfma_f32_16x16x32_bf16 v[64:67], v[92:95], v[204:207], v[64:67]
  ds_read_b128 v[84:87], v3 offset:53248
  s_waitcnt lgkmcnt(9)
  s_waitcnt vmcnt(14)
  v_mfma_f32_16x16x32_bf16 v[48:51], v[164:167], v[208:211], v[48:51]
  ds_read_b128 v[92:95], v3 offset:54272
  v_mfma_f32_16x16x32_bf16 v[68:71], v[8:11], v[208:211], v[68:71]
  s_add_u32 s7, s7, 133120
  buffer_load_dwordx2 v[240:241], v4, s[36:39], s7 offen sc1
  v_mfma_f32_16x16x32_bf16 v[52:55], v[168:171], v[208:211], v[52:55]
  ds_read_b128 v[164:167], v3 offset:55296
  v_mfma_f32_16x16x32_bf16 v[72:75], v[208:211], v[208:211], v[72:75]
  buffer_load_dwordx2 v[242:243], v15, s[36:39], s7 offen sc1
  v_mfma_f32_16x16x32_bf16 v[56:59], v[16:19], v[208:211], v[56:59]
  ds_read_b128 v[168:171], v3 offset:56320
  v_mov_b32 v91, 2
  ds_write_b32 v0, v91
  v_mfma_f32_16x16x32_bf16 v[60:63], v[20:23], v[208:211], v[60:63]
  ds_read_b128 v[16:19], v3 offset:57344
  s_waitcnt lgkmcnt(10)
  v_mfma_f32_16x16x32_bf16 v[64:67], v[24:27], v[208:211], v[64:67]
  ds_read_b128 v[20:23], v3 offset:58368
  s_waitcnt vmcnt(14)
  v_mfma_f32_16x16x32_bf16 v[48:51], v[28:31], v[212:215], v[48:51]
  ds_read_b128 v[24:27], v3 offset:59392
  v_mfma_f32_16x16x32_bf16 v[68:71], v[8:11], v[212:215], v[68:71]
  s_add_u32 s7, s7, 133120
  buffer_load_dwordx2 v[244:245], v4, s[36:39], s7 offen sc1
  v_mfma_f32_16x16x32_bf16 v[52:55], v[32:35], v[212:215], v[52:55]
  ds_read_b128 v[28:31], v3 offset:60416
  v_mfma_f32_16x16x32_bf16 v[72:75], v[212:215], v[212:215], v[72:75]
  buffer_load_dwordx2 v[246:247], v15, s[36:39], s7 offen sc1
  v_mfma_f32_16x16x32_bf16 v[56:59], v[36:39], v[212:215], v[56:59]
  s_cmp_ge_u32 s77, 4
  s_cbranch_scc1 GG_ro4
GG_rd4:
  ds_read_b128 v[140:143], v153
  s_add_u32 s76, s76, 1
  s_waitcnt lgkmcnt(0)
  v_min_u32 v140, v140, v141
  v_min3_u32 v140, v140, v142, v143
  s_nop 0
  v_readfirstlane_b32 s77, v140
  s_nop 0
  s_cmp_ge_u32 s77, 4
  s_cbranch_scc1 GG_ro4
  s_cmp_lt_u32 s76, 8388608
  s_cbranch_scc1 GG_rd4
GG_ro4:
  ds_read_b128 v[32:35], v3 offset:61440
  s_waitcnt lgkmcnt(10)
  v_mfma_f32_16x16x32_bf16 v[60:63], v[40:43], v[212:215], v[60:63]
  ds_read_b128 v[36:39], v3 offset:62464
  v_mfma_f32_16x16x32_bf16 v[64:67], v[44:47], v[212:215], v[64:67]
  ds_read_b128 v[40:43], v3 offset:63488
  s_waitcnt vmcnt(14)
  v_mfma_f32_16x16x32_bf16 v[48:51], v[76:79], v[216:219], v[48:51]
  ds_read_b128 v[44:47], v3 offset:64512
  v_mfma_f32_16x16x32_bf16 v[68:71], v[8:11], v[216:219], v[68:71]
  s_add_u32 s7, s7, 133120
  buffer_load_dwordx2 v[248:249], v4, s[36:39], s7 offen sc1
  v_mfma_f32_16x16x32_bf16 v[52:55], v[80:83], v[216:219], v[52:55]
  ds_read_b128 v[76:79], v1 offset:0
  v_mfma_f32_16x16x32_bf16 v[72:75], v[216:219], v[216:219], v[72:75]
  buffer_load_dwordx2 v[250:251], v15, s[36:39], s7 offen sc1
  s_waitcnt lgkmcnt(10)
  v_mfma_f32_16x16x32_bf16 v[56:59], v[84:87], v[216:219], v[56:59]
  ds_read_b128 v[80:83], v1 offset:1024
  v_mfma_f32_16x16x32_bf16 v[60:63], v[92:95], v[216:219], v[60:63]
  ds_read_b128 v[84:87], v1 offset:2048
  v_mfma_f32_16x16x32_bf16 v[64:67], v[164:167], v[216:219], v[64:67]
  ds_read_b128 v[92:95], v1 offset:3072
  s_waitcnt vmcnt(14)
  v_mfma_f32_16x16x32_bf16 v[48:51], v[168:171], v[220:223], v[48:51]
  ds_read_b128 v[164:167], v1 offset:4096
  v_mfma_f32_16x16x32_bf16 v[68:71], v[8:11], v[220:223], v[68:71]
  s_add_u32 s7, s7, 133120
  buffer_load_dwordx2 v[252:253], v4, s[36:39], s7 offen sc1
  s_waitcnt lgkmcnt(9)
  v_mfma_f32_16x16x32_bf16 v[52:55], v[16:19], v[220:223], v[52:55]
  ds_read_b128 v[168:171], v1 offset:5120
  v_mfma_f32_16x16x32_bf16 v[72:75], v[220:223], v[220:223], v[72:75]
  buffer_load_dwordx2 v[254:255], v15, s[36:39], s7 offen sc1
  v_mfma_f32_16x16x32_bf16 v[56:59], v[20:23], v[220:223], v[56:59]
  ds_read_b128 v[16:19], v1 offset:6144
  v_mfma_f32_16x16x32_bf16 v[60:63], v[24:27], v[220:223], v[60:63]
  ds_read_b128 v[20:23], v1 offset:7168
  v_mfma_f32_16x16x32_bf16 v[64:67], v[28:31], v[220:223], v[64:67]
  ds_read_b128 v[24:27], v1 offset:8192
  s_waitcnt lgkmcnt(9)
  s_waitcnt vmcnt(14)
  v_mfma_f32_16x16x32_bf16 v[48:51], v[32:35], v[224:227], v[48:51]
  ds_read_b128 v[28:31], v1 offset:9216
  v_mfma_f32_16x16x32_bf16 v[68:71], v[8:11], v[224:227], v[68:71]
  buffer_load_dwordx4 v[96:99], v128, s[36:39], s51 offen offset:0 sc1
  v_mfma_f32_16x16x32_bf16 v[52:55], v[36:39], v[224:227], v[52:55]
  ds_read_b128 v[32:35], v1 offset:10240
  v_mfma_f32_16x16x32_bf16 v[72:75], v[224:227], v[224:227], v[72:75]
  buffer_load_dwordx4 v[100:103], v128, s[36:39], s51 offen offset:16 sc1
  v_mfma_f32_16x16x32_bf16 v[56:59], v[40:43], v[224:227], v[56:59]
  ds_read_b128 v[36:39], v1 offset:11264
  v_mov_b32 v91, 3
  ds_write_b32 v0, v91
  v_mfma_f32_16x16x32_bf16 v[60:63], v[44:47], v[224:227], v[60:63]
  ds_read_b128 v[40:43], v1 offset:12288
  s_waitcnt lgkmcnt(10)
  v_mfma_f32_16x16x32_bf16 v[64:67], v[76:79], v[224:227], v[64:67]
  ds_read_b128 v[44:47], v1 offset:13312
  s_waitcnt vmcnt(14)
  v_mfma_f32_16x16x32_bf16 v[48:51], v[80:83], v[228:231], v[48:51]
  ds_read_b128 v[76:79], v1 offset:14336
  v_mfma_f32_16x16x32_bf16 v[68:71], v[8:11], v[228:231], v[68:71]
  buffer_load_dwordx4 v[104:107], v128, s[36:39], s51 offen offset:128 sc1
  v_mfma_f32_16x16x32_bf16 v[52:55], v[84:87], v[228:231], v[52:55]
  ds_read_b128 v[80:83], v1 offset:15360
  v_mfma_f32_16x16x32_bf16 v[72:75], v[228:231], v[228:231], v[72:75]
  buffer_load_dwordx4 v[108:111], v128, s[36:39], s51 offen offset:144 sc1
  v_mfma_f32_16x16x32_bf16 v[56:59], v[92:95], v[228:231], v[56:59]
  s_cmp_ge_u32 s77, 5
  s_cbranch_scc1 GG_ro5
GG_rd5:
  ds_read_b128 v[140:143], v153
  s_add_u32 s76, s76, 1
  s_waitcnt lgkmcnt(0)
  v_min_u32 v140, v140, v141
  v_min3_u32 v140, v140, v142, v143
  s_nop 0
  v_readfirstlane_b32 s77, v140
  s_nop 0
  s_cmp_ge_u32 s77, 5
  s_cbranch_scc1 GG_ro5
  s_cmp_lt_u32 s76, 8388608
  s_cbranch_scc1 GG_rd5
GG_ro5:
  ds_read_b128 v[84:87], v1 offset:16384
  s_waitcnt lgkmcnt(10)
  v_mfma_f32_16x16x32_bf16 v[60:63], v[164:167], v[228:231], v[60:63]
  ds_read_b128 v[92:95], v1 offset:17408
  v_mfma_f32_16x16x32_bf16 v[64:67], v[168:171], v[228:231], v[64:67]
  ds_read_b128 v[164:167], v1 offset:18432
  s_waitcnt vmcnt(14)
  v_mfma_f32_16x16x32_bf16 v[48:51], v[16:19], v[232:235], v[48:51]
  ds_read_b128 v[168:171], v1 offset:19456
  v_mfma_f32_16x16x32_bf16 v[68:71], v[8:11], v[232:235], v[68:71]
  buffer_load_dwordx4 v[112:115], v128, s[36:39], s52 offen offset:0 sc1
  v_mfma_f32_16x16x32_bf16 v[52:55], v[20:23], v[232:235], v[52:55]
  ds_read_b128 v[16:19], v1 offset:20480
  v_mfma_f32_16x16x32_bf16 v[72:75], v[232:235], v[232:235], v[72:75]
  buffer_load_dwordx2 v[154:155], v4, s[36:39], s72 offen sc1
  s_waitcnt lgkmcnt(10)
  v_mfma_f32_16x16x32_bf16 v[56:59], v[24:27], v[232:235], v[56:59]
  ds_read_b128 v[20:23], v1 offset:21504
  v_mfma_f32_16x16x32_bf16 v[60:63], v[28:31], v[232:235], v[60:63]
  ds_read_b128 v[24:27], v1 offset:22528
  v_mfma_f32_16x16x32_bf16 v[64:67], v[32:35], v[232:235], v[64:67]
  ds_read_b128 v[28:31], v1 offset:23552
  s_waitcnt vmcnt(14)
  v_mfma_f32_16x16x32_bf16 v[48:51], v[36:39], v[236:239], v[48:51]
  ds_read_b128 v[32:35], v1 offset:24576
  v_mfma_f32_16x16x32_bf16 v[68:71], v[8:11], v[236:239], v[68:71]
  buffer_load_dwordx2 v[156:157], v15, s[36:39], s72 offen sc1
  s_waitcnt lgkmcnt(9)
  v_mfma_f32_16x16x32_bf16 v[52:55], v[40:43], v[236:239], v[52:55]
  ds_read_b128 v[36:39], v1 offset:25600
  v_mfma_f32_16x16x32_bf16 v[72:75], v[236:239], v[236:239], v[72:75]
  buffer_load_dwordx2 v[158:159], v4, s[36:39], s73 offen sc1
  v_mfma_f32_16x16x32_bf16 v[56:59], v[44:47], v[236:239], v[56:59]
  ds_read_b128 v[40:43], v1 offset:26624
  v_mfma_f32_16x16x32_bf16 v[60:63], v[76:79], v[236:239], v[60:63]
  ds_read_b128 v[44:47], v1 offset:27648
  v_mfma_f32_16x16x32_bf16 v[64:67], v[80:83], v[236:239], v[64:67]
  ds_read_b128 v[76:79], v1 offset:28672
  s_waitcnt lgkmcnt(9)
  s_waitcnt vmcnt(14)
  v_mfma_f32_16x16x32_bf16 v[48:51], v[84:87], v[240:243], v[48:51]
  ds_read_b128 v[80:83], v1 offset:29696
  v_mfma_f32_16x16x32_bf16 v[68:71], v[8:11], v[240:243], v[68:71]
  buffer_load_dwordx2 v[160:161], v15, s[36:39], s73 offen sc1
  v_mfma_f32_16x16x32_bf16 v[52:55], v[92:95], v[240:243], v[52:55]
  ds_read_b128 v[84:87], v1 offset:30720
  v_mfma_f32_16x16x32_bf16 v[72:75], v[240:243], v[240:243], v[72:75]
  buffer_load_dwordx2 v[162:163], v4, s[36:39], s74 offen sc1
  v_mfma_f32_16x16x32_bf16 v[56:59], v[164:167], v[240:243], v[56:59]
  ds_read_b128 v[92:95], v1 offset:31744
  v_mov_b32 v91, 4
  ds_write_b32 v0, v91
  v_mfma_f32_16x16x32_bf16 v[60:63], v[168:171], v[240:243], v[60:63]
  ds_read_b128 v[164:167], v1 offset:32768
  s_waitcnt lgkmcnt(10)
  v_mfma_f32_16x16x32_bf16 v[64:67], v[16:19], v[240:243], v[64:67]
  ds_read_b128 v[168:171], v1 offset:33792
  s_waitcnt vmcnt(14)
  v_mfma_f32_16x16x32_bf16 v[48:51], v[20:23], v[244:247], v[48:51]
  ds_read_b128 v[16:19], v1 offset:34816
  v_mfma_f32_16x16x32_bf16 v[68:71], v[8:11], v[244:247], v[68:71]
  buffer_load_dword v150, v89, s[36:39], s75 offen sc1
  v_mfma_f32_16x16x32_bf16 v[52:55], v[24:27], v[244:247], v[52:55]
  ds_read_b128 v[20:23], v1 offset:35840
  v_mfma_f32_16x16x32_bf16 v[72:75], v[244:247], v[244:247], v[72:75]
  v_mfma_f32_16x16x32_bf16 v[56:59], v[28:31], v[244:247], v[56:59]
  s_waitcnt lgkmcnt(9)
  v_mfma_f32_16x16x32_bf16 v[60:63], v[32:35], v[244:247], v[60:63]
  v_mfma_f32_16x16x32_bf16 v[64:67], v[36:39], v[244:247], v[64:67]
  s_waitcnt vmcnt(13)
  v_mfma_f32_16x16x32_bf16 v[48:51], v[40:43], v[248:251], v[48:51]
  v_mfma_f32_16x16x32_bf16 v[68:71], v[8:11], v[248:251], v[68:71]
  v_mfma_f32_16x16x32_bf16 v[52:55], v[44:47], v[248:251], v[52:55]
  v_mfma_f32_16x16x32_bf16 v[72:75], v[248:251], v[248:251], v[72:75]
  s_waitcnt lgkmcnt(5)
  v_mfma_f32_16x16x32_bf16 v[56:59], v[76:79], v[248:251], v[56:59]
  v_mfma_f32_16x16x32_bf16 v[60:63], v[80:83], v[248:251], v[60:63]
  v_mfma_f32_16x16x32_bf16 v[64:67], v[84:87], v[248:251], v[64:67]
  s_waitcnt vmcnt(11)
  v_mfma_f32_16x16x32_bf16 v[48:51], v[92:95], v[252:255], v[48:51]
  v_mfma_f32_16x16x32_bf16 v[68:71], v[8:11], v[252:255], v[68:71]
  s_waitcnt lgkmcnt(0)
  v_mfma_f32_16x16x32_bf16 v[52:55], v[164:167], v[252:255], v[52:55]
  v_mfma_f32_16x16x32_bf16 v[72:75], v[252:255], v[252:255], v[72:75]
  v_mfma_f32_16x16x32_bf16 v[56:59], v[168:171], v[252:255], v[56:59]
  v_mfma_f32_16x16x32_bf16 v[60:63], v[16:19], v[252:255], v[60:63]
  v_mfma_f32_16x16x32_bf16 v[64:67], v[20:23], v[252:255], v[64:67]
  v_mov_b32 v91, 5
  ds_write_b32 v0, v91
  s_nop 2
  v_cndmask_b32 v121, v72, v73, s[42:43]
  v_cndmask_b32 v121, v121, v74, s[58:59]
  v_cndmask_b32 v121, v121, v75, s[78:79]
  v_cndmask_b32 v121, 0, v121, s[56:57]
  v_mov_b32 v120, v68
  v_mov_b32 v122, v121
  s_nop 1
  v_permlane16_swap_b32 v121, v122
  v_add_f32 v121, v121, v122
  v_mov_b32 v122, v121
  s_nop 1
  v_permlane32_swap_b32 v121, v122
  v_add_f32 v121, v121, v122
  v_mul_f32 v120, 0x3acccccd, v120
  v_mul_f32 v121, 0x3acccccd, v121
  v_fma_f32 v121, -v120, v120, v121
  v_max_f32 v121, 0, v121
  v_cvt_pk_bf16_f32 v122, v120, v121
  v_lshlrev_b32 v174, 16, v122
  v_and_b32 v123, s40, v122
  v_add_f32 v123, 0x3727c5ac, v123
  v_cvt_pk_bf16_f32 v123, v123, v123
  v_lshlrev_b32 v123, 16, v123
  v_sqrt_f32 v123, v123
  s_nop 0
  v_cvt_pk_bf16_f32 v123, v123, v123
  v_lshlrev_b32 v123, 16, v123
  v_rcp_f32 v175, v123
  v_sub_f32 v120, v120, v174
  v_mul_f32 v120, v120, v175
  v_mul_f32 v121, v121, v175
  v_mul_f32 v121, v121, v175
  v_cvt_pk_bf16_f32 v122, v120, v121
  v_lshlrev_b32 v124, 16, v122
  v_and_b32 v125, s40, v122
  v_add_f32 v125, 0x3727c5ac, v125
  v_cvt_pk_bf16_f32 v125, v125, v125
  v_lshlrev_b32 v125, 16, v125
  v_sqrt_f32 v125, v125
  s_nop 0
  v_cvt_pk_bf16_f32 v125, v125, v125
  v_lshlrev_b32 v125, 16, v125
  v_fma_f32 v12, -v124, v123, -v174
  v_mul_f32 v15, v123, v125
  v_rcp_f32 v122, v15
  s_nop 0
  v_mul_f32 v13, 0xc0135761, v122
  v_mul_f32 v14, v122, v122
  v_mul_f32 v14, v14, v122
  v_mul_f32 v14, 0xbdd2d3e8, v14
  s_lshl_b32 s14, s6, 8
  s_add_u32 s14, s14, 33095680
  s_mov_b64 exec, s[70:71]
  buffer_store_dwordx2 v[174:175], v88, s[36:39], s14 offen sc1
  s_mov_b64 exec, -1
  s_waitcnt vmcnt(7)
  s_waitcnt vmcnt(1)
  s_mov_b32 s13, 0
GG_xr:
  v_cmp_ne_u32 vcc, 0, v150
  s_nop 0
  s_cmp_eq_u64 vcc, -1
  s_cbranch_scc1 GG_xo
  s_add_u32 s13, s13, 1
  s_cmp_ge_u32 s13, 400000
  s_cbranch_scc1 GG_xo
  buffer_load_dword v150, v89, s[36:39], s75 offen sc1
  s_waitcnt vmcnt(0)
  s_branch GG_xr
GG_xo:
  v_cmp_eq_u32 vcc, s30, v150
  s_nop 0
  s_cmp_eq_u64 vcc, -1
  s_cselect_b32 s75, 1, 0
  v_pk_fma_f32 v[128:129], v[12:13], v[96:97], v[48:49] op_sel_hi:[0,1,1]
  v_pk_fma_f32 v[132:133], v[12:13], v[98:99], v[50:51] op_sel_hi:[0,1,1]
  v_pk_mul_f32 v[130:131], v[128:129], v[128:129]
  v_pk_mul_f32 v[134:135], v[132:133], v[132:133]
  v_pk_fma_f32 v[130:131], v[14:15], v[130:131], v[12:13] op_sel:[0,0,1] op_sel_hi:[0,1,1]
  v_pk_fma_f32 v[134:135], v[14:15], v[134:135], v[12:13] op_sel:[0,0,1] op_sel_hi:[0,1,1]
  v_pk_mul_f32 v[130:131], v[130:131], v[128:129]
  v_pk_mul_f32 v[134:135], v[134:135], v[132:133]
  v_exp_f32 v130, v130
  v_exp_f32 v134, v134
  v_exp_f32 v131, v131
  v_exp_f32 v135, v135
  v_pk_fma_f32 v[130:131], v[130:131], v[14:15], v[14:15] op_sel:[0,1,1] op_sel_hi:[1,1,1]
  v_pk_fma_f32 v[134:135], v[134:135], v[14:15], v[14:15] op_sel:[0,1,1] op_sel_hi:[1,1,1]
  v_rcp_f32 v130, v130
  v_rcp_f32 v134, v134
  v_rcp_f32 v131, v131
  v_rcp_f32 v135, v135
  v_pk_mul_f32 v[128:129], v[128:129], v[130:131]
  v_pk_mul_f32 v[132:133], v[132:133], v[134:135]
  v_cvt_pk_bf16_f32 v136, v128, v129
  v_cvt_pk_bf16_f32 v137, v132, v133
  v_cndmask_b32 v136, 0, v136, s[60:61]
  v_cndmask_b32 v137, 0, v137, s[60:61]
  v_pk_fma_f32 v[128:129], v[12:13], v[100:101], v[52:53] op_sel_hi:[0,1,1]
  v_pk_fma_f32 v[132:133], v[12:13], v[102:103], v[54:55] op_sel_hi:[0,1,1]
  v_pk_mul_f32 v[130:131], v[128:129], v[128:129]
  v_pk_mul_f32 v[134:135], v[132:133], v[132:133]
  v_pk_fma_f32 v[130:131], v[14:15], v[130:131], v[12:13] op_sel:[0,0,1] op_sel_hi:[0,1,1]
  v_pk_fma_f32 v[134:135], v[14:15], v[134:135], v[12:13] op_sel:[0,0,1] op_sel_hi:[0,1,1]
  v_pk_mul_f32 v[130:131], v[130:131], v[128:129]
  v_pk_mul_f32 v[134:135], v[134:135], v[132:133]
  v_exp_f32 v130, v130
  v_exp_f32 v134, v134
  v_exp_f32 v131, v131
  v_exp_f32 v135, v135
  v_pk_fma_f32 v[130:131], v[130:131], v[14:15], v[14:15] op_sel:[0,1,1] op_sel_hi:[1,1,1]
  v_pk_fma_f32 v[134:135], v[134:135], v[14:15], v[14:15] op_sel:[0,1,1] op_sel_hi:[1,1,1]
  v_rcp_f32 v130, v130
  v_rcp_f32 v134, v134
  v_rcp_f32 v131, v131
  v_rcp_f32 v135, v135
  v_pk_mul_f32 v[128:129], v[128:129], v[130:131]
  v_pk_mul_f32 v[132:133], v[132:133], v[134:135]
  v_cvt_pk_bf16_f32 v138, v128, v129
  v_cvt_pk_bf16_f32 v139, v132, v133
  v_cndmask_b32 v138, 0, v138, s[60:61]
  v_cndmask_b32 v139, 0, v139, s[60:61]
  buffer_store_dwordx4 v[136:139], v5, s[36:39], s53 offen sc1
  v_pk_fma_f32 v[128:129], v[12:13], v[104:105], v[56:57] op_sel_hi:[0,1,1]
  v_pk_fma_f32 v[132:133], v[12:13], v[106:107], v[58:59] op_sel_hi:[0,1,1]
  v_pk_mul_f32 v[130:131], v[128:129], v[128:129]
  v_pk_mul_f32 v[134:135], v[132:133], v[132:133]
  v_pk_fma_f32 v[130:131], v[14:15], v[130:131], v[12:13] op_sel:[0,0,1] op_sel_hi:[0,1,1]
  v_pk_fma_f32 v[134:135], v[14:15], v[134:135], v[12:13] op_sel:[0,0,1] op_sel_hi:[0,1,1]
  v_pk_mul_f32 v[130:131], v[130:131], v[128:129]
  v_pk_mul_f32 v[134:135], v[134:135], v[132:133]
  v_exp_f32 v130, v130
  v_exp_f32 v134, v134
  v_exp_f32 v131, v131
  v_exp_f32 v135, v135
  v_pk_fma_f32 v[130:131], v[130:131], v[14:15], v[14:15] op_sel:[0,1,1] op_sel_hi:[1,1,1]
  v_pk_fma_f32 v[134:135], v[134:135], v[14:15], v[14:15] op_sel:[0,1,1] op_sel_hi:[1,1,1]
  v_rcp_f32 v130, v130
  v_rcp_f32 v134, v134
  v_rcp_f32 v131, v131
  v_rcp_f32 v135, v135
  v_pk_mul_f32 v[128:129], v[128:129], v[130:131]
  v_pk_mul_f32 v[132:133], v[132:133], v[134:135]
  v_cvt_pk_bf16_f32 v136, v128, v129
  v_cvt_pk_bf16_f32 v137, v132, v133
  v_cndmask_b32 v136, 0, v136, s[60:61]
  v_cndmask_b32 v137, 0, v137, s[60:61]
  v_pk_fma_f32 v[128:129], v[12:13], v[108:109], v[60:61] op_sel_hi:[0,1,1]
  v_pk_fma_f32 v[132:133], v[12:13], v[110:111], v[62:63] op_sel_hi:[0,1,1]
  v_pk_mul_f32 v[130:131], v[128:129], v[128:129]
  v_pk_mul_f32 v[134:135], v[132:133], v[132:133]
  v_pk_fma_f32 v[130:131], v[14:15], v[130:131], v[12:13] op_sel:[0,0,1] op_sel_hi:[0,1,1]
  v_pk_fma_f32 v[134:135], v[14:15], v[134:135], v[12:13] op_sel:[0,0,1] op_sel_hi:[0,1,1]
  v_pk_mul_f32 v[130:131], v[130:131], v[128:129]
  v_pk_mul_f32 v[134:135], v[134:135], v[132:133]
  v_exp_f32 v130, v130
  v_exp_f32 v134, v134
  v_exp_f32 v131, v131
  v_exp_f32 v135, v135
  v_pk_fma_f32 v[130:131], v[130:131], v[14:15], v[14:15] op_sel:[0,1,1] op_sel_hi:[1,1,1]
  v_pk_fma_f32 v[134:135], v[134:135], v[14:15], v[14:15] op_sel:[0,1,1] op_sel_hi:[1,1,1]
  v_rcp_f32 v130, v130
  v_rcp_f32 v134, v134
  v_rcp_f32 v131, v131
  v_rcp_f32 v135, v135
  v_pk_mul_f32 v[128:129], v[128:129], v[130:131]
  v_pk_mul_f32 v[132:133], v[132:133], v[134:135]
  v_cvt_pk_bf16_f32 v138, v128, v129
  v_cvt_pk_bf16_f32 v139, v132, v133
  v_cndmask_b32 v138, 0, v138, s[60:61]
  v_cndmask_b32 v139, 0, v139, s[60:61]
  buffer_store_dwordx4 v[136:139], v5, s[36:39], s54 offen sc1
  v_pk_fma_f32 v[128:129], v[12:13], v[112:113], v[64:65] op_sel_hi:[0,1,1]
  v_pk_fma_f32 v[132:133], v[12:13], v[114:115], v[66:67] op_sel_hi:[0,1,1]
  v_pk_mul_f32 v[130:131], v[128:129], v[128:129]
  v_pk_mul_f32 v[134:135], v[132:133], v[132:133]
  v_pk_fma_f32 v[130:131], v[14:15], v[130:131], v[12:13] op_sel:[0,0,1] op_sel_hi:[0,1,1]
  v_pk_fma_f32 v[134:135], v[14:15], v[134:135], v[12:13] op_sel:[0,0,1] op_sel_hi:[0,1,1]
  v_pk_mul_f32 v[130:131], v[130:131], v[128:129]
  v_pk_mul_f32 v[134:135], v[134:135], v[132:133]
  v_exp_f32 v130, v130
  v_exp_f32 v134, v134
  v_exp_f32 v131, v131
  v_exp_f32 v135, v135
  v_pk_fma_f32 v[130:131], v[130:131], v[14:15], v[14:15] op_sel:[0,1,1] op_sel_hi:[1,1,1]
  v_pk_fma_f32 v[134:135], v[134:135], v[14:15], v[14:15] op_sel:[0,1,1] op_sel_hi:[1,1,1]
  v_rcp_f32 v130, v130
  v_rcp_f32 v134, v134
  v_rcp_f32 v131, v131
  v_rcp_f32 v135, v135
  v_pk_mul_f32 v[128:129], v[128:129], v[130:131]
  v_pk_mul_f32 v[132:133], v[132:133], v[134:135]
  v_cvt_pk_bf16_f32 v136, v128, v129
  v_cvt_pk_bf16_f32 v137, v132, v133
  v_cndmask_b32 v136, 0, v136, s[60:61]
  v_cndmask_b32 v137, 0, v137, s[60:61]
  buffer_store_dwordx2 v[136:137], v151, s[36:39], s55 offen sc1
  v_lshlrev_b32 v127, 3, v6
  v_add_u32 v127, 8, v127
  v_cmp_eq_u32 vcc, 15, v6
  v_mov_b32 v126, 240
  s_nop 0
  v_cndmask_b32 v127, v127, v126, vcc
  buffer_load_dwordx2 v[174:175], v127, s[36:39], s14 offen sc1
  s_waitcnt vmcnt(1)
  s_lshl_b32 s12, s6, 7
  s_lshl_b32 s13, s5, 2
  s_add_u32 s12, s12, s13
  s_add_u32 s12, s12, 33030144
  v_mov_b32 v148, 1
  v_mov_b32 v149, 0
  s_mov_b64 exec, 1
  s_cmp_lg_u32 s75, 0
  s_cbranch_scc1 GG_ff1
  buffer_store_dword v148, v149, s[36:39], s12 offen sc1
  s_branch GG_fe1
GG_ff1:
  buffer_store_dword v148, v149, s[36:39], s12 offen
GG_fe1:
  s_mov_b64 exec, -1
  s_mov_b32 s7, s17
  s_add_u32 s17, s69, 0
  s_mov_b32 s8, s7
  s_add_u32 s9, s7, 337920
  s_mul_i32 s12, s65, 84480
  s_add_u32 s7, s7, s12
  s_sub_u32 s7, s7, 16896
  s_add_u32 s54, s17, s62
  s_add_u32 s55, s17, s63
  s_add_u32 s56, s17, s64
  v_lshlrev_b32 v126, 5, v7
  s_mul_i32 s51, s25, 384
  s_add_u32 s51, s51, 32571392
  s_cmp_ge_u32 s77, 6
  s_cbranch_scc1 GG_ro6
GG_rd6:
  ds_read_b128 v[140:143], v153
  s_add_u32 s76, s76, 1
  s_waitcnt lgkmcnt(0)
  v_min_u32 v140, v140, v141
  v_min3_u32 v140, v140, v142, v143
  s_nop 0
  v_readfirstlane_b32 s77, v140
  s_nop 0
  s_cmp_ge_u32 s77, 6
  s_cbranch_scc1 GG_ro6
  s_cmp_lt_u32 s76, 8388608
  s_cbranch_scc1 GG_rd6
GG_ro6:
  ds_read_b128 v[16:19], v1 offset:36864
  ds_read_b128 v[20:23], v1 offset:37888
  ds_read_b128 v[24:27], v1 offset:38912
  ds_read_b128 v[28:31], v1 offset:39936
  ds_read_b128 v[32:35], v1 offset:40960
  ds_read_b128 v[36:39], v1 offset:41984
  ds_read_b128 v[40:43], v1 offset:43008
  ds_read_b128 v[44:47], v1 offset:44032
  ds_read_b128 v[88:91], v1 offset:45056
  ds_read_b128 v[92:95], v1 offset:46080
  ds_read_b128 v[136:139], v1 offset:47104
  s_waitcnt vmcnt(1)
  s_mov_b32 s13, 0
GG_s1:
  v_cmp_ne_u32 vcc, 0, v175
  s_add_u32 s13, s13, 1
  s_cmp_eq_u64 vcc, -1
  s_cbranch_scc1 GG_s1o
  s_cmp_ge_u32 s13, 400000
  s_cbranch_scc1 GG_s1o
  buffer_load_dwordx2 v[174:175], v127, s[36:39], s14 offen sc1
  s_waitcnt vmcnt(0)
  s_branch GG_s1
GG_s1o:
  v_lshlrev_b32 v68, 16, v154
  v_and_b32 v69, s40, v154
  v_pk_add_f32 v[68:69], v[68:69], v[174:175] op_sel_hi:[1,0] neg_lo:[0,1] neg_hi:[0,1]
  v_cvt_pk_bf16_f32 v128, v68, v69
  v_lshlrev_b32 v68, 16, v128
  v_and_b32 v69, s40, v128
  v_pk_mul_f32 v[68:69], v[68:69], v[174:175] op_sel:[0,1] op_sel_hi:[1,1]
  v_cvt_pk_bf16_f32 v128, v68, v69
  v_lshlrev_b32 v68, 16, v128
  v_and_b32 v69, s40, v128
  v_lshlrev_b32 v70, 16, v155
  v_and_b32 v71, s40, v155
  v_pk_add_f32 v[70:71], v[70:71], v[174:175] op_sel_hi:[1,0] neg_lo:[0,1] neg_hi:[0,1]
  v_cvt_pk_bf16_f32 v129, v70, v71
  v_lshlrev_b32 v70, 16, v129
  v_and_b32 v71, s40, v129
  v_pk_mul_f32 v[70:71], v[70:71], v[174:175] op_sel:[0,1] op_sel_hi:[1,1]
  v_cvt_pk_bf16_f32 v129, v70, v71
  v_lshlrev_b32 v70, 16, v129
  v_and_b32 v71, s40, v129
  v_lshlrev_b32 v72, 16, v156
  v_and_b32 v73, s40, v156
  v_pk_add_f32 v[72:73], v[72:73], v[174:175] op_sel_hi:[1,0] neg_lo:[0,1] neg_hi:[0,1]
  v_cvt_pk_bf16_f32 v130, v72, v73
  v_lshlrev_b32 v72, 16, v130
  v_and_b32 v73, s40, v130
  v_pk_mul_f32 v[72:73], v[72:73], v[174:175] op_sel:[0,1] op_sel_hi:[1,1]
  v_cvt_pk_bf16_f32 v130, v72, v73
  v_lshlrev_b32 v72, 16, v130
  v_and_b32 v73, s40, v130
  v_lshlrev_b32 v74, 16, v157
  v_and_b32 v75, s40, v157
  v_pk_add_f32 v[74:75], v[74:75], v[174:175] op_sel_hi:[1,0] neg_lo:[0,1] neg_hi:[0,1]
  v_cvt_pk_bf16_f32 v131, v74, v75
  v_lshlrev_b32 v74, 16, v131
  v_and_b32 v75, s40, v131
  v_pk_mul_f32 v[74:75], v[74:75], v[174:175] op_sel:[0,1] op_sel_hi:[1,1]
  v_cvt_pk_bf16_f32 v131, v74, v75
  v_lshlrev_b32 v74, 16, v131
  v_and_b32 v75, s40, v131
  v_lshlrev_b32 v76, 16, v158
  v_and_b32 v77, s40, v158
  v_pk_add_f32 v[76:77], v[76:77], v[174:175] op_sel_hi:[1,0] neg_lo:[0,1] neg_hi:[0,1]
  v_cvt_pk_bf16_f32 v128, v76, v77
  v_lshlrev_b32 v76, 16, v128
  v_and_b32 v77, s40, v128
  v_pk_mul_f32 v[76:77], v[76:77], v[174:175] op_sel:[0,1] op_sel_hi:[1,1]
  v_cvt_pk_bf16_f32 v128, v76, v77
  v_lshlrev_b32 v76, 16, v128
  v_and_b32 v77, s40, v128
  v_lshlrev_b32 v78, 16, v159
  v_and_b32 v79, s40, v159
  v_pk_add_f32 v[78:79], v[78:79], v[174:175] op_sel_hi:[1,0] neg_lo:[0,1] neg_hi:[0,1]
  v_cvt_pk_bf16_f32 v129, v78, v79
  v_lshlrev_b32 v78, 16, v129
  v_and_b32 v79, s40, v129
  v_pk_mul_f32 v[78:79], v[78:79], v[174:175] op_sel:[0,1] op_sel_hi:[1,1]
  v_cvt_pk_bf16_f32 v129, v78, v79
  v_lshlrev_b32 v78, 16, v129
  v_and_b32 v79, s40, v129
  v_lshlrev_b32 v80, 16, v160
  v_and_b32 v81, s40, v160
  v_pk_add_f32 v[80:81], v[80:81], v[174:175] op_sel_hi:[1,0] neg_lo:[0,1] neg_hi:[0,1]
  v_cvt_pk_bf16_f32 v130, v80, v81
  v_lshlrev_b32 v80, 16, v130
  v_and_b32 v81, s40, v130
  v_pk_mul_f32 v[80:81], v[80:81], v[174:175] op_sel:[0,1] op_sel_hi:[1,1]
  v_cvt_pk_bf16_f32 v130, v80, v81
  v_lshlrev_b32 v80, 16, v130
  v_and_b32 v81, s40, v130
  v_lshlrev_b32 v82, 16, v161
  v_and_b32 v83, s40, v161
  v_pk_add_f32 v[82:83], v[82:83], v[174:175] op_sel_hi:[1,0] neg_lo:[0,1] neg_hi:[0,1]
  v_cvt_pk_bf16_f32 v131, v82, v83
  v_lshlrev_b32 v82, 16, v131
  v_and_b32 v83, s40, v131
  v_pk_mul_f32 v[82:83], v[82:83], v[174:175] op_sel:[0,1] op_sel_hi:[1,1]
  v_cvt_pk_bf16_f32 v131, v82, v83
  v_lshlrev_b32 v82, 16, v131
  v_and_b32 v83, s40, v131
  v_lshlrev_b32 v84, 16, v162
  v_and_b32 v85, s40, v162
  v_pk_add_f32 v[84:85], v[84:85], v[174:175] op_sel_hi:[1,0] neg_lo:[0,1] neg_hi:[0,1]
  v_cvt_pk_bf16_f32 v128, v84, v85
  v_lshlrev_b32 v84, 16, v128
  v_and_b32 v85, s40, v128
  v_pk_mul_f32 v[84:85], v[84:85], v[174:175] op_sel:[0,1] op_sel_hi:[1,1]
  v_cvt_pk_bf16_f32 v128, v84, v85
  v_lshlrev_b32 v84, 16, v128
  v_and_b32 v85, s40, v128
  v_lshlrev_b32 v86, 16, v163
  v_and_b32 v87, s40, v163
  v_pk_add_f32 v[86:87], v[86:87], v[174:175] op_sel_hi:[1,0] neg_lo:[0,1] neg_hi:[0,1]
  v_cvt_pk_bf16_f32 v129, v86, v87
  v_lshlrev_b32 v86, 16, v129
  v_and_b32 v87, s40, v129
  v_pk_mul_f32 v[86:87], v[86:87], v[174:175] op_sel:[0,1] op_sel_hi:[1,1]
  v_cvt_pk_bf16_f32 v129, v86, v87
  v_lshlrev_b32 v86, 16, v129
  v_and_b32 v87, s40, v129
  s_lshl_b32 s12, s6, 7
  s_add_u32 s12, s12, 33030144
  v_and_b32 v149, 7, v2
  v_lshl_add_u32 v149, v149, 2, s12
  s_mov_b32 s13, 0
  s_mov_b64 exec, 0xffff
GG_poll1:
  buffer_load_dword v148, v149, s[36:39], 0 offen sc1
  s_waitcnt vmcnt(0)
  v_cmp_ne_u32 vcc, 0, v148
  s_add_u32 s13, s13, 1
  s_cmp_eq_u64 vcc, exec
  s_cbranch_scc1 GG_np1
  s_nop 0
  s_cmp_lt_u32 s13, 400000
  s_cbranch_scc1 GG_poll1
GG_np1:
  s_mov_b64 exec, -1
  s_add_u32 s7, s7, 16896
  buffer_load_dwordx4 v[176:179], v5, s[36:39], s7 offen offset:0 sc1
  s_add_u32 s7, s7, 16896
  buffer_load_dwordx4 v[180:183], v5, s[36:39], s7 offen offset:0 sc1
  s_add_u32 s7, s7, 16896
  s_lshl_b32 s11, s68, 7
  s_sub_u32 s11, s7, s11
  buffer_load_dwordx2 v[184:185], v151, s[36:39], s11 offen offset:0 sc1
  buffer_load_dwordx2 v[186:187], v151, s[36:39], s11 offen offset:2048 sc1
  s_add_u32 s7, s7, 16896
  buffer_load_dwordx4 v[188:191], v5, s[36:39], s7 offen offset:0 sc1
  s_add_u32 s7, s7, 16896
  buffer_load_dwordx4 v[192:195], v5, s[36:39], s7 offen offset:0 sc1
  s_waitcnt lgkmcnt(7)
  s_waitcnt vmcnt(5)
  v_mfma_f32_16x16x32_bf16 v[48:51], v[16:19], v[176:179], 0
  ds_read_b128 v[144:147], v1 offset:48128
  s_add_u32 s7, s7, 16896
  s_cmp_eq_u32 s7, s9
  s_cselect_b32 s7, s8, s7
  buffer_load_dwordx4 v[196:199], v5, s[36:39], s7 offen offset:0 sc1
  v_mfma_f32_16x16x32_bf16 v[52:55], v[20:23], v[176:179], 0
  ds_read_b128 v[16:19], v1 offset:49152
  s_add_u32 s7, s7, 16896
  buffer_load_dwordx4 v[200:203], v5, s[36:39], s7 offen offset:0 sc1
  v_mfma_f32_16x16x32_bf16 v[56:59], v[24:27], v[176:179], 0
  ds_read_b128 v[20:23], v1 offset:50176
  s_add_u32 s7, s7, 16896
  s_lshl_b32 s11, s68, 7
  s_sub_u32 s11, s7, s11
  buffer_load_dwordx2 v[204:205], v151, s[36:39], s11 offen offset:0 sc1
  v_mfma_f32_16x16x32_bf16 v[60:63], v[28:31], v[176:179], 0
  ds_read_b128 v[24:27], v1 offset:51200
  buffer_load_dwordx2 v[206:207], v151, s[36:39], s11 offen offset:2048 sc1
  s_waitcnt lgkmcnt(7)
  v_mfma_f32_16x16x32_bf16 v[64:67], v[32:35], v[176:179], 0
  ds_read_b128 v[28:31], v1 offset:52224
  s_add_u32 s7, s7, 16896
  buffer_load_dwordx4 v[208:211], v5, s[36:39], s7 offen offset:0 sc1
  s_waitcnt vmcnt(9)
  v_mfma_f32_16x16x32_bf16 v[48:51], v[36:39], v[180:183], v[48:51]
  ds_read_b128 v[32:35], v1 offset:53248
  s_add_u32 s7, s7, 16896
  buffer_load_dwordx4 v[212:215], v5, s[36:39], s7 offen offset:0 sc1
  v_mfma_f32_16x16x32_bf16 v[52:55], v[40:43], v[180:183], v[52:55]
  ds_read_b128 v[36:39], v1 offset:54272
  v_mfma_f32_16x16x32_bf16 v[56:59], v[44:47], v[180:183], v[56:59]
  ds_read_b128 v[40:43], v1 offset:55296
  s_waitcnt lgkmcnt(7)
  v_mfma_f32_16x16x32_bf16 v[60:63], v[88:91], v[180:183], v[60:63]
  ds_read_b128 v[44:47], v1 offset:56320
  v_mfma_f32_16x16x32_bf16 v[64:67], v[92:95], v[180:183], v[64:67]
  s_cmp_ge_u32 s77, 7
  s_cbranch_scc1 GG_ro7
GG_rd7:
  ds_read_b128 v[140:143], v153
  s_add_u32 s76, s76, 1
  s_waitcnt lgkmcnt(0)
  v_min_u32 v140, v140, v141
  v_min3_u32 v140, v140, v142, v143
  s_nop 0
  v_readfirstlane_b32 s77, v140
  s_nop 0
  s_cmp_ge_u32 s77, 7
  s_cbranch_scc1 GG_ro7
  s_cmp_lt_u32 s76, 8388608
  s_cbranch_scc1 GG_rd7
GG_ro7:
  ds_read_b128 v[88:91], v1 offset:57344
  s_waitcnt vmcnt(8)
  v_mfma_f32_16x16x32_bf16 v[48:51], v[136:139], v[184:187], v[48:51]
  ds_read_b128 v[92:95], v1 offset:58368
  s_add_u32 s7, s7, 16896
  s_cmp_eq_u32 s7, s9
  s_cselect_b32 s7, s8, s7
  buffer_load_dwordx4 v[216:219], v5, s[36:39], s7 offen offset:0 sc1
  v_mfma_f32_16x16x32_bf16 v[52:55], v[144:147], v[184:187], v[52:55]
  ds_read_b128 v[136:139], v1 offset:59392
  s_add_u32 s7, s7, 16896
  buffer_load_dwordx4 v[220:223], v5, s[36:39], s7 offen offset:0 sc1
  s_waitcnt lgkmcnt(7)
  v_mfma_f32_16x16x32_bf16 v[56:59], v[16:19], v[184:187], v[56:59]
  ds_read_b128 v[144:147], v1 offset:60416
  v_mfma_f32_16x16x32_bf16 v[60:63], v[20:23], v[184:187], v[60:63]
  ds_read_b128 v[16:19], v1 offset:61440
  v_mfma_f32_16x16x32_bf16 v[64:67], v[24:27], v[184:187], v[64:67]
  ds_read_b128 v[20:23], v1 offset:62464
  s_waitcnt vmcnt(9)
  v_mfma_f32_16x16x32_bf16 v[48:51], v[28:31], v[188:191], v[48:51]
  ds_read_b128 v[24:27], v1 offset:63488
  s_add_u32 s7, s7, 16896
  s_lshl_b32 s11, s68, 7
  s_sub_u32 s11, s7, s11
  buffer_load_dwordx2 v[224:225], v151, s[36:39], s11 offen offset:0 sc1
  s_waitcnt lgkmcnt(7)
  v_mfma_f32_16x16x32_bf16 v[52:55], v[32:35], v[188:191], v[52:55]
  ds_read_b128 v[28:31], v1 offset:64512
  v_mfma_f32_16x16x32_bf16 v[56:59], v[36:39], v[188:191], v[56:59]
  ds_read_b128 v[32:35], v152 offset:0
  v_mfma_f32_16x16x32_bf16 v[60:63], v[40:43], v[188:191], v[60:63]
  ds_read_b128 v[36:39], v152 offset:1024
  v_mfma_f32_16x16x32_bf16 v[64:67], v[44:47], v[188:191], v[64:67]
  ds_read_b128 v[40:43], v152 offset:2048
  s_waitcnt lgkmcnt(7)
  s_waitcnt vmcnt(9)
  v_mfma_f32_16x16x32_bf16 v[48:51], v[88:91], v[192:195], v[48:51]
  ds_read_b128 v[44:47], v152 offset:3072
  buffer_load_dwordx2 v[226:227], v151, s[36:39], s11 offen offset:2048 sc1
  v_mfma_f32_16x16x32_bf16 v[52:55], v[92:95], v[192:195], v[52:55]
  ds_read_b128 v[88:91], v152 offset:4096
  v_mov_b32 v9, 6
  ds_write_b32 v0, v9
  v_mfma_f32_16x16x32_bf16 v[56:59], v[136:139], v[192:195], v[56:59]
  ds_read_b128 v[92:95], v152 offset:5120
  v_mfma_f32_16x16x32_bf16 v[60:63], v[144:147], v[192:195], v[60:63]
  ds_read_b128 v[136:139], v152 offset:6144
  s_waitcnt lgkmcnt(8)
  v_mfma_f32_16x16x32_bf16 v[64:67], v[16:19], v[192:195], v[64:67]
  ds_read_b128 v[144:147], v152 offset:7168
  s_waitcnt vmcnt(9)
  v_mfma_f32_16x16x32_bf16 v[48:51], v[20:23], v[196:199], v[48:51]
  ds_read_b128 v[16:19], v152 offset:8192
  s_add_u32 s7, s7, 16896
  buffer_load_dwordx4 v[228:231], v5, s[36:39], s7 offen offset:0 sc1
  v_mfma_f32_16x16x32_bf16 v[52:55], v[24:27], v[196:199], v[52:55]
  ds_read_b128 v[20:23], v152 offset:9216
  v_mfma_f32_16x16x32_bf16 v[56:59], v[28:31], v[196:199], v[56:59]
  ds_read_b128 v[24:27], v152 offset:10240
  s_waitcnt lgkmcnt(8)
  v_mfma_f32_16x16x32_bf16 v[60:63], v[32:35], v[196:199], v[60:63]
  ds_read_b128 v[28:31], v152 offset:11264
  v_mfma_f32_16x16x32_bf16 v[64:67], v[36:39], v[196:199], v[64:67]
  s_cmp_ge_u32 s77, 8
  s_cbranch_scc1 GG_ro8
GG_rd8:
  ds_read_b128 v[140:143], v153
  s_add_u32 s76, s76, 1
  s_waitcnt lgkmcnt(0)
  v_min_u32 v140, v140, v141
  v_min3_u32 v140, v140, v142, v143
  s_nop 0
  v_readfirstlane_b32 s77, v140
  s_nop 0
  s_cmp_ge_u32 s77, 8
  s_cbranch_scc1 GG_ro8
  s_cmp_lt_u32 s76, 8388608
  s_cbranch_scc1 GG_rd8
GG_ro8:
  ds_read_b128 v[32:35], v3 offset:0
  s_waitcnt vmcnt(9)
  v_mfma_f32_16x16x32_bf16 v[48:51], v[40:43], v[200:203], v[48:51]
  ds_read_b128 v[36:39], v3 offset:1024
  s_add_u32 s7, s7, 16896
  buffer_load_dwordx4 v[232:235], v5, s[36:39], s7 offen offset:0 sc1
  v_mfma_f32_16x16x32_bf16 v[52:55], v[44:47], v[200:203], v[52:55]
  ds_read_b128 v[40:43], v3 offset:2048
  s_waitcnt lgkmcnt(7)
  v_mfma_f32_16x16x32_bf16 v[56:59], v[88:91], v[200:203], v[56:59]
  ds_read_b128 v[44:47], v3 offset:3072
  v_mfma_f32_16x16x32_bf16 v[60:63], v[92:95], v[200:203], v[60:63]
  ds_read_b128 v[88:91], v3 offset:4096
  v_mfma_f32_16x16x32_bf16 v[64:67], v[136:139], v[200:203], v[64:67]
  ds_read_b128 v[92:95], v3 offset:5120
  s_waitcnt vmcnt(8)
  v_mfma_f32_16x16x32_bf16 v[48:51], v[144:147], v[204:207], v[48:51]
  ds_read_b128 v[136:139], v3 offset:6144
  s_add_u32 s7, s7, 16896
  s_cmp_eq_u32 s7, s9
  s_cselect_b32 s7, s8, s7
  buffer_load_dwordx4 v[236:239], v5, s[36:39], s7 offen offset:0 sc1
  s_waitcnt lgkmcnt(7)
  v_mfma_f32_16x16x32_bf16 v[52:55], v[16:19], v[204:207], v[52:55]
  ds_read_b128 v[144:147], v3 offset:7168
  s_add_u32 s7, s7, 16896
  buffer_load_dwordx4 v[240:243], v5, s[36:39], s7 offen offset:0 sc1
  v_mfma_f32_16x16x32_bf16 v[56:59], v[20:23], v[204:207], v[56:59]
  ds_read_b128 v[16:19], v3 offset:8192
  v_mfma_f32_16x16x32_bf16 v[60:63], v[24:27], v[204:207], v[60:63]
  ds_read_b128 v[20:23], v3 offset:9216
  v_mfma_f32_16x16x32_bf16 v[64:67], v[28:31], v[204:207], v[64:67]
  ds_read_b128 v[24:27], v3 offset:10240
  s_waitcnt lgkmcnt(7)
  s_waitcnt vmcnt(9)
  v_mfma_f32_16x16x32_bf16 v[48:51], v[32:35], v[208:211], v[48:51]
  ds_read_b128 v[28:31], v3 offset:11264
  s_add_u32 s7, s7, 16896
  s_lshl_b32 s11, s68, 7
  s_sub_u32 s11, s7, s11
  buffer_load_dwordx2 v[244:245], v151, s[36:39], s11 offen offset:0 sc1
  v_mfma_f32_16x16x32_bf16 v[52:55], v[36:39], v[208:211], v[52:55]
  ds_read_b128 v[32:35], v3 offset:12288
  v_mov_b32 v9, 7
  ds_write_b32 v0, v9
  v_mfma_f32_16x16x32_bf16 v[56:59], v[40:43], v[208:211], v[56:59]
  ds_read_b128 v[36:39], v3 offset:13312
  v_mfma_f32_16x16x32_bf16 v[60:63], v[44:47], v[208:211], v[60:63]
  ds_read_b128 v[40:43], v3 offset:14336
  s_waitcnt lgkmcnt(8)
  v_mfma_f32_16x16x32_bf16 v[64:67], v[88:91], v[208:211], v[64:67]
  ds_read_b128 v[44:47], v3 offset:15360
  s_waitcnt vmcnt(9)
  v_mfma_f32_16x16x32_bf16 v[48:51], v[92:95], v[212:215], v[48:51]
  ds_read_b128 v[88:91], v3 offset:16384
  buffer_load_dwordx2 v[246:247], v151, s[36:39], s11 offen offset:2048 sc1
  v_mfma_f32_16x16x32_bf16 v[52:55], v[136:139], v[212:215], v[52:55]
  ds_read_b128 v[92:95], v3 offset:17408
  v_mfma_f32_16x16x32_bf16 v[56:59], v[144:147], v[212:215], v[56:59]
  ds_read_b128 v[136:139], v3 offset:18432
  s_waitcnt lgkmcnt(8)
  v_mfma_f32_16x16x32_bf16 v[60:63], v[16:19], v[212:215], v[60:63]
  ds_read_b128 v[144:147], v3 offset:19456
  v_mfma_f32_16x16x32_bf16 v[64:67], v[20:23], v[212:215], v[64:67]
  s_cmp_ge_u32 s77, 9
  s_cbranch_scc1 GG_ro9
GG_rd9:
  ds_read_b128 v[140:143], v153
  s_add_u32 s76, s76, 1
  s_waitcnt lgkmcnt(0)
  v_min_u32 v140, v140, v141
  v_min3_u32 v140, v140, v142, v143
  s_nop 0
  v_readfirstlane_b32 s77, v140
  s_nop 0
  s_cmp_ge_u32 s77, 9
  s_cbranch_scc1 GG_ro9
  s_cmp_lt_u32 s76, 8388608
  s_cbranch_scc1 GG_rd9
GG_ro9:
  ds_read_b128 v[16:19], v3 offset:20480
  s_waitcnt vmcnt(9)
  v_mfma_f32_16x16x32_bf16 v[48:51], v[24:27], v[216:219], v[48:51]
  ds_read_b128 v[20:23], v3 offset:21504
  s_add_u32 s7, s7, 16896
  buffer_load_dwordx4 v[248:251], v5, s[36:39], s7 offen offset:0 sc1
  v_mfma_f32_16x16x32_bf16 v[52:55], v[28:31], v[216:219], v[52:55]
  ds_read_b128 v[24:27], v3 offset:22528
  s_waitcnt lgkmcnt(7)
  v_mfma_f32_16x16x32_bf16 v[56:59], v[32:35], v[216:219], v[56:59]
  ds_read_b128 v[28:31], v3 offset:23552
  v_mfma_f32_16x16x32_bf16 v[60:63], v[36:39], v[216:219], v[60:63]
  ds_read_b128 v[32:35], v3 offset:24576
  v_mfma_f32_16x16x32_bf16 v[64:67], v[40:43], v[216:219], v[64:67]
  ds_read_b128 v[36:39], v3 offset:25600
  s_waitcnt vmcnt(9)
  v_mfma_f32_16x16x32_bf16 v[48:51], v[44:47], v[220:223], v[48:51]
  ds_read_b128 v[40:43], v3 offset:26624
  s_add_u32 s7, s7, 16896
  buffer_load_dwordx4 v[252:255], v5, s[36:39], s7 offen offset:0 sc1
  s_waitcnt lgkmcnt(7)
  v_mfma_f32_16x16x32_bf16 v[52:55], v[88:91], v[220:223], v[52:55]
  ds_read_b128 v[44:47], v3 offset:27648
  v_mfma_f32_16x16x32_bf16 v[56:59], v[92:95], v[220:223], v[56:59]
  ds_read_b128 v[88:91], v3 offset:28672
  v_mfma_f32_16x16x32_bf16 v[60:63], v[136:139], v[220:223], v[60:63]
  ds_read_b128 v[92:95], v3 offset:29696
  v_mfma_f32_16x16x32_bf16 v[64:67], v[144:147], v[220:223], v[64:67]
  ds_read_b128 v[136:139], v3 offset:30720
  s_waitcnt lgkmcnt(7)
  s_waitcnt vmcnt(8)
  v_mfma_f32_16x16x32_bf16 v[48:51], v[16:19], v[224:227], v[48:51]
  ds_read_b128 v[144:147], v3 offset:31744
  buffer_load_dwordx4 v[96:99], v126, s[36:39], s51 offen offset:0 sc1
  v_mfma_f32_16x16x32_bf16 v[52:55], v[20:23], v[224:227], v[52:55]
  ds_read_b128 v[16:19], v3 offset:32768
  buffer_load_dwordx4 v[100:103], v126, s[36:39], s51 offen offset:16 sc1
  v_mfma_f32_16x16x32_bf16 v[56:59], v[24:27], v[224:227], v[56:59]
  ds_read_b128 v[20:23], v3 offset:33792
  v_mov_b32 v9, 8
  ds_write_b32 v0, v9
  v_mfma_f32_16x16x32_bf16 v[60:63], v[28:31], v[224:227], v[60:63]
  ds_read_b128 v[24:27], v3 offset:34816
  s_waitcnt lgkmcnt(8)
  v_mfma_f32_16x16x32_bf16 v[64:67], v[32:35], v[224:227], v[64:67]
  ds_read_b128 v[28:31], v3 offset:35840
  s_waitcnt vmcnt(9)
  v_mfma_f32_16x16x32_bf16 v[48:51], v[36:39], v[228:231], v[48:51]
  ds_read_b128 v[32:35], v3 offset:36864
  buffer_load_dwordx4 v[104:107], v126, s[36:39], s51 offen offset:128 sc1
  v_mfma_f32_16x16x32_bf16 v[52:55], v[40:43], v[228:231], v[52:55]
  ds_read_b128 v[36:39], v3 offset:37888
  v_mfma_f32_16x16x32_bf16 v[56:59], v[44:47], v[228:231], v[56:59]
  ds_read_b128 v[40:43], v3 offset:38912
  s_waitcnt lgkmcnt(8)
  v_mfma_f32_16x16x32_bf16 v[60:63], v[88:91], v[228:231], v[60:63]
  ds_read_b128 v[44:47], v3 offset:39936
  v_mfma_f32_16x16x32_bf16 v[64:67], v[92:95], v[228:231], v[64:67]
  s_cmp_ge_u32 s77, 10
  s_cbranch_scc1 GG_ro10
GG_rd10:
  ds_read_b128 v[140:143], v153
  s_add_u32 s76, s76, 1
  s_waitcnt lgkmcnt(0)
  v_min_u32 v140, v140, v141
  v_min3_u32 v140, v140, v142, v143
  s_nop 0
  v_readfirstlane_b32 s77, v140
  s_nop 0
  s_cmp_ge_u32 s77, 10
  s_cbranch_scc1 GG_ro10
  s_cmp_lt_u32 s76, 8388608
  s_cbranch_scc1 GG_rd10
GG_ro10:
  ds_read_b128 v[88:91], v3 offset:40960
  s_waitcnt vmcnt(9)
  v_mfma_f32_16x16x32_bf16 v[48:51], v[136:139], v[232:235], v[48:51]
  ds_read_b128 v[92:95], v3 offset:41984
  buffer_load_dwordx4 v[108:111], v126, s[36:39], s51 offen offset:144 sc1
  v_mfma_f32_16x16x32_bf16 v[52:55], v[144:147], v[232:235], v[52:55]
  ds_read_b128 v[136:139], v3 offset:43008
  s_waitcnt lgkmcnt(7)
  v_mfma_f32_16x16x32_bf16 v[56:59], v[16:19], v[232:235], v[56:59]
  ds_read_b128 v[144:147], v3 offset:44032
  v_mfma_f32_16x16x32_bf16 v[60:63], v[20:23], v[232:235], v[60:63]
  ds_read_b128 v[16:19], v3 offset:45056
  v_mfma_f32_16x16x32_bf16 v[64:67], v[24:27], v[232:235], v[64:67]
  ds_read_b128 v[20:23], v3 offset:46080
  s_waitcnt vmcnt(9)
  v_mfma_f32_16x16x32_bf16 v[48:51], v[28:31], v[236:239], v[48:51]
  ds_read_b128 v[24:27], v3 offset:47104
  buffer_load_dwordx4 v[112:115], v126, s[36:39], s51 offen offset:256 sc1
  s_waitcnt lgkmcnt(7)
  v_mfma_f32_16x16x32_bf16 v[52:55], v[32:35], v[236:239], v[52:55]
  ds_read_b128 v[28:31], v3 offset:48128
  v_mfma_f32_16x16x32_bf16 v[56:59], v[36:39], v[236:239], v[56:59]
  ds_read_b128 v[32:35], v3 offset:49152
  v_mfma_f32_16x16x32_bf16 v[60:63], v[40:43], v[236:239], v[60:63]
  ds_read_b128 v[36:39], v3 offset:50176
  v_mfma_f32_16x16x32_bf16 v[64:67], v[44:47], v[236:239], v[64:67]
  ds_read_b128 v[40:43], v3 offset:51200
  s_waitcnt lgkmcnt(7)
  s_waitcnt vmcnt(9)
  v_mfma_f32_16x16x32_bf16 v[48:51], v[88:91], v[240:243], v[48:51]
  ds_read_b128 v[44:47], v3 offset:52224
  buffer_load_dwordx4 v[116:119], v126, s[36:39], s51 offen offset:272 sc1
  v_mfma_f32_16x16x32_bf16 v[52:55], v[92:95], v[240:243], v[52:55]
  ds_read_b128 v[88:91], v3 offset:53248
  v_mov_b32 v9, 9
  ds_write_b32 v0, v9
  v_mfma_f32_16x16x32_bf16 v[56:59], v[136:139], v[240:243], v[56:59]
  ds_read_b128 v[92:95], v3 offset:54272
  v_mfma_f32_16x16x32_bf16 v[60:63], v[144:147], v[240:243], v[60:63]
  ds_read_b128 v[136:139], v3 offset:55296
  s_waitcnt lgkmcnt(8)
  v_mfma_f32_16x16x32_bf16 v[64:67], v[16:19], v[240:243], v[64:67]
  ds_read_b128 v[144:147], v3 offset:56320
  s_waitcnt vmcnt(8)
  v_mfma_f32_16x16x32_bf16 v[48:51], v[20:23], v[244:247], v[48:51]
  ds_read_b128 v[16:19], v3 offset:57344
  v_mfma_f32_16x16x32_bf16 v[52:55], v[24:27], v[244:247], v[52:55]
  ds_read_b128 v[20:23], v3 offset:58368
  v_mfma_f32_16x16x32_bf16 v[56:59], v[28:31], v[244:247], v[56:59]
  ds_read_b128 v[24:27], v3 offset:59392
  s_waitcnt lgkmcnt(8)
  v_mfma_f32_16x16x32_bf16 v[60:63], v[32:35], v[244:247], v[60:63]
  ds_read_b128 v[28:31], v3 offset:60416
  v_mfma_f32_16x16x32_bf16 v[64:67], v[36:39], v[244:247], v[64:67]
  s_waitcnt vmcnt(7)
  v_mfma_f32_16x16x32_bf16 v[48:51], v[40:43], v[248:251], v[48:51]
  v_mfma_f32_16x16x32_bf16 v[52:55], v[44:47], v[248:251], v[52:55]
  s_waitcnt lgkmcnt(4)
  v_mfma_f32_16x16x32_bf16 v[56:59], v[88:91], v[248:251], v[56:59]
  v_mfma_f32_16x16x32_bf16 v[60:63], v[92:95], v[248:251], v[60:63]
  v_mfma_f32_16x16x32_bf16 v[64:67], v[136:139], v[248:251], v[64:67]
  s_waitcnt vmcnt(6)
  v_mfma_f32_16x16x32_bf16 v[48:51], v[144:147], v[252:255], v[48:51]
  s_waitcnt lgkmcnt(0)
  v_mfma_f32_16x16x32_bf16 v[52:55], v[16:19], v[252:255], v[52:55]
  v_mfma_f32_16x16x32_bf16 v[56:59], v[20:23], v[252:255], v[56:59]
  v_mfma_f32_16x16x32_bf16 v[60:63], v[24:27], v[252:255], v[60:63]
  v_mfma_f32_16x16x32_bf16 v[64:67], v[28:31], v[252:255], v[64:67]
  v_mov_b32 v9, 10
  ds_write_b32 v0, v9
  s_nop 0
  v_cvt_pk_bf16_f32 v164, v48, v49
  v_cvt_pk_bf16_f32 v165, v50, v51
  v_lshlrev_b32 v128, 16, v164
  v_lshlrev_b32 v130, 16, v165
  v_and_b32 v129, s40, v164
  v_and_b32 v131, s40, v165
  v_pk_add_f32 v[128:129], v[128:129], v[68:69]
  v_pk_add_f32 v[130:131], v[130:131], v[70:71]
  v_cvt_pk_bf16_f32 v164, v128, v129
  v_cvt_pk_bf16_f32 v165, v130, v131
  v_cvt_pk_bf16_f32 v166, v52, v53
  v_cvt_pk_bf16_f32 v167, v54, v55
  v_lshlrev_b32 v128, 16, v166
  v_lshlrev_b32 v130, 16, v167
  v_and_b32 v129, s40, v166
  v_and_b32 v131, s40, v167
  v_pk_add_f32 v[128:129], v[128:129], v[72:73]
  v_pk_add_f32 v[130:131], v[130:131], v[74:75]
  v_cvt_pk_bf16_f32 v166, v128, v129
  v_cvt_pk_bf16_f32 v167, v130, v131
  buffer_store_dwordx4 v[164:167], v5, s[36:39], s54 offen sc1
  v_cvt_pk_bf16_f32 v168, v56, v57
  v_cvt_pk_bf16_f32 v169, v58, v59
  v_lshlrev_b32 v128, 16, v168
  v_lshlrev_b32 v130, 16, v169
  v_and_b32 v129, s40, v168
  v_and_b32 v131, s40, v169
  v_pk_add_f32 v[128:129], v[128:129], v[76:77]
  v_pk_add_f32 v[130:131], v[130:131], v[78:79]
  v_cvt_pk_bf16_f32 v168, v128, v129
  v_cvt_pk_bf16_f32 v169, v130, v131
  v_cvt_pk_bf16_f32 v170, v60, v61
  v_cvt_pk_bf16_f32 v171, v62, v63
  v_lshlrev_b32 v128, 16, v170
  v_lshlrev_b32 v130, 16, v171
  v_and_b32 v129, s40, v170
  v_and_b32 v131, s40, v171
  v_pk_add_f32 v[128:129], v[128:129], v[80:81]
  v_pk_add_f32 v[130:131], v[130:131], v[82:83]
  v_cvt_pk_bf16_f32 v170, v128, v129
  v_cvt_pk_bf16_f32 v171, v130, v131
  buffer_store_dwordx4 v[168:171], v5, s[36:39], s55 offen sc1
  v_cvt_pk_bf16_f32 v172, v64, v65
  v_cvt_pk_bf16_f32 v173, v66, v67
  v_lshlrev_b32 v128, 16, v172
  v_lshlrev_b32 v130, 16, v173
  v_and_b32 v129, s40, v172
  v_and_b32 v131, s40, v173
  v_pk_add_f32 v[128:129], v[128:129], v[84:85]
  v_pk_add_f32 v[130:131], v[130:131], v[86:87]
  v_cvt_pk_bf16_f32 v172, v128, v129
  v_cvt_pk_bf16_f32 v173, v130, v131
  buffer_store_dwordx2 v[172:173], v151, s[36:39], s56 offen sc1
  v_dot2_f32_bf16 v124, v164, s41, 0
  v_dot2_f32_bf16 v125, v164, v164, 0
  v_dot2_f32_bf16 v124, v165, s41, v124
  v_dot2_f32_bf16 v125, v165, v165, v125
  v_dot2_f32_bf16 v124, v166, s41, v124
  v_dot2_f32_bf16 v125, v166, v166, v125
  v_dot2_f32_bf16 v124, v167, s41, v124
  v_dot2_f32_bf16 v125, v167, v167, v125
  v_dot2_f32_bf16 v124, v168, s41, v124
  v_dot2_f32_bf16 v125, v168, v168, v125
  v_dot2_f32_bf16 v124, v169, s41, v124
  v_dot2_f32_bf16 v125, v169, v169, v125
  v_dot2_f32_bf16 v124, v170, s41, v124
  v_dot2_f32_bf16 v125, v170, v170, v125
  v_dot2_f32_bf16 v124, v171, s41, v124
  v_dot2_f32_bf16 v125, v171, v171, v125
  v_dot2_f32_bf16 v124, v172, s41, v124
  v_dot2_f32_bf16 v125, v172, v172, v125
  v_dot2_f32_bf16 v124, v173, s41, v124
  v_dot2_f32_bf16 v125, v173, v173, v125
  s_nop 1
  v_mov_b32 v128, v124
  v_mov_b32 v129, v125
  s_nop 0
  v_permlane16_swap_b32 v124, v128
  v_permlane16_swap_b32 v125, v129
  v_add_f32 v124, v124, v128
  v_add_f32 v125, v125, v129
  v_mov_b32 v128, v124
  v_mov_b32 v129, v125
  s_nop 0
  v_permlane32_swap_b32 v124, v128
  v_permlane32_swap_b32 v125, v129
  v_add_f32 v124, v124, v128
  v_add_f32 v125, v125, v129
  s_lshl_b32 s14, s68, 10
  s_lshl_b32 s12, s5, 7
  s_add_u32 s14, s14, s12
  s_add_u32 s14, s14, s67
  s_add_u32 s14, s14, 677888
  v_lshlrev_b32 v128, 3, v6
  s_mov_b64 exec, 0xffff
  buffer_store_dwordx2 v[124:125], v128, s[36:39], s14 offen sc1
  s_mov_b64 exec, -1
  s_waitcnt vmcnt(0)
  s_lshl_b32 s12, s6, 7
  s_lshl_b32 s13, s5, 2
  s_add_u32 s12, s12, s13
  s_add_u32 s12, s12, 33046528
  v_mov_b32 v148, 1
  v_mov_b32 v149, 0
  s_mov_b64 exec, 1
  s_cmp_lg_u32 s75, 0
  s_cbranch_scc1 GG_ff2
  buffer_store_dword v148, v149, s[36:39], s12 offen sc1
  s_branch GG_fe2
GG_ff2:
  buffer_store_dword v148, v149, s[36:39], s12 offen
GG_fe2:
  s_mov_b64 exec, -1
  s_lshl_b32 s7, s27, 8
  s_add_u32 s7, s7, s67
  s_add_u32 s7, s7, 0
  s_mov_b32 s8, s7
  s_add_u32 s9, s7, 337920
  s_mul_i32 s12, s66, 84480
  s_add_u32 s7, s7, s12
  s_sub_u32 s7, s7, 16896
  v_lshlrev_b32 v129, 3, v6
  v_lshl_add_u32 v129, v7, 8, v129
  s_lshl_b32 s14, s27, 10
  s_add_u32 s14, s14, s67
  s_add_u32 s14, s14, 677888
  s_mul_i32 s17, s27, 49152
  s_mul_i32 s12, s25, 3072
  s_add_u32 s17, s17, s12
  s_add_u32 s17, s17, s67
  s_add_u32 s17, s17, 694272
  s_add_u32 s16, s17, 49152
  s_cmp_ge_u32 s77, 11
  s_cbranch_scc1 GG_ro11
GG_rd11:
  ds_read_b128 v[140:143], v153
  s_add_u32 s76, s76, 1
  s_waitcnt lgkmcnt(0)
  v_min_u32 v140, v140, v141
  v_min3_u32 v140, v140, v142, v143
  s_nop 0
  v_readfirstlane_b32 s77, v140
  s_nop 0
  s_cmp_ge_u32 s77, 11
  s_cbranch_scc1 GG_ro11
  s_cmp_lt_u32 s76, 8388608
  s_cbranch_scc1 GG_rd11
GG_ro11:
  ds_read_b128 v[16:19], v3 offset:61440
  ds_read_b128 v[20:23], v3 offset:62464
  ds_read_b128 v[24:27], v3 offset:63488
  ds_read_b128 v[28:31], v3 offset:64512
  ds_read_b128 v[32:35], v1 offset:0
  ds_read_b128 v[36:39], v1 offset:1024
  ds_read_b128 v[40:43], v1 offset:2048
  s_lshl_b32 s12, s26, 7
  s_add_u32 s12, s12, 33046528
  v_and_b32 v149, 7, v2
  v_lshl_add_u32 v149, v149, 2, s12
  v_bfe_u32 v148, v2, 3, 1
  v_lshl_add_u32 v149, v148, 7, v149
  s_mov_b32 s13, 0
  s_mov_b64 exec, 0xffff
GG_poll2:
  buffer_load_dword v148, v149, s[36:39], 0 offen sc1
  s_waitcnt vmcnt(0)
  v_cmp_ne_u32 vcc, 0, v148
  s_add_u32 s13, s13, 1
  s_cmp_eq_u64 vcc, exec
  s_cbranch_scc1 GG_np2
  s_nop 0
  s_cmp_lt_u32 s13, 400000
  s_cbranch_scc1 GG_poll2
GG_np2:
  s_mov_b64 exec, -1
  s_add_u32 s7, s7, 16896
  buffer_load_dwordx4 v[176:179], v5, s[36:39], s7 offen offset:0 sc1
  buffer_load_dwordx4 v[180:183], v5, s[36:39], s7 offen offset:256 sc1
  s_add_u32 s7, s7, 16896
  buffer_load_dwordx4 v[184:187], v5, s[36:39], s7 offen offset:0 sc1
  buffer_load_dwordx4 v[188:191], v5, s[36:39], s7 offen offset:256 sc1
  s_add_u32 s7, s7, 16896
  s_lshl_b32 s11, s27, 7
  s_sub_u32 s11, s7, s11
  buffer_load_dwordx2 v[192:193], v151, s[36:39], s11 offen offset:0 sc1
  buffer_load_dwordx2 v[194:195], v151, s[36:39], s11 offen offset:2048 sc1
  buffer_load_dwordx2 v[196:197], v151, s[36:39], s11 offen offset:128 sc1
  buffer_load_dwordx2 v[198:199], v151, s[36:39], s11 offen offset:2176 sc1
  s_add_u32 s7, s7, 16896
  buffer_load_dwordx4 v[200:203], v5, s[36:39], s7 offen offset:0 sc1
  buffer_load_dwordx4 v[204:207], v5, s[36:39], s7 offen offset:256 sc1
  buffer_load_dwordx2 v[120:121], v129, s[36:39], s14 offen offset:0 sc1
  buffer_load_dwordx2 v[122:123], v129, s[36:39], s14 offen offset:128 sc1
  buffer_load_dwordx2 v[124:125], v129, s[36:39], s14 offen offset:1024 sc1
  buffer_load_dwordx2 v[126:127], v129, s[36:39], s14 offen offset:1152 sc1
  s_add_u32 s7, s7, 16896
  buffer_load_dwordx4 v[208:211], v5, s[36:39], s7 offen offset:0 sc1
  buffer_load_dwordx4 v[212:215], v5, s[36:39], s7 offen offset:256 sc1
  s_waitcnt lgkmcnt(5)
  s_waitcnt vmcnt(14)
  v_mfma_f32_16x16x32_bf16 v[48:51], v[16:19], v[176:179], 0
  v_mfma_f32_16x16x32_bf16 v[52:55], v[16:19], v[180:183], 0
  ds_read_b128 v[44:47], v1 offset:3072
  v_mfma_f32_16x16x32_bf16 v[56:59], v[20:23], v[176:179], 0
  v_mfma_f32_16x16x32_bf16 v[60:63], v[20:23], v[180:183], 0
  ds_read_b128 v[16:19], v1 offset:4096
  s_waitcnt lgkmcnt(5)
  v_mfma_f32_16x16x32_bf16 v[64:67], v[24:27], v[176:179], 0
  v_mfma_f32_16x16x32_bf16 v[68:71], v[24:27], v[180:183], 0
  ds_read_b128 v[20:23], v1 offset:5120
  v_mfma_f32_16x16x32_bf16 v[72:75], v[28:31], v[176:179], 0
  v_mfma_f32_16x16x32_bf16 v[76:79], v[28:31], v[180:183], 0
  ds_read_b128 v[24:27], v1 offset:6144
  s_waitcnt lgkmcnt(5)
  v_mfma_f32_16x16x32_bf16 v[80:83], v[32:35], v[176:179], 0
  v_mfma_f32_16x16x32_bf16 v[84:87], v[32:35], v[180:183], 0
  ds_read_b128 v[28:31], v1 offset:7168
  v_mfma_f32_16x16x32_bf16 v[88:91], v[36:39], v[176:179], 0
  v_mfma_f32_16x16x32_bf16 v[92:95], v[36:39], v[180:183], 0
  ds_read_b128 v[32:35], v1 offset:8192
  s_waitcnt lgkmcnt(5)
  s_waitcnt vmcnt(12)
  v_mfma_f32_16x16x32_bf16 v[48:51], v[40:43], v[184:187], v[48:51]
  v_mfma_f32_16x16x32_bf16 v[52:55], v[40:43], v[188:191], v[52:55]
  ds_read_b128 v[36:39], v1 offset:9216
  v_mfma_f32_16x16x32_bf16 v[56:59], v[44:47], v[184:187], v[56:59]
  v_mfma_f32_16x16x32_bf16 v[60:63], v[44:47], v[188:191], v[60:63]
  ds_read_b128 v[40:43], v1 offset:10240
  s_waitcnt lgkmcnt(5)
  v_mfma_f32_16x16x32_bf16 v[64:67], v[16:19], v[184:187], v[64:67]
  v_mfma_f32_16x16x32_bf16 v[68:71], v[16:19], v[188:191], v[68:71]
  ds_read_b128 v[44:47], v1 offset:11264
  v_mfma_f32_16x16x32_bf16 v[72:75], v[20:23], v[184:187], v[72:75]
  v_mfma_f32_16x16x32_bf16 v[76:79], v[20:23], v[188:191], v[76:79]
  ds_read_b128 v[16:19], v1 offset:12288
  s_waitcnt lgkmcnt(5)
  v_mfma_f32_16x16x32_bf16 v[80:83], v[24:27], v[184:187], v[80:83]
  v_mfma_f32_16x16x32_bf16 v[84:87], v[24:27], v[188:191], v[84:87]
  ds_read_b128 v[20:23], v1 offset:13312
  v_mfma_f32_16x16x32_bf16 v[88:91], v[28:31], v[184:187], v[88:91]
  v_mfma_f32_16x16x32_bf16 v[92:95], v[28:31], v[188:191], v[92:95]
  ds_read_b128 v[24:27], v1 offset:14336
  s_waitcnt lgkmcnt(5)
  s_waitcnt vmcnt(8)
  v_mfma_f32_16x16x32_bf16 v[48:51], v[32:35], v[192:195], v[48:51]
  s_add_u32 s7, s7, 16896
  s_cmp_eq_u32 s7, s9
  s_cselect_b32 s7, s8, s7
  buffer_load_dwordx4 v[216:219], v5, s[36:39], s7 offen offset:0 sc1
  v_mfma_f32_16x16x32_bf16 v[52:55], v[32:35], v[196:199], v[52:55]
  ds_read_b128 v[28:31], v1 offset:15360
  v_mfma_f32_16x16x32_bf16 v[56:59], v[36:39], v[192:195], v[56:59]
  buffer_load_dwordx4 v[220:223], v5, s[36:39], s7 offen offset:256 sc1
  v_mfma_f32_16x16x32_bf16 v[60:63], v[36:39], v[196:199], v[60:63]
  s_cmp_ge_u32 s77, 12
  s_cbranch_scc1 GG_ro12
GG_rd12:
  ds_read_b128 v[140:143], v153
  s_add_u32 s76, s76, 1
  s_waitcnt lgkmcnt(0)
  v_min_u32 v140, v140, v141
  v_min3_u32 v140, v140, v142, v143
  s_nop 0
  v_readfirstlane_b32 s77, v140
  s_nop 0
  s_cmp_ge_u32 s77, 12
  s_cbranch_scc1 GG_ro12
  s_cmp_lt_u32 s76, 8388608
  s_cbranch_scc1 GG_rd12
GG_ro12:
  ds_read_b128 v[32:35], v1 offset:16384
  s_waitcnt lgkmcnt(5)
  v_mfma_f32_16x16x32_bf16 v[64:67], v[40:43], v[192:195], v[64:67]
  s_add_u32 s7, s7, 16896
  buffer_load_dwordx4 v[224:227], v5, s[36:39], s7 offen offset:0 sc1
  v_mfma_f32_16x16x32_bf16 v[68:71], v[40:43], v[196:199], v[68:71]
  ds_read_b128 v[36:39], v1 offset:17408
  v_mfma_f32_16x16x32_bf16 v[72:75], v[44:47], v[192:195], v[72:75]
  buffer_load_dwordx4 v[228:231], v5, s[36:39], s7 offen offset:256 sc1
  v_mfma_f32_16x16x32_bf16 v[76:79], v[44:47], v[196:199], v[76:79]
  ds_read_b128 v[40:43], v1 offset:18432
  s_waitcnt lgkmcnt(5)
  v_mfma_f32_16x16x32_bf16 v[80:83], v[16:19], v[192:195], v[80:83]
  v_mfma_f32_16x16x32_bf16 v[84:87], v[16:19], v[196:199], v[84:87]
  ds_read_b128 v[44:47], v1 offset:19456
  v_mfma_f32_16x16x32_bf16 v[88:91], v[20:23], v[192:195], v[88:91]
  v_mfma_f32_16x16x32_bf16 v[92:95], v[20:23], v[196:199], v[92:95]
  ds_read_b128 v[16:19], v1 offset:20480
  s_waitcnt lgkmcnt(5)
  s_waitcnt vmcnt(10)
  v_mfma_f32_16x16x32_bf16 v[48:51], v[24:27], v[200:203], v[48:51]
  s_add_u32 s7, s7, 16896
  s_lshl_b32 s11, s27, 7
  s_sub_u32 s11, s7, s11
  buffer_load_dwordx2 v[232:233], v151, s[36:39], s11 offen offset:0 sc1
  v_mfma_f32_16x16x32_bf16 v[52:55], v[24:27], v[204:207], v[52:55]
  ds_read_b128 v[20:23], v1 offset:21504
  v_mfma_f32_16x16x32_bf16 v[56:59], v[28:31], v[200:203], v[56:59]
  buffer_load_dwordx2 v[234:235], v151, s[36:39], s11 offen offset:2048 sc1
  v_mfma_f32_16x16x32_bf16 v[60:63], v[28:31], v[204:207], v[60:63]
  ds_read_b128 v[24:27], v1 offset:22528
  s_waitcnt lgkmcnt(5)
  v_mfma_f32_16x16x32_bf16 v[64:67], v[32:35], v[200:203], v[64:67]
  v_mov_b32 v9, 11
  ds_write_b32 v0, v9
  v_mfma_f32_16x16x32_bf16 v[68:71], v[32:35], v[204:207], v[68:71]
  ds_read_b128 v[28:31], v1 offset:23552
  v_mfma_f32_16x16x32_bf16 v[72:75], v[36:39], v[200:203], v[72:75]
  v_mfma_f32_16x16x32_bf16 v[76:79], v[36:39], v[204:207], v[76:79]
  ds_read_b128 v[32:35], v1 offset:24576
  s_waitcnt lgkmcnt(6)
  v_mfma_f32_16x16x32_bf16 v[80:83], v[40:43], v[200:203], v[80:83]
  v_mfma_f32_16x16x32_bf16 v[84:87], v[40:43], v[204:207], v[84:87]
  ds_read_b128 v[36:39], v1 offset:25600
  v_mfma_f32_16x16x32_bf16 v[88:91], v[44:47], v[200:203], v[88:91]
  v_mfma_f32_16x16x32_bf16 v[92:95], v[44:47], v[204:207], v[92:95]
  ds_read_b128 v[40:43], v1 offset:26624
  s_waitcnt lgkmcnt(6)
  s_waitcnt vmcnt(6)
  v_mfma_f32_16x16x32_bf16 v[48:51], v[16:19], v[208:211], v[48:51]
  buffer_load_dwordx2 v[236:237], v151, s[36:39], s11 offen offset:128 sc1
  v_mfma_f32_16x16x32_bf16 v[52:55], v[16:19], v[212:215], v[52:55]
  ds_read_b128 v[44:47], v1 offset:27648
  v_mfma_f32_16x16x32_bf16 v[56:59], v[20:23], v[208:211], v[56:59]
  buffer_load_dwordx2 v[238:239], v151, s[36:39], s11 offen offset:2176 sc1
  v_mfma_f32_16x16x32_bf16 v[60:63], v[20:23], v[212:215], v[60:63]
  ds_read_b128 v[16:19], v1 offset:28672
  s_waitcnt lgkmcnt(5)
  v_mfma_f32_16x16x32_bf16 v[64:67], v[24:27], v[208:211], v[64:67]
  s_add_u32 s7, s7, 16896
  buffer_load_dwordx4 v[240:243], v5, s[36:39], s7 offen offset:0 sc1
  v_mfma_f32_16x16x32_bf16 v[68:71], v[24:27], v[212:215], v[68:71]
  ds_read_b128 v[20:23], v1 offset:29696
  v_mfma_f32_16x16x32_bf16 v[72:75], v[28:31], v[208:211], v[72:75]
  buffer_load_dwordx4 v[244:247], v5, s[36:39], s7 offen offset:256 sc1
  v_mfma_f32_16x16x32_bf16 v[76:79], v[28:31], v[212:215], v[76:79]
  ds_read_b128 v[24:27], v1 offset:30720
  s_waitcnt lgkmcnt(5)
  v_mfma_f32_16x16x32_bf16 v[80:83], v[32:35], v[208:211], v[80:83]
  s_add_u32 s7, s7, 16896
  buffer_load_dwordx4 v[248:251], v5, s[36:39], s7 offen offset:0 sc1
  v_mfma_f32_16x16x32_bf16 v[84:87], v[32:35], v[212:215], v[84:87]
  ds_read_b128 v[28:31], v1 offset:31744
  v_mfma_f32_16x16x32_bf16 v[88:91], v[36:39], v[208:211], v[88:91]
  buffer_load_dwordx4 v[252:255], v5, s[36:39], s7 offen offset:256 sc1
  v_mfma_f32_16x16x32_bf16 v[92:95], v[36:39], v[212:215], v[92:95]
  ds_read_b128 v[32:35], v1 offset:32768
  s_waitcnt lgkmcnt(5)
  s_waitcnt vmcnt(10)
  v_mfma_f32_16x16x32_bf16 v[48:51], v[40:43], v[216:219], v[48:51]
  s_add_u32 s7, s7, 16896
  s_cmp_eq_u32 s7, s9
  s_cselect_b32 s7, s8, s7
  buffer_load_dwordx4 v[176:179], v5, s[36:39], s7 offen offset:0 sc1
  v_mfma_f32_16x16x32_bf16 v[52:55], v[40:43], v[220:223], v[52:55]
  ds_read_b128 v[36:39], v1 offset:33792
  v_mfma_f32_16x16x32_bf16 v[56:59], v[44:47], v[216:219], v[56:59]
  buffer_load_dwordx4 v[180:183], v5, s[36:39], s7 offen offset:256 sc1
  v_mfma_f32_16x16x32_bf16 v[60:63], v[44:47], v[220:223], v[60:63]
  ds_read_b128 v[40:43], v1 offset:34816
  s_waitcnt lgkmcnt(5)
  v_mfma_f32_16x16x32_bf16 v[64:67], v[16:19], v[216:219], v[64:67]
  v_mfma_f32_16x16x32_bf16 v[68:71], v[16:19], v[220:223], v[68:71]
  ds_read_b128 v[44:47], v1 offset:35840
  v_mfma_f32_16x16x32_bf16 v[72:75], v[20:23], v[216:219], v[72:75]
  v_mfma_f32_16x16x32_bf16 v[76:79], v[20:23], v[220:223], v[76:79]
  s_cmp_ge_u32 s77, 13
  s_cbranch_scc1 GG_ro13
GG_rd13:
  ds_read_b128 v[140:143], v153
  s_add_u32 s76, s76, 1
  s_waitcnt lgkmcnt(0)
  v_min_u32 v140, v140, v141
  v_min3_u32 v140, v140, v142, v143
  s_nop 0
  v_readfirstlane_b32 s77, v140
  s_nop 0
  s_cmp_ge_u32 s77, 13
  s_cbranch_scc1 GG_ro13
  s_cmp_lt_u32 s76, 8388608
  s_cbranch_scc1 GG_rd13
GG_ro13:
  ds_read_b128 v[16:19], v1 offset:36864
  s_waitcnt lgkmcnt(5)
  v_mfma_f32_16x16x32_bf16 v[80:83], v[24:27], v[216:219], v[80:83]
  v_mfma_f32_16x16x32_bf16 v[84:87], v[24:27], v[220:223], v[84:87]
  ds_read_b128 v[20:23], v1 offset:37888
  v_mfma_f32_16x16x32_bf16 v[88:91], v[28:31], v[216:219], v[88:91]
  v_mfma_f32_16x16x32_bf16 v[92:95], v[28:31], v[220:223], v[92:95]
  ds_read_b128 v[24:27], v1 offset:38912
  s_waitcnt lgkmcnt(5)
  s_waitcnt vmcnt(10)
  v_mfma_f32_16x16x32_bf16 v[48:51], v[32:35], v[224:227], v[48:51]
  s_add_u32 s7, s7, 16896
  buffer_load_dwordx4 v[184:187], v5, s[36:39], s7 offen offset:0 sc1
  v_mfma_f32_16x16x32_bf16 v[52:55], v[32:35], v[228:231], v[52:55]
  ds_read_b128 v[28:31], v1 offset:39936
  v_mfma_f32_16x16x32_bf16 v[56:59], v[36:39], v[224:227], v[56:59]
  buffer_load_dwordx4 v[188:191], v5, s[36:39], s7 offen offset:256 sc1
  v_mfma_f32_16x16x32_bf16 v[60:63], v[36:39], v[228:231], v[60:63]
  ds_read_b128 v[32:35], v1 offset:40960
  s_waitcnt lgkmcnt(5)
  v_mfma_f32_16x16x32_bf16 v[64:67], v[40:43], v[224:227], v[64:67]
  v_mfma_f32_16x16x32_bf16 v[68:71], v[40:43], v[228:231], v[68:71]
  ds_read_b128 v[36:39], v1 offset:41984
  v_mfma_f32_16x16x32_bf16 v[72:75], v[44:47], v[224:227], v[72:75]
  v_mfma_f32_16x16x32_bf16 v[76:79], v[44:47], v[228:231], v[76:79]
  ds_read_b128 v[40:43], v1 offset:43008
  s_waitcnt lgkmcnt(5)
  v_mfma_f32_16x16x32_bf16 v[80:83], v[16:19], v[224:227], v[80:83]
  v_mov_b32 v9, 12
  ds_write_b32 v0, v9
  v_mfma_f32_16x16x32_bf16 v[84:87], v[16:19], v[228:231], v[84:87]
  ds_read_b128 v[44:47], v1 offset:44032
  v_mfma_f32_16x16x32_bf16 v[88:91], v[20:23], v[224:227], v[88:91]
  v_add_f32 v120, v120, v122
  v_add_f32 v121, v121, v123
  v_mfma_f32_16x16x32_bf16 v[92:95], v[20:23], v[228:231], v[92:95]
  ds_read_b128 v[16:19], v1 offset:45056
  s_waitcnt lgkmcnt(6)
  s_waitcnt vmcnt(8)
  v_mfma_f32_16x16x32_bf16 v[48:51], v[24:27], v[232:235], v[48:51]
  s_add_u32 s7, s7, 16896
  s_lshl_b32 s11, s27, 7
  s_sub_u32 s11, s7, s11
  buffer_load_dwordx2 v[192:193], v151, s[36:39], s11 offen offset:0 sc1
  v_mfma_f32_16x16x32_bf16 v[52:55], v[24:27], v[236:239], v[52:55]
  ds_read_b128 v[20:23], v1 offset:46080
  v_mfma_f32_16x16x32_bf16 v[56:59], v[28:31], v[232:235], v[56:59]
  buffer_load_dwordx2 v[194:195], v151, s[36:39], s11 offen offset:2048 sc1
  v_mfma_f32_16x16x32_bf16 v[60:63], v[28:31], v[236:239], v[60:63]
  ds_read_b128 v[24:27], v1 offset:47104
  s_waitcnt lgkmcnt(6)
  v_mfma_f32_16x16x32_bf16 v[64:67], v[32:35], v[232:235], v[64:67]
  buffer_load_dwordx2 v[196:197], v151, s[36:39], s11 offen offset:128 sc1
  v_mfma_f32_16x16x32_bf16 v[68:71], v[32:35], v[236:239], v[68:71]
  ds_read_b128 v[28:31], v1 offset:48128
  v_mfma_f32_16x16x32_bf16 v[72:75], v[36:39], v[232:235], v[72:75]
  buffer_load_dwordx2 v[198:199], v151, s[36:39], s11 offen offset:2176 sc1
  v_mfma_f32_16x16x32_bf16 v[76:79], v[36:39], v[236:239], v[76:79]
  ds_read_b128 v[32:35], v1 offset:49152
  s_waitcnt lgkmcnt(5)
  v_mfma_f32_16x16x32_bf16 v[80:83], v[40:43], v[232:235], v[80:83]
  v_mov_b32 v122, v120
  s_nop 1
  v_permlane16_swap_b32 v120, v122
  v_mfma_f32_16x16x32_bf16 v[84:87], v[40:43], v[236:239], v[84:87]
  ds_read_b128 v[36:39], v1 offset:50176
  v_mfma_f32_16x16x32_bf16 v[88:91], v[44:47], v[232:235], v[88:91]
  v_add_f32 v120, v120, v122
  v_mov_b32 v122, v120
  v_mfma_f32_16x16x32_bf16 v[92:95], v[44:47], v[236:239], v[92:95]
  ds_read_b128 v[40:43], v1 offset:51200
  s_waitcnt lgkmcnt(5)
  s_waitcnt vmcnt(10)
  v_mfma_f32_16x16x32_bf16 v[48:51], v[16:19], v[240:243], v[48:51]
  s_add_u32 s7, s7, 16896
  buffer_load_dwordx4 v[200:203], v5, s[36:39], s7 offen offset:0 sc1
  v_mfma_f32_16x16x32_bf16 v[52:55], v[16:19], v[244:247], v[52:55]
  ds_read_b128 v[44:47], v1 offset:52224
  v_mfma_f32_16x16x32_bf16 v[56:59], v[20:23], v[240:243], v[56:59]
  buffer_load_dwordx4 v[204:207], v5, s[36:39], s7 offen offset:256 sc1
  v_mfma_f32_16x16x32_bf16 v[60:63], v[20:23], v[244:247], v[60:63]
  ds_read_b128 v[16:19], v1 offset:53248
  s_waitcnt lgkmcnt(5)
  v_mfma_f32_16x16x32_bf16 v[64:67], v[24:27], v[240:243], v[64:67]
  v_permlane32_swap_b32 v120, v122
  v_add_f32 v120, v120, v122
  v_mfma_f32_16x16x32_bf16 v[68:71], v[24:27], v[244:247], v[68:71]
  ds_read_b128 v[20:23], v1 offset:54272
  v_mfma_f32_16x16x32_bf16 v[72:75], v[28:31], v[240:243], v[72:75]
  v_mov_b32 v122, v121
  s_nop 1
  v_permlane16_swap_b32 v121, v122
  v_mfma_f32_16x16x32_bf16 v[76:79], v[28:31], v[244:247], v[76:79]
  ds_read_b128 v[24:27], v1 offset:55296
  s_waitcnt lgkmcnt(5)
  v_mfma_f32_16x16x32_bf16 v[80:83], v[32:35], v[240:243], v[80:83]
  v_add_f32 v121, v121, v122
  v_mov_b32 v122, v121
  v_mfma_f32_16x16x32_bf16 v[84:87], v[32:35], v[244:247], v[84:87]
  ds_read_b128 v[28:31], v1 offset:56320
  v_mfma_f32_16x16x32_bf16 v[88:91], v[36:39], v[240:243], v[88:91]
  v_permlane32_swap_b32 v121, v122
  v_add_f32 v121, v121, v122
  v_mfma_f32_16x16x32_bf16 v[92:95], v[36:39], v[244:247], v[92:95]
  s_cmp_ge_u32 s77, 14
  s_cbranch_scc1 GG_ro14
GG_rd14:
  ds_read_b128 v[140:143], v153
  s_add_u32 s76, s76, 1
  s_waitcnt lgkmcnt(0)
  v_min_u32 v140, v140, v141
  v_min3_u32 v140, v140, v142, v143
  s_nop 0
  v_readfirstlane_b32 s77, v140
  s_nop 0
  s_cmp_ge_u32 s77, 14
  s_cbranch_scc1 GG_ro14
  s_cmp_lt_u32 s76, 8388608
  s_cbranch_scc1 GG_rd14
GG_ro14:
  ds_read_b128 v[32:35], v1 offset:57344
  s_waitcnt lgkmcnt(5)
  s_waitcnt vmcnt(10)
  v_mfma_f32_16x16x32_bf16 v[48:51], v[40:43], v[248:251], v[48:51]
  s_add_u32 s7, s7, 16896
  buffer_load_dwordx4 v[208:211], v5, s[36:39], s7 offen offset:0 sc1
  v_mfma_f32_16x16x32_bf16 v[52:55], v[40:43], v[252:255], v[52:55]
  ds_read_b128 v[36:39], v1 offset:58368
  v_mfma_f32_16x16x32_bf16 v[56:59], v[44:47], v[248:251], v[56:59]
  buffer_load_dwordx4 v[212:215], v5, s[36:39], s7 offen offset:256 sc1
  v_mfma_f32_16x16x32_bf16 v[60:63], v[44:47], v[252:255], v[60:63]
  ds_read_b128 v[40:43], v1 offset:59392
  s_waitcnt lgkmcnt(5)
  v_mfma_f32_16x16x32_bf16 v[64:67], v[16:19], v[248:251], v[64:67]
  v_mul_f32 v120, 0x3acccccd, v120
  v_mul_f32 v121, 0x3acccccd, v121
  v_mfma_f32_16x16x32_bf16 v[68:71], v[16:19], v[252:255], v[68:71]
  ds_read_b128 v[44:47], v1 offset:60416
  v_mfma_f32_16x16x32_bf16 v[72:75], v[20:23], v[248:251], v[72:75]
  v_fma_f32 v121, -v120, v120, v121
  v_max_f32 v121, 0, v121
  v_mfma_f32_16x16x32_bf16 v[76:79], v[20:23], v[252:255], v[76:79]
  ds_read_b128 v[16:19], v1 offset:61440
  s_waitcnt lgkmcnt(5)
  v_mfma_f32_16x16x32_bf16 v[80:83], v[24:27], v[248:251], v[80:83]
  v_cvt_pk_bf16_f32 v123, v120, v121
  v_lshlrev_b32 v122, 16, v123
  v_mfma_f32_16x16x32_bf16 v[84:87], v[24:27], v[252:255], v[84:87]
  ds_read_b128 v[20:23], v1 offset:62464
  v_mfma_f32_16x16x32_bf16 v[88:91], v[28:31], v[248:251], v[88:91]
  v_and_b32 v15, s40, v123
  v_add_f32 v15, 0x3727c5ac, v15
  v_mfma_f32_16x16x32_bf16 v[92:95], v[28:31], v[252:255], v[92:95]
  ds_read_b128 v[24:27], v1 offset:63488
  s_waitcnt lgkmcnt(5)
  s_waitcnt vmcnt(10)
  v_mfma_f32_16x16x32_bf16 v[48:51], v[32:35], v[176:179], v[48:51]
  s_add_u32 s7, s7, 16896
  s_cmp_eq_u32 s7, s9
  s_cselect_b32 s7, s8, s7
  buffer_load_dwordx4 v[216:219], v5, s[36:39], s7 offen offset:0 sc1
  v_mfma_f32_16x16x32_bf16 v[52:55], v[32:35], v[180:183], v[52:55]
  ds_read_b128 v[28:31], v1 offset:64512
  v_mfma_f32_16x16x32_bf16 v[56:59], v[36:39], v[176:179], v[56:59]
  buffer_load_dwordx4 v[220:223], v5, s[36:39], s7 offen offset:256 sc1
  v_mfma_f32_16x16x32_bf16 v[60:63], v[36:39], v[180:183], v[60:63]
  ds_read_b128 v[32:35], v152 offset:0
  s_waitcnt lgkmcnt(5)
  v_mfma_f32_16x16x32_bf16 v[64:67], v[40:43], v[176:179], v[64:67]
  v_mov_b32 v9, 13
  ds_write_b32 v0, v9
  v_mfma_f32_16x16x32_bf16 v[68:71], v[40:43], v[180:183], v[68:71]
  ds_read_b128 v[36:39], v152 offset:1024
  v_mfma_f32_16x16x32_bf16 v[72:75], v[44:47], v[176:179], v[72:75]
  v_cvt_pk_bf16_f32 v15, v15, v15
  v_lshlrev_b32 v15, 16, v15
  v_mfma_f32_16x16x32_bf16 v[76:79], v[44:47], v[180:183], v[76:79]
  ds_read_b128 v[40:43], v152 offset:2048
  s_waitcnt lgkmcnt(6)
  v_mfma_f32_16x16x32_bf16 v[80:83], v[16:19], v[176:179], v[80:83]
  v_sqrt_f32 v15, v15
  v_mfma_f32_16x16x32_bf16 v[84:87], v[16:19], v[180:183], v[84:87]
  ds_read_b128 v[44:47], v152 offset:3072
  v_mfma_f32_16x16x32_bf16 v[88:91], v[20:23], v[176:179], v[88:91]
  v_cvt_pk_bf16_f32 v15, v15, v15
  v_lshlrev_b32 v15, 16, v15
  v_mfma_f32_16x16x32_bf16 v[92:95], v[20:23], v[180:183], v[92:95]
  ds_read_b128 v[16:19], v152 offset:4096
  s_waitcnt lgkmcnt(6)
  s_waitcnt vmcnt(10)
  v_mfma_f32_16x16x32_bf16 v[48:51], v[24:27], v[184:187], v[48:51]
  s_add_u32 s7, s7, 16896
  buffer_load_dwordx4 v[224:227], v5, s[36:39], s7 offen offset:0 sc1
  v_mfma_f32_16x16x32_bf16 v[52:55], v[24:27], v[188:191], v[52:55]
  ds_read_b128 v[20:23], v152 offset:5120
  v_mfma_f32_16x16x32_bf16 v[56:59], v[28:31], v[184:187], v[56:59]
  buffer_load_dwordx4 v[228:231], v5, s[36:39], s7 offen offset:256 sc1
  v_mfma_f32_16x16x32_bf16 v[60:63], v[28:31], v[188:191], v[60:63]
  ds_read_b128 v[24:27], v152 offset:6144
  s_waitcnt lgkmcnt(5)
  v_mfma_f32_16x16x32_bf16 v[64:67], v[32:35], v[184:187], v[64:67]
  v_sub_f32 v12, 0, v122
  v_rcp_f32 v123, v15
  v_mfma_f32_16x16x32_bf16 v[68:71], v[32:35], v[188:191], v[68:71]
  ds_read_b128 v[28:31], v152 offset:7168
  v_mfma_f32_16x16x32_bf16 v[72:75], v[36:39], v[184:187], v[72:75]
  v_mul_f32 v13, 0xc0135761, v123
  v_mul_f32 v14, v123, v123
  v_mfma_f32_16x16x32_bf16 v[76:79], v[36:39], v[188:191], v[76:79]
  ds_read_b128 v[32:35], v152 offset:8192
  s_waitcnt lgkmcnt(5)
  v_mfma_f32_16x16x32_bf16 v[80:83], v[40:43], v[184:187], v[80:83]
  v_mul_f32 v14, v14, v123
  v_mul_f32 v14, 0xbdd2d3e8, v14
  v_mfma_f32_16x16x32_bf16 v[84:87], v[40:43], v[188:191], v[84:87]
  ds_read_b128 v[36:39], v152 offset:9216
  v_mfma_f32_16x16x32_bf16 v[88:91], v[44:47], v[184:187], v[88:91]
  v_add_f32 v124, v124, v126
  v_add_f32 v125, v125, v127
  v_mfma_f32_16x16x32_bf16 v[92:95], v[44:47], v[188:191], v[92:95]
  ds_read_b128 v[40:43], v152 offset:10240
  s_waitcnt lgkmcnt(5)
  s_waitcnt vmcnt(8)
  v_mfma_f32_16x16x32_bf16 v[48:51], v[16:19], v[192:195], v[48:51]
  s_add_u32 s7, s7, 16896
  s_lshl_b32 s11, s27, 7
  s_sub_u32 s11, s7, s11
  buffer_load_dwordx2 v[232:233], v151, s[36:39], s11 offen offset:0 sc1
  v_mfma_f32_16x16x32_bf16 v[52:55], v[16:19], v[196:199], v[52:55]
  ds_read_b128 v[44:47], v152 offset:11264
  v_mfma_f32_16x16x32_bf16 v[56:59], v[20:23], v[192:195], v[56:59]
  buffer_load_dwordx2 v[234:235], v151, s[36:39], s11 offen offset:2048 sc1
  v_mfma_f32_16x16x32_bf16 v[60:63], v[20:23], v[196:199], v[60:63]
  s_cmp_ge_u32 s77, 15
  s_cbranch_scc1 GG_ro15
GG_rd15:
  ds_read_b128 v[140:143], v153
  s_add_u32 s76, s76, 1
  s_waitcnt lgkmcnt(0)
  v_min_u32 v140, v140, v141
  v_min3_u32 v140, v140, v142, v143
  s_nop 0
  v_readfirstlane_b32 s77, v140
  s_nop 0
  s_cmp_ge_u32 s77, 15
  s_cbranch_scc1 GG_ro15
  s_cmp_lt_u32 s76, 8388608
  s_cbranch_scc1 GG_rd15
GG_ro15:
  ds_read_b128 v[16:19], v3 offset:0
  s_waitcnt lgkmcnt(5)
  v_mfma_f32_16x16x32_bf16 v[64:67], v[24:27], v[192:195], v[64:67]
  buffer_load_dwordx2 v[236:237], v151, s[36:39], s11 offen offset:128 sc1
  v_mfma_f32_16x16x32_bf16 v[68:71], v[24:27], v[196:199], v[68:71]
  ds_read_b128 v[20:23], v3 offset:1024
  v_mfma_f32_16x16x32_bf16 v[72:75], v[28:31], v[192:195], v[72:75]
  buffer_load_dwordx2 v[238:239], v151, s[36:39], s11 offen offset:2176 sc1
  v_mfma_f32_16x16x32_bf16 v[76:79], v[28:31], v[196:199], v[76:79]
  ds_read_b128 v[24:27], v3 offset:2048
  s_waitcnt lgkmcnt(5)
  v_mfma_f32_16x16x32_bf16 v[80:83], v[32:35], v[192:195], v[80:83]
  v_mov_b32 v126, v124
  s_nop 1
  v_permlane16_swap_b32 v124, v126
  v_mfma_f32_16x16x32_bf16 v[84:87], v[32:35], v[196:199], v[84:87]
  ds_read_b128 v[28:31], v3 offset:3072
  v_mfma_f32_16x16x32_bf16 v[88:91], v[36:39], v[192:195], v[88:91]
  v_add_f32 v124, v124, v126
  v_mov_b32 v126, v124
  v_mfma_f32_16x16x32_bf16 v[92:95], v[36:39], v[196:199], v[92:95]
  ds_read_b128 v[32:35], v3 offset:4096
  s_waitcnt lgkmcnt(5)
  s_waitcnt vmcnt(10)
  v_mfma_f32_16x16x32_bf16 v[48:51], v[40:43], v[200:203], v[48:51]
  s_add_u32 s7, s7, 16896
  buffer_load_dwordx4 v[240:243], v5, s[36:39], s7 offen offset:0 sc1
  v_mfma_f32_16x16x32_bf16 v[52:55], v[40:43], v[204:207], v[52:55]
  ds_read_b128 v[36:39], v3 offset:5120
  v_mfma_f32_16x16x32_bf16 v[56:59], v[44:47], v[200:203], v[56:59]
  buffer_load_dwordx4 v[244:247], v5, s[36:39], s7 offen offset:256 sc1
  v_mfma_f32_16x16x32_bf16 v[60:63], v[44:47], v[204:207], v[60:63]
  ds_read_b128 v[40:43], v3 offset:6144
  s_waitcnt lgkmcnt(5)
  v_mfma_f32_16x16x32_bf16 v[64:67], v[16:19], v[200:203], v[64:67]
  v_mov_b32 v9, 14
  ds_write_b32 v0, v9
  v_mfma_f32_16x16x32_bf16 v[68:71], v[16:19], v[204:207], v[68:71]
  ds_read_b128 v[44:47], v3 offset:7168
  v_mfma_f32_16x16x32_bf16 v[72:75], v[20:23], v[200:203], v[72:75]
  v_permlane32_swap_b32 v124, v126
  v_add_f32 v124, v124, v126
  v_mfma_f32_16x16x32_bf16 v[76:79], v[20:23], v[204:207], v[76:79]
  ds_read_b128 v[16:19], v3 offset:8192
  s_waitcnt lgkmcnt(6)
  v_mfma_f32_16x16x32_bf16 v[80:83], v[24:27], v[200:203], v[80:83]
  v_mov_b32 v126, v125
  s_nop 1
  v_permlane16_swap_b32 v125, v126
  v_mfma_f32_16x16x32_bf16 v[84:87], v[24:27], v[204:207], v[84:87]
  ds_read_b128 v[20:23], v3 offset:9216
  v_mfma_f32_16x16x32_bf16 v[88:91], v[28:31], v[200:203], v[88:91]
  v_add_f32 v125, v125, v126
  v_mov_b32 v126, v125
  v_mfma_f32_16x16x32_bf16 v[92:95], v[28:31], v[204:207], v[92:95]
  ds_read_b128 v[24:27], v3 offset:10240
  s_waitcnt lgkmcnt(6)
  s_waitcnt vmcnt(10)
  v_mfma_f32_16x16x32_bf16 v[48:51], v[32:35], v[208:211], v[48:51]
  s_add_u32 s7, s7, 16896
  buffer_load_dwordx4 v[248:251], v5, s[36:39], s7 offen offset:0 sc1
  v_mfma_f32_16x16x32_bf16 v[52:55], v[32:35], v[212:215], v[52:55]
  ds_read_b128 v[28:31], v3 offset:11264
  v_mfma_f32_16x16x32_bf16 v[56:59], v[36:39], v[208:211], v[56:59]
  buffer_load_dwordx4 v[252:255], v5, s[36:39], s7 offen offset:256 sc1
  v_mfma_f32_16x16x32_bf16 v[60:63], v[36:39], v[212:215], v[60:63]
  ds_read_b128 v[32:35], v3 offset:12288
  s_waitcnt lgkmcnt(5)
  v_mfma_f32_16x16x32_bf16 v[64:67], v[40:43], v[208:211], v[64:67]
  v_permlane32_swap_b32 v125, v126
  v_add_f32 v125, v125, v126
  v_mfma_f32_16x16x32_bf16 v[68:71], v[40:43], v[212:215], v[68:71]
  ds_read_b128 v[36:39], v3 offset:13312
  v_mfma_f32_16x16x32_bf16 v[72:75], v[44:47], v[208:211], v[72:75]
  v_mul_f32 v124, 0x3acccccd, v124
  v_mul_f32 v125, 0x3acccccd, v125
  v_mfma_f32_16x16x32_bf16 v[76:79], v[44:47], v[212:215], v[76:79]
  ds_read_b128 v[40:43], v3 offset:14336
  s_waitcnt lgkmcnt(5)
  v_mfma_f32_16x16x32_bf16 v[80:83], v[16:19], v[208:211], v[80:83]
  v_fma_f32 v125, -v124, v124, v125
  v_max_f32 v125, 0, v125
  v_mfma_f32_16x16x32_bf16 v[84:87], v[16:19], v[212:215], v[84:87]
  ds_read_b128 v[44:47], v3 offset:15360
  v_mfma_f32_16x16x32_bf16 v[88:91], v[20:23], v[208:211], v[88:91]
  v_cvt_pk_bf16_f32 v127, v124, v125
  v_lshlrev_b32 v126, 16, v127
  v_mfma_f32_16x16x32_bf16 v[92:95], v[20:23], v[212:215], v[92:95]
  ds_read_b128 v[16:19], v3 offset:16384
  s_waitcnt lgkmcnt(5)
  s_waitcnt vmcnt(10)
  v_mfma_f32_16x16x32_bf16 v[48:51], v[24:27], v[216:219], v[48:51]
  v_and_b32 v147, s40, v127
  v_add_f32 v147, 0x3727c5ac, v147
  v_mfma_f32_16x16x32_bf16 v[52:55], v[24:27], v[220:223], v[52:55]
  ds_read_b128 v[20:23], v3 offset:17408
  v_mfma_f32_16x16x32_bf16 v[56:59], v[28:31], v[216:219], v[56:59]
  v_cvt_pk_bf16_f32 v147, v147, v147
  v_lshlrev_b32 v147, 16, v147
  v_mfma_f32_16x16x32_bf16 v[60:63], v[28:31], v[220:223], v[60:63]
  ds_read_b128 v[24:27], v3 offset:18432
  s_waitcnt lgkmcnt(5)
  v_mfma_f32_16x16x32_bf16 v[64:67], v[32:35], v[216:219], v[64:67]
  v_sqrt_f32 v147, v147
  v_mfma_f32_16x16x32_bf16 v[68:71], v[32:35], v[220:223], v[68:71]
  ds_read_b128 v[28:31], v3 offset:19456
  v_mfma_f32_16x16x32_bf16 v[72:75], v[36:39], v[216:219], v[72:75]
  v_cvt_pk_bf16_f32 v147, v147, v147
  v_lshlrev_b32 v147, 16, v147
  v_mfma_f32_16x16x32_bf16 v[76:79], v[36:39], v[220:223], v[76:79]
  s_cmp_ge_u32 s77, 16
  s_cbranch_scc1 GG_ro16
GG_rd16:
  ds_read_b128 v[140:143], v153
  s_add_u32 s76, s76, 1
  s_waitcnt lgkmcnt(0)
  v_min_u32 v140, v140, v141
  v_min3_u32 v140, v140, v142, v143
  s_nop 0
  v_readfirstlane_b32 s77, v140
  s_nop 0
  s_cmp_ge_u32 s77, 16
  s_cbranch_scc1 GG_ro16
  s_cmp_lt_u32 s76, 8388608
  s_cbranch_scc1 GG_rd16
GG_ro16:
  ds_read_b128 v[32:35], v3 offset:20480
  s_waitcnt lgkmcnt(5)
  v_mfma_f32_16x16x32_bf16 v[80:83], v[40:43], v[216:219], v[80:83]
  v_sub_f32 v144, 0, v126
  v_rcp_f32 v127, v147
  v_mfma_f32_16x16x32_bf16 v[84:87], v[40:43], v[220:223], v[84:87]
  ds_read_b128 v[36:39], v3 offset:21504
  v_mfma_f32_16x16x32_bf16 v[88:91], v[44:47], v[216:219], v[88:91]
  v_mul_f32 v145, 0xc0135761, v127
  v_mul_f32 v146, v127, v127
  v_mfma_f32_16x16x32_bf16 v[92:95], v[44:47], v[220:223], v[92:95]
  ds_read_b128 v[40:43], v3 offset:22528
  s_waitcnt lgkmcnt(5)
  s_waitcnt vmcnt(8)
  v_mfma_f32_16x16x32_bf16 v[48:51], v[16:19], v[224:227], v[48:51]
  v_mul_f32 v146, v146, v127
  v_mul_f32 v146, 0xbdd2d3e8, v146
  v_mfma_f32_16x16x32_bf16 v[52:55], v[16:19], v[228:231], v[52:55]
  ds_read_b128 v[44:47], v3 offset:23552
  v_mfma_f32_16x16x32_bf16 v[56:59], v[20:23], v[224:227], v[56:59]
  v_mfma_f32_16x16x32_bf16 v[60:63], v[20:23], v[228:231], v[60:63]
  ds_read_b128 v[16:19], v3 offset:24576
  s_waitcnt lgkmcnt(5)
  v_mfma_f32_16x16x32_bf16 v[64:67], v[24:27], v[224:227], v[64:67]
  v_mfma_f32_16x16x32_bf16 v[68:71], v[24:27], v[228:231], v[68:71]
  ds_read_b128 v[20:23], v3 offset:25600
  v_mfma_f32_16x16x32_bf16 v[72:75], v[28:31], v[224:227], v[72:75]
  v_mfma_f32_16x16x32_bf16 v[76:79], v[28:31], v[228:231], v[76:79]
  ds_read_b128 v[24:27], v3 offset:26624
  s_waitcnt lgkmcnt(5)
  v_mfma_f32_16x16x32_bf16 v[80:83], v[32:35], v[224:227], v[80:83]
  v_mov_b32 v9, 15
  ds_write_b32 v0, v9
  v_mfma_f32_16x16x32_bf16 v[84:87], v[32:35], v[228:231], v[84:87]
  ds_read_b128 v[28:31], v3 offset:27648
  v_mfma_f32_16x16x32_bf16 v[88:91], v[36:39], v[224:227], v[88:91]
  v_mfma_f32_16x16x32_bf16 v[92:95], v[36:39], v[228:231], v[92:95]
  ds_read_b128 v[32:35], v3 offset:28672
  s_waitcnt lgkmcnt(6)
  s_waitcnt vmcnt(4)
  v_mfma_f32_16x16x32_bf16 v[48:51], v[40:43], v[232:235], v[48:51]
  v_mfma_f32_16x16x32_bf16 v[52:55], v[40:43], v[236:239], v[52:55]
  ds_read_b128 v[36:39], v3 offset:29696
  v_mfma_f32_16x16x32_bf16 v[56:59], v[44:47], v[232:235], v[56:59]
  v_mfma_f32_16x16x32_bf16 v[60:63], v[44:47], v[236:239], v[60:63]
  ds_read_b128 v[40:43], v3 offset:30720
  s_waitcnt lgkmcnt(6)
  v_mfma_f32_16x16x32_bf16 v[64:67], v[16:19], v[232:235], v[64:67]
  v_mfma_f32_16x16x32_bf16 v[68:71], v[16:19], v[236:239], v[68:71]
  ds_read_b128 v[44:47], v3 offset:31744
  v_mfma_f32_16x16x32_bf16 v[72:75], v[20:23], v[232:235], v[72:75]
  v_mfma_f32_16x16x32_bf16 v[76:79], v[20:23], v[236:239], v[76:79]
  ds_read_b128 v[16:19], v3 offset:32768
  s_waitcnt lgkmcnt(5)
  v_mfma_f32_16x16x32_bf16 v[80:83], v[24:27], v[232:235], v[80:83]
  v_mfma_f32_16x16x32_bf16 v[84:87], v[24:27], v[236:239], v[84:87]
  ds_read_b128 v[20:23], v3 offset:33792
  v_mfma_f32_16x16x32_bf16 v[88:91], v[28:31], v[232:235], v[88:91]
  v_mfma_f32_16x16x32_bf16 v[92:95], v[28:31], v[236:239], v[92:95]
  ds_read_b128 v[24:27], v3 offset:34816
  s_waitcnt lgkmcnt(5)
  s_waitcnt vmcnt(2)
  v_mfma_f32_16x16x32_bf16 v[48:51], v[32:35], v[240:243], v[48:51]
  v_mfma_f32_16x16x32_bf16 v[52:55], v[32:35], v[244:247], v[52:55]
  ds_read_b128 v[28:31], v3 offset:35840
  v_mfma_f32_16x16x32_bf16 v[56:59], v[36:39], v[240:243], v[56:59]
  v_mfma_f32_16x16x32_bf16 v[60:63], v[36:39], v[244:247], v[60:63]
  ds_read_b128 v[32:35], v3 offset:36864
  s_waitcnt lgkmcnt(5)
  v_mfma_f32_16x16x32_bf16 v[64:67], v[40:43], v[240:243], v[64:67]
  v_mfma_f32_16x16x32_bf16 v[68:71], v[40:43], v[244:247], v[68:71]
  ds_read_b128 v[36:39], v3 offset:37888
  v_mfma_f32_16x16x32_bf16 v[72:75], v[44:47], v[240:243], v[72:75]
  v_mfma_f32_16x16x32_bf16 v[76:79], v[44:47], v[244:247], v[76:79]
  ds_read_b128 v[40:43], v3 offset:38912
  s_waitcnt lgkmcnt(5)
  v_mfma_f32_16x16x32_bf16 v[80:83], v[16:19], v[240:243], v[80:83]
  v_mfma_f32_16x16x32_bf16 v[84:87], v[16:19], v[244:247], v[84:87]
  ds_read_b128 v[44:47], v3 offset:39936
  v_mfma_f32_16x16x32_bf16 v[88:91], v[20:23], v[240:243], v[88:91]
  v_mfma_f32_16x16x32_bf16 v[92:95], v[20:23], v[244:247], v[92:95]
  s_waitcnt lgkmcnt(4)
  s_waitcnt vmcnt(0)
  v_mfma_f32_16x16x32_bf16 v[48:51], v[24:27], v[248:251], v[48:51]
  v_mfma_f32_16x16x32_bf16 v[52:55], v[24:27], v[252:255], v[52:55]
  v_mfma_f32_16x16x32_bf16 v[56:59], v[28:31], v[248:251], v[56:59]
  v_mfma_f32_16x16x32_bf16 v[60:63], v[28:31], v[252:255], v[60:63]
  s_waitcnt lgkmcnt(2)
  v_mfma_f32_16x16x32_bf16 v[64:67], v[32:35], v[248:251], v[64:67]
  v_mfma_f32_16x16x32_bf16 v[68:71], v[32:35], v[252:255], v[68:71]
  v_mfma_f32_16x16x32_bf16 v[72:75], v[36:39], v[248:251], v[72:75]
  v_mfma_f32_16x16x32_bf16 v[76:79], v[36:39], v[252:255], v[76:79]
  s_waitcnt lgkmcnt(0)
  v_mfma_f32_16x16x32_bf16 v[80:83], v[40:43], v[248:251], v[80:83]
  v_mfma_f32_16x16x32_bf16 v[84:87], v[40:43], v[252:255], v[84:87]
  v_mfma_f32_16x16x32_bf16 v[88:91], v[44:47], v[248:251], v[88:91]
  v_mfma_f32_16x16x32_bf16 v[92:95], v[44:47], v[252:255], v[92:95]
  v_mov_b32 v9, 16
  ds_write_b32 v0, v9
  v_pk_fma_f32 v[128:129], v[12:13], v[96:97], v[48:49] op_sel_hi:[0,1,1]
  v_pk_fma_f32 v[132:133], v[12:13], v[98:99], v[50:51] op_sel_hi:[0,1,1]
  v_pk_mul_f32 v[130:131], v[128:129], v[128:129]
  v_pk_mul_f32 v[134:135], v[132:133], v[132:133]
  v_pk_fma_f32 v[130:131], v[14:15], v[130:131], v[12:13] op_sel:[0,0,1] op_sel_hi:[0,1,1]
  v_pk_fma_f32 v[134:135], v[14:15], v[134:135], v[12:13] op_sel:[0,0,1] op_sel_hi:[0,1,1]
  v_pk_mul_f32 v[130:131], v[130:131], v[128:129]
  v_pk_mul_f32 v[134:135], v[134:135], v[132:133]
  v_exp_f32 v130, v130
  v_exp_f32 v134, v134
  v_exp_f32 v131, v131
  v_exp_f32 v135, v135
  v_pk_fma_f32 v[130:131], v[130:131], v[14:15], v[14:15] op_sel:[0,1,1] op_sel_hi:[1,1,1]
  v_pk_fma_f32 v[134:135], v[134:135], v[14:15], v[14:15] op_sel:[0,1,1] op_sel_hi:[1,1,1]
  v_rcp_f32 v130, v130
  v_rcp_f32 v134, v134
  v_rcp_f32 v131, v131
  v_rcp_f32 v135, v135
  v_pk_mul_f32 v[128:129], v[128:129], v[130:131]
  v_pk_mul_f32 v[132:133], v[132:133], v[134:135]
  v_cvt_pk_bf16_f32 v136, v128, v129
  v_cvt_pk_bf16_f32 v137, v132, v133
  v_pk_fma_f32 v[128:129], v[144:145], v[96:97], v[52:53] op_sel_hi:[0,1,1]
  v_pk_fma_f32 v[132:133], v[144:145], v[98:99], v[54:55] op_sel_hi:[0,1,1]
  v_pk_mul_f32 v[130:131], v[128:129], v[128:129]
  v_pk_mul_f32 v[134:135], v[132:133], v[132:133]
  v_pk_fma_f32 v[130:131], v[146:147], v[130:131], v[144:145] op_sel:[0,0,1] op_sel_hi:[0,1,1]
  v_pk_fma_f32 v[134:135], v[146:147], v[134:135], v[144:145] op_sel:[0,0,1] op_sel_hi:[0,1,1]
  v_pk_mul_f32 v[130:131], v[130:131], v[128:129]
  v_pk_mul_f32 v[134:135], v[134:135], v[132:133]
  v_exp_f32 v130, v130
  v_exp_f32 v134, v134
  v_exp_f32 v131, v131
  v_exp_f32 v135, v135
  v_pk_fma_f32 v[130:131], v[130:131], v[146:147], v[146:147] op_sel:[0,1,1] op_sel_hi:[1,1,1]
  v_pk_fma_f32 v[134:135], v[134:135], v[146:147], v[146:147] op_sel:[0,1,1] op_sel_hi:[1,1,1]
  v_rcp_f32 v130, v130
  v_rcp_f32 v134, v134
  v_rcp_f32 v131, v131
  v_rcp_f32 v135, v135
  v_pk_mul_f32 v[128:129], v[128:129], v[130:131]
  v_pk_mul_f32 v[132:133], v[132:133], v[134:135]
  v_cvt_pk_bf16_f32 v140, v128, v129
  v_cvt_pk_bf16_f32 v141, v132, v133
  v_pk_fma_f32 v[128:129], v[12:13], v[100:101], v[56:57] op_sel_hi:[0,1,1]
  v_pk_fma_f32 v[132:133], v[12:13], v[102:103], v[58:59] op_sel_hi:[0,1,1]
  v_pk_mul_f32 v[130:131], v[128:129], v[128:129]
  v_pk_mul_f32 v[134:135], v[132:133], v[132:133]
  v_pk_fma_f32 v[130:131], v[14:15], v[130:131], v[12:13] op_sel:[0,0,1] op_sel_hi:[0,1,1]
  v_pk_fma_f32 v[134:135], v[14:15], v[134:135], v[12:13] op_sel:[0,0,1] op_sel_hi:[0,1,1]
  v_pk_mul_f32 v[130:131], v[130:131], v[128:129]
  v_pk_mul_f32 v[134:135], v[134:135], v[132:133]
  v_exp_f32 v130, v130
  v_exp_f32 v134, v134
  v_exp_f32 v131, v131
  v_exp_f32 v135, v135
  v_pk_fma_f32 v[130:131], v[130:131], v[14:15], v[14:15] op_sel:[0,1,1] op_sel_hi:[1,1,1]
  v_pk_fma_f32 v[134:135], v[134:135], v[14:15], v[14:15] op_sel:[0,1,1] op_sel_hi:[1,1,1]
  v_rcp_f32 v130, v130
  v_rcp_f32 v134, v134
  v_rcp_f32 v131, v131
  v_rcp_f32 v135, v135
  v_pk_mul_f32 v[128:129], v[128:129], v[130:131]
  v_pk_mul_f32 v[132:133], v[132:133], v[134:135]
  v_cvt_pk_bf16_f32 v138, v128, v129
  v_cvt_pk_bf16_f32 v139, v132, v133
  buffer_store_dwordx4 v[136:139], v3, s[36:39], s17 offen offset:0 sc1
  v_pk_fma_f32 v[128:129], v[144:145], v[100:101], v[60:61] op_sel_hi:[0,1,1]
  v_pk_fma_f32 v[132:133], v[144:145], v[102:103], v[62:63] op_sel_hi:[0,1,1]
  v_pk_mul_f32 v[130:131], v[128:129], v[128:129]
  v_pk_mul_f32 v[134:135], v[132:133], v[132:133]
  v_pk_fma_f32 v[130:131], v[146:147], v[130:131], v[144:145] op_sel:[0,0,1] op_sel_hi:[0,1,1]
  v_pk_fma_f32 v[134:135], v[146:147], v[134:135], v[144:145] op_sel:[0,0,1] op_sel_hi:[0,1,1]
  v_pk_mul_f32 v[130:131], v[130:131], v[128:129]
  v_pk_mul_f32 v[134:135], v[134:135], v[132:133]
  v_exp_f32 v130, v130
  v_exp_f32 v134, v134
  v_exp_f32 v131, v131
  v_exp_f32 v135, v135
  v_pk_fma_f32 v[130:131], v[130:131], v[146:147], v[146:147] op_sel:[0,1,1] op_sel_hi:[1,1,1]
  v_pk_fma_f32 v[134:135], v[134:135], v[146:147], v[146:147] op_sel:[0,1,1] op_sel_hi:[1,1,1]
  v_rcp_f32 v130, v130
  v_rcp_f32 v134, v134
  v_rcp_f32 v131, v131
  v_rcp_f32 v135, v135
  v_pk_mul_f32 v[128:129], v[128:129], v[130:131]
  v_pk_mul_f32 v[132:133], v[132:133], v[134:135]
  v_cvt_pk_bf16_f32 v142, v128, v129
  v_cvt_pk_bf16_f32 v143, v132, v133
  buffer_store_dwordx4 v[140:143], v3, s[36:39], s16 offen offset:0 sc1
  v_pk_fma_f32 v[128:129], v[12:13], v[104:105], v[64:65] op_sel_hi:[0,1,1]
  v_pk_fma_f32 v[132:133], v[12:13], v[106:107], v[66:67] op_sel_hi:[0,1,1]
  v_pk_mul_f32 v[130:131], v[128:129], v[128:129]
  v_pk_mul_f32 v[134:135], v[132:133], v[132:133]
  v_pk_fma_f32 v[130:131], v[14:15], v[130:131], v[12:13] op_sel:[0,0,1] op_sel_hi:[0,1,1]
  v_pk_fma_f32 v[134:135], v[14:15], v[134:135], v[12:13] op_sel:[0,0,1] op_sel_hi:[0,1,1]
  v_pk_mul_f32 v[130:131], v[130:131], v[128:129]
  v_pk_mul_f32 v[134:135], v[134:135], v[132:133]
  v_exp_f32 v130, v130
  v_exp_f32 v134, v134
  v_exp_f32 v131, v131
  v_exp_f32 v135, v135
  v_pk_fma_f32 v[130:131], v[130:131], v[14:15], v[14:15] op_sel:[0,1,1] op_sel_hi:[1,1,1]
  v_pk_fma_f32 v[134:135], v[134:135], v[14:15], v[14:15] op_sel:[0,1,1] op_sel_hi:[1,1,1]
  v_rcp_f32 v130, v130
  v_rcp_f32 v134, v134
  v_rcp_f32 v131, v131
  v_rcp_f32 v135, v135
  v_pk_mul_f32 v[128:129], v[128:129], v[130:131]
  v_pk_mul_f32 v[132:133], v[132:133], v[134:135]
  v_cvt_pk_bf16_f32 v136, v128, v129
  v_cvt_pk_bf16_f32 v137, v132, v133
  v_pk_fma_f32 v[128:129], v[144:145], v[104:105], v[68:69] op_sel_hi:[0,1,1]
  v_pk_fma_f32 v[132:133], v[144:145], v[106:107], v[70:71] op_sel_hi:[0,1,1]
  v_pk_mul_f32 v[130:131], v[128:129], v[128:129]
  v_pk_mul_f32 v[134:135], v[132:133], v[132:133]
  v_pk_fma_f32 v[130:131], v[146:147], v[130:131], v[144:145] op_sel:[0,0,1] op_sel_hi:[0,1,1]
  v_pk_fma_f32 v[134:135], v[146:147], v[134:135], v[144:145] op_sel:[0,0,1] op_sel_hi:[0,1,1]
  v_pk_mul_f32 v[130:131], v[130:131], v[128:129]
  v_pk_mul_f32 v[134:135], v[134:135], v[132:133]
  v_exp_f32 v130, v130
  v_exp_f32 v134, v134
  v_exp_f32 v131, v131
  v_exp_f32 v135, v135
  v_pk_fma_f32 v[130:131], v[130:131], v[146:147], v[146:147] op_sel:[0,1,1] op_sel_hi:[1,1,1]
  v_pk_fma_f32 v[134:135], v[134:135], v[146:147], v[146:147] op_sel:[0,1,1] op_sel_hi:[1,1,1]
  v_rcp_f32 v130, v130
  v_rcp_f32 v134, v134
  v_rcp_f32 v131, v131
  v_rcp_f32 v135, v135
  v_pk_mul_f32 v[128:129], v[128:129], v[130:131]
  v_pk_mul_f32 v[132:133], v[132:133], v[134:135]
  v_cvt_pk_bf16_f32 v140, v128, v129
  v_cvt_pk_bf16_f32 v141, v132, v133
  v_pk_fma_f32 v[128:129], v[12:13], v[108:109], v[72:73] op_sel_hi:[0,1,1]
  v_pk_fma_f32 v[132:133], v[12:13], v[110:111], v[74:75] op_sel_hi:[0,1,1]
  v_pk_mul_f32 v[130:131], v[128:129], v[128:129]
  v_pk_mul_f32 v[134:135], v[132:133], v[132:133]
  v_pk_fma_f32 v[130:131], v[14:15], v[130:131], v[12:13] op_sel:[0,0,1] op_sel_hi:[0,1,1]
  v_pk_fma_f32 v[134:135], v[14:15], v[134:135], v[12:13] op_sel:[0,0,1] op_sel_hi:[0,1,1]
  v_pk_mul_f32 v[130:131], v[130:131], v[128:129]
  v_pk_mul_f32 v[134:135], v[134:135], v[132:133]
  v_exp_f32 v130, v130
  v_exp_f32 v134, v134
  v_exp_f32 v131, v131
  v_exp_f32 v135, v135
  v_pk_fma_f32 v[130:131], v[130:131], v[14:15], v[14:15] op_sel:[0,1,1] op_sel_hi:[1,1,1]
  v_pk_fma_f32 v[134:135], v[134:135], v[14:15], v[14:15] op_sel:[0,1,1] op_sel_hi:[1,1,1]
  v_rcp_f32 v130, v130
  v_rcp_f32 v134, v134
  v_rcp_f32 v131, v131
  v_rcp_f32 v135, v135
  v_pk_mul_f32 v[128:129], v[128:129], v[130:131]
  v_pk_mul_f32 v[132:133], v[132:133], v[134:135]
  v_cvt_pk_bf16_f32 v138, v128, v129
  v_cvt_pk_bf16_f32 v139, v132, v133
  buffer_store_dwordx4 v[136:139], v3, s[36:39], s17 offen offset:1024 sc1
  v_pk_fma_f32 v[128:129], v[144:145], v[108:109], v[76:77] op_sel_hi:[0,1,1]
  v_pk_fma_f32 v[132:133], v[144:145], v[110:111], v[78:79] op_sel_hi:[0,1,1]
  v_pk_mul_f32 v[130:131], v[128:129], v[128:129]
  v_pk_mul_f32 v[134:135], v[132:133], v[132:133]
  v_pk_fma_f32 v[130:131], v[146:147], v[130:131], v[144:145] op_sel:[0,0,1] op_sel_hi:[0,1,1]
  v_pk_fma_f32 v[134:135], v[146:147], v[134:135], v[144:145] op_sel:[0,0,1] op_sel_hi:[0,1,1]
  v_pk_mul_f32 v[130:131], v[130:131], v[128:129]
  v_pk_mul_f32 v[134:135], v[134:135], v[132:133]
  v_exp_f32 v130, v130
  v_exp_f32 v134, v134
  v_exp_f32 v131, v131
  v_exp_f32 v135, v135
  v_pk_fma_f32 v[130:131], v[130:131], v[146:147], v[146:147] op_sel:[0,1,1] op_sel_hi:[1,1,1]
  v_pk_fma_f32 v[134:135], v[134:135], v[146:147], v[146:147] op_sel:[0,1,1] op_sel_hi:[1,1,1]
  v_rcp_f32 v130, v130
  v_rcp_f32 v134, v134
  v_rcp_f32 v131, v131
  v_rcp_f32 v135, v135
  v_pk_mul_f32 v[128:129], v[128:129], v[130:131]
  v_pk_mul_f32 v[132:133], v[132:133], v[134:135]
  v_cvt_pk_bf16_f32 v142, v128, v129
  v_cvt_pk_bf16_f32 v143, v132, v133
  buffer_store_dwordx4 v[140:143], v3, s[36:39], s16 offen offset:1024 sc1
  v_pk_fma_f32 v[128:129], v[12:13], v[112:113], v[80:81] op_sel_hi:[0,1,1]
  v_pk_fma_f32 v[132:133], v[12:13], v[114:115], v[82:83] op_sel_hi:[0,1,1]
  v_pk_mul_f32 v[130:131], v[128:129], v[128:129]
  v_pk_mul_f32 v[134:135], v[132:133], v[132:133]
  v_pk_fma_f32 v[130:131], v[14:15], v[130:131], v[12:13] op_sel:[0,0,1] op_sel_hi:[0,1,1]
  v_pk_fma_f32 v[134:135], v[14:15], v[134:135], v[12:13] op_sel:[0,0,1] op_sel_hi:[0,1,1]
  v_pk_mul_f32 v[130:131], v[130:131], v[128:129]
  v_pk_mul_f32 v[134:135], v[134:135], v[132:133]
  v_exp_f32 v130, v130
  v_exp_f32 v134, v134
  v_exp_f32 v131, v131
  v_exp_f32 v135, v135
  v_pk_fma_f32 v[130:131], v[130:131], v[14:15], v[14:15] op_sel:[0,1,1] op_sel_hi:[1,1,1]
  v_pk_fma_f32 v[134:135], v[134:135], v[14:15], v[14:15] op_sel:[0,1,1] op_sel_hi:[1,1,1]
  v_rcp_f32 v130, v130
  v_rcp_f32 v134, v134
  v_rcp_f32 v131, v131
  v_rcp_f32 v135, v135
  v_pk_mul_f32 v[128:129], v[128:129], v[130:131]
  v_pk_mul_f32 v[132:133], v[132:133], v[134:135]
  v_cvt_pk_bf16_f32 v136, v128, v129
  v_cvt_pk_bf16_f32 v137, v132, v133
  v_pk_fma_f32 v[128:129], v[144:145], v[112:113], v[84:85] op_sel_hi:[0,1,1]
  v_pk_fma_f32 v[132:133], v[144:145], v[114:115], v[86:87] op_sel_hi:[0,1,1]
  v_pk_mul_f32 v[130:131], v[128:129], v[128:129]
  v_pk_mul_f32 v[134:135], v[132:133], v[132:133]
  v_pk_fma_f32 v[130:131], v[146:147], v[130:131], v[144:145] op_sel:[0,0,1] op_sel_hi:[0,1,1]
  v_pk_fma_f32 v[134:135], v[146:147], v[134:135], v[144:145] op_sel:[0,0,1] op_sel_hi:[0,1,1]
  v_pk_mul_f32 v[130:131], v[130:131], v[128:129]
  v_pk_mul_f32 v[134:135], v[134:135], v[132:133]
  v_exp_f32 v130, v130
  v_exp_f32 v134, v134
  v_exp_f32 v131, v131
  v_exp_f32 v135, v135
  v_pk_fma_f32 v[130:131], v[130:131], v[146:147], v[146:147] op_sel:[0,1,1] op_sel_hi:[1,1,1]
  v_pk_fma_f32 v[134:135], v[134:135], v[146:147], v[146:147] op_sel:[0,1,1] op_sel_hi:[1,1,1]
  v_rcp_f32 v130, v130
  v_rcp_f32 v134, v134
  v_rcp_f32 v131, v131
  v_rcp_f32 v135, v135
  v_pk_mul_f32 v[128:129], v[128:129], v[130:131]
  v_pk_mul_f32 v[132:133], v[132:133], v[134:135]
  v_cvt_pk_bf16_f32 v140, v128, v129
  v_cvt_pk_bf16_f32 v141, v132, v133
  v_pk_fma_f32 v[128:129], v[12:13], v[116:117], v[88:89] op_sel_hi:[0,1,1]
  v_pk_fma_f32 v[132:133], v[12:13], v[118:119], v[90:91] op_sel_hi:[0,1,1]
  v_pk_mul_f32 v[130:131], v[128:129], v[128:129]
  v_pk_mul_f32 v[134:135], v[132:133], v[132:133]
  v_pk_fma_f32 v[130:131], v[14:15], v[130:131], v[12:13] op_sel:[0,0,1] op_sel_hi:[0,1,1]
  v_pk_fma_f32 v[134:135], v[14:15], v[134:135], v[12:13] op_sel:[0,0,1] op_sel_hi:[0,1,1]
  v_pk_mul_f32 v[130:131], v[130:131], v[128:129]
  v_pk_mul_f32 v[134:135], v[134:135], v[132:133]
  v_exp_f32 v130, v130
  v_exp_f32 v134, v134
  v_exp_f32 v131, v131
  v_exp_f32 v135, v135
  v_pk_fma_f32 v[130:131], v[130:131], v[14:15], v[14:15] op_sel:[0,1,1] op_sel_hi:[1,1,1]
  v_pk_fma_f32 v[134:135], v[134:135], v[14:15], v[14:15] op_sel:[0,1,1] op_sel_hi:[1,1,1]
  v_rcp_f32 v130, v130
  v_rcp_f32 v134, v134
  v_rcp_f32 v131, v131
  v_rcp_f32 v135, v135
  v_pk_mul_f32 v[128:129], v[128:129], v[130:131]
  v_pk_mul_f32 v[132:133], v[132:133], v[134:135]
  v_cvt_pk_bf16_f32 v138, v128, v129
  v_cvt_pk_bf16_f32 v139, v132, v133
  buffer_store_dwordx4 v[136:139], v3, s[36:39], s17 offen offset:2048 sc1
  v_pk_fma_f32 v[128:129], v[144:145], v[116:117], v[92:93] op_sel_hi:[0,1,1]
  v_pk_fma_f32 v[132:133], v[144:145], v[118:119], v[94:95] op_sel_hi:[0,1,1]
  v_pk_mul_f32 v[130:131], v[128:129], v[128:129]
  v_pk_mul_f32 v[134:135], v[132:133], v[132:133]
  v_pk_fma_f32 v[130:131], v[146:147], v[130:131], v[144:145] op_sel:[0,0,1] op_sel_hi:[0,1,1]
  v_pk_fma_f32 v[134:135], v[146:147], v[134:135], v[144:145] op_sel:[0,0,1] op_sel_hi:[0,1,1]
  v_pk_mul_f32 v[130:131], v[130:131], v[128:129]
  v_pk_mul_f32 v[134:135], v[134:135], v[132:133]
  v_exp_f32 v130, v130
  v_exp_f32 v134, v134
  v_exp_f32 v131, v131
  v_exp_f32 v135, v135
  v_pk_fma_f32 v[130:131], v[130:131], v[146:147], v[146:147] op_sel:[0,1,1] op_sel_hi:[1,1,1]
  v_pk_fma_f32 v[134:135], v[134:135], v[146:147], v[146:147] op_sel:[0,1,1] op_sel_hi:[1,1,1]
  v_rcp_f32 v130, v130
  v_rcp_f32 v134, v134
  v_rcp_f32 v131, v131
  v_rcp_f32 v135, v135
  v_pk_mul_f32 v[128:129], v[128:129], v[130:131]
  v_pk_mul_f32 v[132:133], v[132:133], v[134:135]
  v_cvt_pk_bf16_f32 v142, v128, v129
  v_cvt_pk_bf16_f32 v143, v132, v133
  buffer_store_dwordx4 v[140:143], v3, s[36:39], s16 offen offset:2048 sc1
  s_waitcnt vmcnt(0)
  s_lshr_b32 s12, s26, 1
  s_lshl_b32 s12, s12, 7
  s_lshl_b32 s13, s25, 2
  s_add_u32 s12, s12, s13
  s_add_u32 s12, s12, 33062912
  v_mov_b32 v148, 1
  v_mov_b32 v149, 0
  s_mov_b64 exec, 1
  s_cmp_lg_u32 s75, 0
  s_cbranch_scc1 GG_ff3
  buffer_store_dword v148, v149, s[36:39], s12 offen sc1
  s_branch GG_fe3
GG_ff3:
  buffer_store_dword v148, v149, s[36:39], s12 offen
GG_fe3:
  s_mov_b64 exec, -1
  s_and_b32 s12, s3, 1
  s_lshl_b32 s12, s12, 11
  s_mul_i32 s7, s68, 49152
  s_add_u32 s7, s7, s67
  s_add_u32 s7, s7, s12
  s_add_u32 s7, s7, 694272
  s_xor_b32 s13, s68, 1
  s_sub_u32 s15, s13, s68
  s_mul_i32 s15, s15, 49152
  v_add_u32 v8, s12, v3
  v_add_u32 v9, 0x10000, v8
  v_add_u32 v10, 0x20000, v8
  s_lshl_b32 s57, s20, 6
  s_add_u32 s58, s57, 64
  s_lshl_b32 s59, s21, 6
  s_add_u32 s59, s59, s23
  s_lshl_b32 s12, s6, 4
  v_add_u32 v11, s12, v6
  s_movk_i32 s12, 1280
  v_mul_lo_u32 v11, s12, v11
  v_lshl_add_u32 v11, v7, 4, v11
  s_mul_i32 s12, s3, 5120
  s_add_u32 s12, s12, 0
  v_add_u32 v12, s12, v3
  s_xor_b32 s13, s3, 1
  s_mul_i32 s13, s13, 5120
  s_add_u32 s13, s13, 0
  v_add_u32 v13, s13, v3
  s_cmp_ge_u32 s77, 17
  s_cbranch_scc1 GG_ro17
GG_rd17:
  ds_read_b128 v[140:143], v153
  s_add_u32 s76, s76, 1
  s_waitcnt lgkmcnt(0)
  v_min_u32 v140, v140, v141
  v_min3_u32 v140, v140, v142, v143
  s_nop 0
  v_readfirstlane_b32 s77, v140
  s_nop 0
  s_cmp_ge_u32 s77, 17
  s_cbranch_scc1 GG_ro17
  s_cmp_lt_u32 s76, 8388608
  s_cbranch_scc1 GG_rd17
GG_ro17:
  ds_read_b128 v[16:19], v8 offset:40960
  ds_read_b128 v[20:23], v8 offset:45056
  ds_read_b128 v[24:27], v8 offset:49152
  ds_read_b128 v[28:31], v8 offset:53248
  ds_read_b128 v[32:35], v8 offset:57344
  ds_read_b128 v[36:39], v8 offset:41984
  ds_read_b128 v[40:43], v8 offset:46080
  s_lshr_b32 s12, s6, 1
  s_lshl_b32 s12, s12, 7
  s_add_u32 s12, s12, 33062912
  v_lshl_add_u32 v149, v6, 2, s12
  s_mov_b32 s13, 0
  s_mov_b64 exec, 0xffff
GG_poll3:
  buffer_load_dword v148, v149, s[36:39], 0 offen sc1
  s_waitcnt vmcnt(0)
  v_cmp_ne_u32 vcc, 0, v148
  s_add_u32 s13, s13, 1
  s_cmp_eq_u64 vcc, exec
  s_cbranch_scc1 GG_np3
  s_nop 0
  s_cmp_lt_u32 s13, 400000
  s_cbranch_scc1 GG_poll3
GG_np3:
  s_mov_b64 exec, -1
  s_add_u32 s31, s31, 1
  s_cmp_eq_u32 s31, 12
  s_cselect_b32 s31, 0, s31
  s_lshl_b32 s11, s31, 12
  s_add_u32 s11, s11, s7
  s_add_u32 s14, s11, s15
  buffer_load_dwordx4 v[176:179], v3, s[36:39], s11 offen offset:0 sc1
  buffer_load_dwordx4 v[180:183], v3, s[36:39], s14 offen offset:0 sc1
  buffer_load_dwordx4 v[184:187], v3, s[36:39], s11 offen offset:1024 sc1
  buffer_load_dwordx4 v[188:191], v3, s[36:39], s14 offen offset:1024 sc1
  s_add_u32 s31, s31, 1
  s_cmp_eq_u32 s31, 12
  s_cselect_b32 s31, 0, s31
  s_lshl_b32 s11, s31, 12
  s_add_u32 s11, s11, s7
  s_add_u32 s14, s11, s15
  buffer_load_dwordx4 v[192:195], v3, s[36:39], s11 offen offset:0 sc1
  buffer_load_dwordx4 v[196:199], v3, s[36:39], s14 offen offset:0 sc1
  buffer_load_dwordx4 v[200:203], v3, s[36:39], s11 offen offset:1024 sc1
  buffer_load_dwordx4 v[204:207], v3, s[36:39], s14 offen offset:1024 sc1
  s_waitcnt lgkmcnt(5)
  s_waitcnt vmcnt(6)
  v_mfma_f32_16x16x32_bf16 v[48:51], v[16:19], v[176:179], 0
  s_add_u32 s31, s31, 1
  s_cmp_eq_u32 s31, 12
  s_cselect_b32 s31, 0, s31
  s_lshl_b32 s11, s31, 12
  s_add_u32 s11, s11, s7
  s_add_u32 s14, s11, s15
  buffer_load_dwordx4 v[208:211], v3, s[36:39], s11 offen offset:0 sc1
  v_mfma_f32_16x16x32_bf16 v[68:71], v[16:19], v[180:183], 0
  ds_read_b128 v[44:47], v8 offset:50176
  v_mfma_f32_16x16x32_bf16 v[52:55], v[20:23], v[176:179], 0
  buffer_load_dwordx4 v[212:215], v3, s[36:39], s14 offen offset:0 sc1
  v_mfma_f32_16x16x32_bf16 v[72:75], v[20:23], v[180:183], 0
  ds_read_b128 v[16:19], v8 offset:54272
  s_waitcnt lgkmcnt(5)
  v_mfma_f32_16x16x32_bf16 v[56:59], v[24:27], v[176:179], 0
  buffer_load_dwordx4 v[216:219], v3, s[36:39], s11 offen offset:1024 sc1
  v_mfma_f32_16x16x32_bf16 v[76:79], v[24:27], v[180:183], 0
  ds_read_b128 v[20:23], v8 offset:58368
  v_mfma_f32_16x16x32_bf16 v[60:63], v[28:31], v[176:179], 0
  buffer_load_dwordx4 v[220:223], v3, s[36:39], s14 offen offset:1024 sc1
  v_mfma_f32_16x16x32_bf16 v[80:83], v[28:31], v[180:183], 0
  s_cmp_ge_u32 s77, 18
  s_cbranch_scc1 GG_ro18
GG_rd18:
  ds_read_b128 v[140:143], v153
  s_add_u32 s76, s76, 1
  s_waitcnt lgkmcnt(0)
  v_min_u32 v140, v140, v141
  v_min3_u32 v140, v140, v142, v143
  s_nop 0
  v_readfirstlane_b32 s77, v140
  s_nop 0
  s_cmp_ge_u32 s77, 18
  s_cbranch_scc1 GG_ro18
  s_cmp_lt_u32 s76, 8388608
  s_cbranch_scc1 GG_rd18
GG_ro18:
  ds_read_b128 v[24:27], v8 offset:61440
  s_waitcnt lgkmcnt(5)
  v_mfma_f32_16x16x32_bf16 v[64:67], v[32:35], v[176:179], 0
  s_add_u32 s31, s31, 1
  s_cmp_eq_u32 s31, 12
  s_cselect_b32 s31, 0, s31
  s_lshl_b32 s11, s31, 12
  s_add_u32 s11, s11, s7
  s_add_u32 s14, s11, s15
  buffer_load_dwordx4 v[224:227], v3, s[36:39], s11 offen offset:0 sc1
  v_mfma_f32_16x16x32_bf16 v[84:87], v[32:35], v[180:183], 0
  ds_read_b128 v[28:31], v9 offset:0
  s_waitcnt vmcnt(9)
  v_mfma_f32_16x16x32_bf16 v[48:51], v[36:39], v[184:187], v[48:51]
  buffer_load_dwordx4 v[228:231], v3, s[36:39], s14 offen offset:0 sc1
  v_mfma_f32_16x16x32_bf16 v[68:71], v[36:39], v[188:191], v[68:71]
  ds_read_b128 v[32:35], v9 offset:4096
  s_waitcnt lgkmcnt(5)
  v_mfma_f32_16x16x32_bf16 v[52:55], v[40:43], v[184:187], v[52:55]
  buffer_load_dwordx4 v[232:235], v3, s[36:39], s11 offen offset:1024 sc1
  v_mfma_f32_16x16x32_bf16 v[72:75], v[40:43], v[188:191], v[72:75]
  ds_read_b128 v[36:39], v9 offset:8192
  v_mfma_f32_16x16x32_bf16 v[56:59], v[44:47], v[184:187], v[56:59]
  buffer_load_dwordx4 v[236:239], v3, s[36:39], s14 offen offset:1024 sc1
  v_mfma_f32_16x16x32_bf16 v[76:79], v[44:47], v[188:191], v[76:79]
  ds_read_b128 v[40:43], v9 offset:12288
  s_waitcnt lgkmcnt(5)
  v_mfma_f32_16x16x32_bf16 v[60:63], v[16:19], v[184:187], v[60:63]
  s_add_u32 s31, s31, 1
  s_cmp_eq_u32 s31, 12
  s_cselect_b32 s31, 0, s31
  s_lshl_b32 s11, s31, 12
  s_add_u32 s11, s11, s7
  s_add_u32 s14, s11, s15
  buffer_load_dwordx4 v[240:243], v3, s[36:39], s11 offen offset:0 sc1
  v_mfma_f32_16x16x32_bf16 v[80:83], v[16:19], v[188:191], v[80:83]
  ds_read_b128 v[44:47], v8 offset:62464
  v_mfma_f32_16x16x32_bf16 v[64:67], v[20:23], v[184:187], v[64:67]
  buffer_load_dwordx4 v[244:247], v3, s[36:39], s14 offen offset:0 sc1
  v_mfma_f32_16x16x32_bf16 v[84:87], v[20:23], v[188:191], v[84:87]
  ds_read_b128 v[16:19], v9 offset:1024
  s_waitcnt lgkmcnt(5)
  s_waitcnt vmcnt(12)
  v_mfma_f32_16x16x32_bf16 v[48:51], v[24:27], v[192:195], v[48:51]
  buffer_load_dwordx4 v[248:251], v3, s[36:39], s11 offen offset:1024 sc1
  v_mfma_f32_16x16x32_bf16 v[68:71], v[24:27], v[196:199], v[68:71]
  ds_read_b128 v[20:23], v9 offset:5120
  v_mfma_f32_16x16x32_bf16 v[52:55], v[28:31], v[192:195], v[52:55]
  buffer_load_dwordx4 v[252:255], v3, s[36:39], s14 offen offset:1024 sc1
  v_mfma_f32_16x16x32_bf16 v[72:75], v[28:31], v[196:199], v[72:75]
  ds_read_b128 v[24:27], v9 offset:9216
  s_waitcnt lgkmcnt(5)
  v_mfma_f32_16x16x32_bf16 v[56:59], v[32:35], v[192:195], v[56:59]
  s_add_u32 s31, s31, 1
  s_cmp_eq_u32 s31, 12
  s_cselect_b32 s31, 0, s31
  s_lshl_b32 s11, s31, 12
  s_add_u32 s11, s11, s7
  s_add_u32 s14, s11, s15
  buffer_load_dwordx4 v[176:179], v3, s[36:39], s11 offen offset:0 sc1
  v_mfma_f32_16x16x32_bf16 v[76:79], v[32:35], v[196:199], v[76:79]
  ds_read_b128 v[28:31], v9 offset:13312
  v_mfma_f32_16x16x32_bf16 v[60:63], v[36:39], v[192:195], v[60:63]
  buffer_load_dwordx4 v[180:183], v3, s[36:39], s14 offen offset:0 sc1
  v_mfma_f32_16x16x32_bf16 v[80:83], v[36:39], v[196:199], v[80:83]
  s_cmp_ge_u32 s77, 19
  s_cbranch_scc1 GG_ro19
GG_rd19:
  ds_read_b128 v[140:143], v153
  s_add_u32 s76, s76, 1
  s_waitcnt lgkmcnt(0)
  v_min_u32 v140, v140, v141
  v_min3_u32 v140, v140, v142, v143
  s_nop 0
  v_readfirstlane_b32 s77, v140
  s_nop 0
  s_cmp_ge_u32 s77, 19
  s_cbranch_scc1 GG_ro19
  s_cmp_lt_u32 s76, 8388608
  s_cbranch_scc1 GG_rd19
GG_ro19:
  ds_read_b128 v[32:35], v9 offset:16384
  s_waitcnt lgkmcnt(5)
  v_mfma_f32_16x16x32_bf16 v[64:67], v[40:43], v[192:195], v[64:67]
  v_mov_b32 v91, 17
  ds_write_b32 v0, v91
  v_mfma_f32_16x16x32_bf16 v[84:87], v[40:43], v[196:199], v[84:87]
  ds_read_b128 v[36:39], v9 offset:20480
  s_waitcnt vmcnt(14)
  v_mfma_f32_16x16x32_bf16 v[48:51], v[44:47], v[200:203], v[48:51]
  buffer_load_dwordx4 v[184:187], v3, s[36:39], s11 offen offset:1024 sc1
  v_mfma_f32_16x16x32_bf16 v[68:71], v[44:47], v[204:207], v[68:71]
  ds_read_b128 v[40:43], v9 offset:24576
  s_waitcnt lgkmcnt(6)
  v_mfma_f32_16x16x32_bf16 v[52:55], v[16:19], v[200:203], v[52:55]
  v_mfma_f32_16x16x32_bf16 v[72:75], v[16:19], v[204:207], v[72:75]
  ds_read_b128 v[44:47], v9 offset:28672
  v_mfma_f32_16x16x32_bf16 v[56:59], v[20:23], v[200:203], v[56:59]
  buffer_load_dwordx4 v[188:191], v3, s[36:39], s14 offen offset:1024 sc1
  v_mfma_f32_16x16x32_bf16 v[76:79], v[20:23], v[204:207], v[76:79]
  ds_read_b128 v[16:19], v9 offset:32768
  s_waitcnt lgkmcnt(6)
  v_mfma_f32_16x16x32_bf16 v[60:63], v[24:27], v[200:203], v[60:63]
  v_mfma_f32_16x16x32_bf16 v[80:83], v[24:27], v[204:207], v[80:83]
  ds_read_b128 v[20:23], v9 offset:17408
  v_mfma_f32_16x16x32_bf16 v[64:67], v[28:31], v[200:203], v[64:67]
  v_mfma_f32_16x16x32_bf16 v[84:87], v[28:31], v[204:207], v[84:87]
  ds_read_b128 v[24:27], v9 offset:21504
  s_waitcnt lgkmcnt(5)
  s_waitcnt vmcnt(14)
  v_mfma_f32_16x16x32_bf16 v[48:51], v[32:35], v[208:211], v[48:51]
  s_add_u32 s31, s31, 1
  s_cmp_eq_u32 s31, 12
  s_cselect_b32 s31, 0, s31
  s_lshl_b32 s11, s31, 12
  s_add_u32 s11, s11, s7
  s_add_u32 s14, s11, s15
  buffer_load_dwordx4 v[192:195], v3, s[36:39], s11 offen offset:0 sc1
  v_mfma_f32_16x16x32_bf16 v[68:71], v[32:35], v[212:215], v[68:71]
  ds_read_b128 v[28:31], v9 offset:25600
  v_mfma_f32_16x16x32_bf16 v[52:55], v[36:39], v[208:211], v[52:55]
  v_mov_b32 v91, 18
  ds_write_b32 v0, v91
  v_mfma_f32_16x16x32_bf16 v[72:75], v[36:39], v[212:215], v[72:75]
  ds_read_b128 v[32:35], v9 offset:29696
  s_waitcnt lgkmcnt(6)
  v_mfma_f32_16x16x32_bf16 v[56:59], v[40:43], v[208:211], v[56:59]
  buffer_load_dwordx4 v[196:199], v3, s[36:39], s14 offen offset:0 sc1
  v_mfma_f32_16x16x32_bf16 v[76:79], v[40:43], v[212:215], v[76:79]
  ds_read_b128 v[36:39], v9 offset:33792
  v_mfma_f32_16x16x32_bf16 v[60:63], v[44:47], v[208:211], v[60:63]
  v_lshlrev_b32 v96, 16, v164
  v_mfma_f32_16x16x32_bf16 v[80:83], v[44:47], v[212:215], v[80:83]
  s_cmp_ge_u32 s77, 20
  s_cbranch_scc1 GG_ro20
GG_rd20:
  ds_read_b128 v[140:143], v153
  s_add_u32 s76, s76, 1
  s_waitcnt lgkmcnt(0)
  v_min_u32 v140, v140, v141
  v_min3_u32 v140, v140, v142, v143
  s_nop 0
  v_readfirstlane_b32 s77, v140
  s_nop 0
  s_cmp_ge_u32 s77, 20
  s_cbranch_scc1 GG_ro20
  s_cmp_lt_u32 s76, 8388608
  s_cbranch_scc1 GG_rd20
GG_ro20:
  ds_read_b128 v[40:43], v9 offset:36864
  s_waitcnt lgkmcnt(6)
  v_mfma_f32_16x16x32_bf16 v[64:67], v[16:19], v[208:211], v[64:67]
  v_and_b32 v97, s40, v164
  v_mfma_f32_16x16x32_bf16 v[84:87], v[16:19], v[212:215], v[84:87]
  ds_read_b128 v[44:47], v9 offset:40960
  s_waitcnt vmcnt(14)
  v_mfma_f32_16x16x32_bf16 v[48:51], v[20:23], v[216:219], v[48:51]
  buffer_load_dwordx4 v[200:203], v3, s[36:39], s11 offen offset:1024 sc1
  v_mfma_f32_16x16x32_bf16 v[68:71], v[20:23], v[220:223], v[68:71]
  ds_read_b128 v[16:19], v9 offset:45056
  s_waitcnt lgkmcnt(6)
  v_mfma_f32_16x16x32_bf16 v[52:55], v[24:27], v[216:219], v[52:55]
  v_lshlrev_b32 v120, 16, v154
  v_mfma_f32_16x16x32_bf16 v[72:75], v[24:27], v[220:223], v[72:75]
  ds_read_b128 v[20:23], v9 offset:49152
  v_mfma_f32_16x16x32_bf16 v[56:59], v[28:31], v[216:219], v[56:59]
  buffer_load_dwordx4 v[204:207], v3, s[36:39], s14 offen offset:1024 sc1
  v_mfma_f32_16x16x32_bf16 v[76:79], v[28:31], v[220:223], v[76:79]
  ds_read_b128 v[24:27], v9 offset:53248
  s_waitcnt lgkmcnt(5)
  v_mfma_f32_16x16x32_bf16 v[60:63], v[32:35], v[216:219], v[60:63]
  v_and_b32 v121, s40, v154
  v_mfma_f32_16x16x32_bf16 v[80:83], v[32:35], v[220:223], v[80:83]
  ds_read_b128 v[28:31], v9 offset:37888
  v_mfma_f32_16x16x32_bf16 v[64:67], v[36:39], v[216:219], v[64:67]
  v_lshlrev_b32 v98, 16, v165
  v_mfma_f32_16x16x32_bf16 v[84:87], v[36:39], v[220:223], v[84:87]
  ds_read_b128 v[32:35], v9 offset:41984
  s_waitcnt lgkmcnt(5)
  s_waitcnt vmcnt(14)
  v_mfma_f32_16x16x32_bf16 v[48:51], v[40:43], v[224:227], v[48:51]
  s_add_u32 s31, s31, 1
  s_cmp_eq_u32 s31, 12
  s_cselect_b32 s31, 0, s31
  s_lshl_b32 s11, s31, 12
  s_add_u32 s11, s11, s7
  s_add_u32 s14, s11, s15
  buffer_load_dwordx4 v[208:211], v3, s[36:39], s11 offen offset:0 sc1
  v_mfma_f32_16x16x32_bf16 v[68:71], v[40:43], v[228:231], v[68:71]
  ds_read_b128 v[36:39], v9 offset:46080
  v_mfma_f32_16x16x32_bf16 v[52:55], v[44:47], v[224:227], v[52:55]
  v_mov_b32 v91, 19
  ds_write_b32 v0, v91
  v_mfma_f32_16x16x32_bf16 v[72:75], v[44:47], v[228:231], v[72:75]
  ds_read_b128 v[40:43], v9 offset:50176
  s_waitcnt lgkmcnt(6)
  v_mfma_f32_16x16x32_bf16 v[56:59], v[16:19], v[224:227], v[56:59]
  buffer_load_dwordx4 v[212:215], v3, s[36:39], s14 offen offset:0 sc1
  v_mfma_f32_16x16x32_bf16 v[76:79], v[16:19], v[228:231], v[76:79]
  ds_read_b128 v[44:47], v9 offset:54272
  v_mfma_f32_16x16x32_bf16 v[60:63], v[20:23], v[224:227], v[60:63]
  v_and_b32 v99, s40, v165
  v_mfma_f32_16x16x32_bf16 v[80:83], v[20:23], v[228:231], v[80:83]
  s_cmp_ge_u32 s77, 21
  s_cbranch_scc1 GG_ro21
GG_rd21:
  ds_read_b128 v[140:143], v153
  s_add_u32 s76, s76, 1
  s_waitcnt lgkmcnt(0)
  v_min_u32 v140, v140, v141
  v_min3_u32 v140, v140, v142, v143
  s_nop 0
  v_readfirstlane_b32 s77, v140
  s_nop 0
  s_cmp_ge_u32 s77, 21
  s_cbranch_scc1 GG_ro21
  s_cmp_lt_u32 s76, 8388608
  s_cbranch_scc1 GG_rd21
GG_ro21:
  ds_read_b128 v[16:19], v9 offset:57344
  s_waitcnt lgkmcnt(6)
  v_mfma_f32_16x16x32_bf16 v[64:67], v[24:27], v[224:227], v[64:67]
  v_lshlrev_b32 v122, 16, v155
  v_mfma_f32_16x16x32_bf16 v[84:87], v[24:27], v[228:231], v[84:87]
  ds_read_b128 v[20:23], v9 offset:61440
  s_waitcnt vmcnt(14)
  v_mfma_f32_16x16x32_bf16 v[48:51], v[28:31], v[232:235], v[48:51]
  buffer_load_dwordx4 v[216:219], v3, s[36:39], s11 offen offset:1024 sc1
  v_mfma_f32_16x16x32_bf16 v[68:71], v[28:31], v[236:239], v[68:71]
  ds_read_b128 v[24:27], v10 offset:0
  s_waitcnt lgkmcnt(6)
  v_mfma_f32_16x16x32_bf16 v[52:55], v[32:35], v[232:235], v[52:55]
  v_and_b32 v123, s40, v155
  v_mfma_f32_16x16x32_bf16 v[72:75], v[32:35], v[236:239], v[72:75]
  ds_read_b128 v[28:31], v10 offset:4096
  v_mfma_f32_16x16x32_bf16 v[56:59], v[36:39], v[232:235], v[56:59]
  buffer_load_dwordx4 v[220:223], v3, s[36:39], s14 offen offset:1024 sc1
  v_mfma_f32_16x16x32_bf16 v[76:79], v[36:39], v[236:239], v[76:79]
  ds_read_b128 v[32:35], v10 offset:8192
  s_waitcnt lgkmcnt(5)
  v_mfma_f32_16x16x32_bf16 v[60:63], v[40:43], v[232:235], v[60:63]
  v_lshlrev_b32 v100, 16, v166
  v_mfma_f32_16x16x32_bf16 v[80:83], v[40:43], v[236:239], v[80:83]
  ds_read_b128 v[36:39], v9 offset:58368
  v_mfma_f32_16x16x32_bf16 v[64:67], v[44:47], v[232:235], v[64:67]
  v_and_b32 v101, s40, v166
  v_mfma_f32_16x16x32_bf16 v[84:87], v[44:47], v[236:239], v[84:87]
  ds_read_b128 v[40:43], v9 offset:62464
  s_waitcnt lgkmcnt(5)
  s_waitcnt vmcnt(14)
  v_mfma_f32_16x16x32_bf16 v[48:51], v[16:19], v[240:243], v[48:51]
  s_add_u32 s31, s31, 1
  s_cmp_eq_u32 s31, 12
  s_cselect_b32 s31, 0, s31
  s_lshl_b32 s11, s31, 12
  s_add_u32 s11, s11, s7
  s_add_u32 s14, s11, s15
  buffer_load_dwordx4 v[224:227], v3, s[36:39], s11 offen offset:0 sc1
  v_mfma_f32_16x16x32_bf16 v[68:71], v[16:19], v[244:247], v[68:71]
  ds_read_b128 v[44:47], v10 offset:1024
  v_mfma_f32_16x16x32_bf16 v[52:55], v[20:23], v[240:243], v[52:55]
  v_mov_b32 v91, 20
  ds_write_b32 v0, v91
  v_mfma_f32_16x16x32_bf16 v[72:75], v[20:23], v[244:247], v[72:75]
  ds_read_b128 v[16:19], v10 offset:5120
  s_waitcnt lgkmcnt(6)
  v_mfma_f32_16x16x32_bf16 v[56:59], v[24:27], v[240:243], v[56:59]
  buffer_load_dwordx4 v[228:231], v3, s[36:39], s14 offen offset:0 sc1
  v_mfma_f32_16x16x32_bf16 v[76:79], v[24:27], v[244:247], v[76:79]
  ds_read_b128 v[20:23], v10 offset:9216
  v_mfma_f32_16x16x32_bf16 v[60:63], v[28:31], v[240:243], v[60:63]
  v_lshlrev_b32 v124, 16, v156
  v_mfma_f32_16x16x32_bf16 v[80:83], v[28:31], v[244:247], v[80:83]
  s_cmp_ge_u32 s77, 22
  s_cbranch_scc1 GG_ro22
GG_rd22:
  ds_read_b128 v[140:143], v153
  s_add_u32 s76, s76, 1
  s_waitcnt lgkmcnt(0)
  v_min_u32 v140, v140, v141
  v_min3_u32 v140, v140, v142, v143
  s_nop 0
  v_readfirstlane_b32 s77, v140
  s_nop 0
  s_cmp_ge_u32 s77, 22
  s_cbranch_scc1 GG_ro22
  s_cmp_lt_u32 s76, 8388608
  s_cbranch_scc1 GG_rd22
GG_ro22:
  ds_read_b128 v[24:27], v8 offset:0
  s_waitcnt lgkmcnt(6)
  v_mfma_f32_16x16x32_bf16 v[64:67], v[32:35], v[240:243], v[64:67]
  v_and_b32 v125, s40, v156
  v_mfma_f32_16x16x32_bf16 v[84:87], v[32:35], v[244:247], v[84:87]
  ds_read_b128 v[28:31], v8 offset:4096
  s_waitcnt vmcnt(14)
  v_mfma_f32_16x16x32_bf16 v[48:51], v[36:39], v[248:251], v[48:51]
  buffer_load_dwordx4 v[232:235], v3, s[36:39], s11 offen offset:1024 sc1
  v_mfma_f32_16x16x32_bf16 v[68:71], v[36:39], v[252:255], v[68:71]
  ds_read_b128 v[32:35], v8 offset:8192
  s_waitcnt lgkmcnt(6)
  v_mfma_f32_16x16x32_bf16 v[52:55], v[40:43], v[248:251], v[52:55]
  v_lshlrev_b32 v102, 16, v167
  v_mfma_f32_16x16x32_bf16 v[72:75], v[40:43], v[252:255], v[72:75]
  ds_read_b128 v[36:39], v8 offset:12288
  v_mfma_f32_16x16x32_bf16 v[56:59], v[44:47], v[248:251], v[56:59]
  buffer_load_dwordx4 v[236:239], v3, s[36:39], s14 offen offset:1024 sc1
  v_mfma_f32_16x16x32_bf16 v[76:79], v[44:47], v[252:255], v[76:79]
  ds_read_b128 v[40:43], v8 offset:16384
  s_waitcnt lgkmcnt(5)
  v_mfma_f32_16x16x32_bf16 v[60:63], v[16:19], v[248:251], v[60:63]
  v_and_b32 v103, s40, v167
  v_mfma_f32_16x16x32_bf16 v[80:83], v[16:19], v[252:255], v[80:83]
  ds_read_b128 v[44:47], v8 offset:1024
  v_mfma_f32_16x16x32_bf16 v[64:67], v[20:23], v[248:251], v[64:67]
  v_lshlrev_b32 v126, 16, v157
  v_mfma_f32_16x16x32_bf16 v[84:87], v[20:23], v[252:255], v[84:87]
  ds_read_b128 v[16:19], v8 offset:5120
  s_waitcnt lgkmcnt(5)
  s_waitcnt vmcnt(14)
  v_mfma_f32_16x16x32_bf16 v[48:51], v[24:27], v[176:179], v[48:51]
  s_add_u32 s31, s31, 1
  s_cmp_eq_u32 s31, 12
  s_cselect_b32 s31, 0, s31
  s_lshl_b32 s11, s31, 12
  s_add_u32 s11, s11, s7
  s_add_u32 s14, s11, s15
  buffer_load_dwordx4 v[240:243], v3, s[36:39], s11 offen offset:0 sc1
  v_mfma_f32_16x16x32_bf16 v[68:71], v[24:27], v[180:183], v[68:71]
  ds_read_b128 v[20:23], v8 offset:9216
  v_mfma_f32_16x16x32_bf16 v[52:55], v[28:31], v[176:179], v[52:55]
  v_mov_b32 v91, 21
  ds_write_b32 v0, v91
  v_mfma_f32_16x16x32_bf16 v[72:75], v[28:31], v[180:183], v[72:75]
  ds_read_b128 v[24:27], v8 offset:13312
  s_waitcnt lgkmcnt(6)
  v_mfma_f32_16x16x32_bf16 v[56:59], v[32:35], v[176:179], v[56:59]
  buffer_load_dwordx4 v[244:247], v3, s[36:39], s14 offen offset:0 sc1
  v_mfma_f32_16x16x32_bf16 v[76:79], v[32:35], v[180:183], v[76:79]
  ds_read_b128 v[28:31], v8 offset:17408
  v_mfma_f32_16x16x32_bf16 v[60:63], v[36:39], v[176:179], v[60:63]
  v_and_b32 v127, s40, v157
  v_mfma_f32_16x16x32_bf16 v[80:83], v[36:39], v[180:183], v[80:83]
  s_cmp_ge_u32 s77, 23
  s_cbranch_scc1 GG_ro23
GG_rd23:
  ds_read_b128 v[140:143], v153
  s_add_u32 s76, s76, 1
  s_waitcnt lgkmcnt(0)
  v_min_u32 v140, v140, v141
  v_min3_u32 v140, v140, v142, v143
  s_nop 0
  v_readfirstlane_b32 s77, v140
  s_nop 0
  s_cmp_ge_u32 s77, 23
  s_cbranch_scc1 GG_ro23
  s_cmp_lt_u32 s76, 8388608
  s_cbranch_scc1 GG_rd23
GG_ro23:
  ds_read_b128 v[32:35], v8 offset:20480
  s_waitcnt lgkmcnt(6)
  v_mfma_f32_16x16x32_bf16 v[64:67], v[40:43], v[176:179], v[64:67]
  v_lshlrev_b32 v104, 16, v168
  v_mfma_f32_16x16x32_bf16 v[84:87], v[40:43], v[180:183], v[84:87]
  ds_read_b128 v[36:39], v8 offset:24576
  s_waitcnt vmcnt(14)
  v_mfma_f32_16x16x32_bf16 v[48:51], v[44:47], v[184:187], v[48:51]
  buffer_load_dwordx4 v[248:251], v3, s[36:39], s11 offen offset:1024 sc1
  v_mfma_f32_16x16x32_bf16 v[68:71], v[44:47], v[188:191], v[68:71]
  ds_read_b128 v[40:43], v8 offset:28672
  s_waitcnt lgkmcnt(6)
  v_mfma_f32_16x16x32_bf16 v[52:55], v[16:19], v[184:187], v[52:55]
  v_and_b32 v105, s40, v168
  v_mfma_f32_16x16x32_bf16 v[72:75], v[16:19], v[188:191], v[72:75]
  ds_read_b128 v[44:47], v8 offset:32768
  v_mfma_f32_16x16x32_bf16 v[56:59], v[20:23], v[184:187], v[56:59]
  buffer_load_dwordx4 v[252:255], v3, s[36:39], s14 offen offset:1024 sc1
  v_mfma_f32_16x16x32_bf16 v[76:79], v[20:23], v[188:191], v[76:79]
  ds_read_b128 v[16:19], v8 offset:36864
  s_waitcnt lgkmcnt(5)
  v_mfma_f32_16x16x32_bf16 v[60:63], v[24:27], v[184:187], v[60:63]
  v_lshlrev_b32 v128, 16, v158
  v_mfma_f32_16x16x32_bf16 v[80:83], v[24:27], v[188:191], v[80:83]
  ds_read_b128 v[20:23], v8 offset:21504
  v_mfma_f32_16x16x32_bf16 v[64:67], v[28:31], v[184:187], v[64:67]
  v_and_b32 v129, s40, v158
  v_mfma_f32_16x16x32_bf16 v[84:87], v[28:31], v[188:191], v[84:87]
  ds_read_b128 v[24:27], v8 offset:25600
  s_waitcnt lgkmcnt(5)
  s_waitcnt vmcnt(14)
  v_mfma_f32_16x16x32_bf16 v[48:51], v[32:35], v[192:195], v[48:51]
  s_add_u32 s31, s31, 1
  s_cmp_eq_u32 s31, 12
  s_cselect_b32 s31, 0, s31
  s_lshl_b32 s11, s31, 12
  s_add_u32 s11, s11, s7
  s_add_u32 s14, s11, s15
  buffer_load_dwordx4 v[176:179], v3, s[36:39], s11 offen offset:0 sc1
  v_mfma_f32_16x16x32_bf16 v[68:71], v[32:35], v[196:199], v[68:71]
  ds_read_b128 v[28:31], v8 offset:29696
  v_mfma_f32_16x16x32_bf16 v[52:55], v[36:39], v[192:195], v[52:55]
  v_mov_b32 v91, 22
  ds_write_b32 v0, v91
  v_mfma_f32_16x16x32_bf16 v[72:75], v[36:39], v[196:199], v[72:75]
  ds_read_b128 v[32:35], v8 offset:33792
  s_waitcnt lgkmcnt(6)
  v_mfma_f32_16x16x32_bf16 v[56:59], v[40:43], v[192:195], v[56:59]
  buffer_load_dwordx4 v[180:183], v3, s[36:39], s14 offen offset:0 sc1
  v_mfma_f32_16x16x32_bf16 v[76:79], v[40:43], v[196:199], v[76:79]
  ds_read_b128 v[36:39], v8 offset:37888
  v_mfma_f32_16x16x32_bf16 v[60:63], v[44:47], v[192:195], v[60:63]
  v_lshlrev_b32 v106, 16, v169
  v_mfma_f32_16x16x32_bf16 v[80:83], v[44:47], v[196:199], v[80:83]
  s_cmp_ge_u32 s77, 24
  s_cbranch_scc1 GG_ro24
GG_rd24:
  ds_read_b128 v[140:143], v153
  s_add_u32 s76, s76, 1
  s_waitcnt lgkmcnt(0)
  v_min_u32 v140, v140, v141
  v_min3_u32 v140, v140, v142, v143
  s_nop 0
  v_readfirstlane_b32 s77, v140
  s_nop 0
  s_cmp_ge_u32 s77, 24
  s_cbranch_scc1 GG_ro24
  s_cmp_lt_u32 s76, 8388608
  s_cbranch_scc1 GG_rd24
GG_ro24:
  ds_read_b128 v[40:43], v8 offset:40960
  s_waitcnt lgkmcnt(6)
  v_mfma_f32_16x16x32_bf16 v[64:67], v[16:19], v[192:195], v[64:67]
  v_and_b32 v107, s40, v169
  v_mfma_f32_16x16x32_bf16 v[84:87], v[16:19], v[196:199], v[84:87]
  ds_read_b128 v[44:47], v8 offset:45056
  s_waitcnt vmcnt(14)
  v_mfma_f32_16x16x32_bf16 v[48:51], v[20:23], v[200:203], v[48:51]
  buffer_load_dwordx4 v[184:187], v3, s[36:39], s11 offen offset:1024 sc1
  v_mfma_f32_16x16x32_bf16 v[68:71], v[20:23], v[204:207], v[68:71]
  ds_read_b128 v[16:19], v8 offset:49152
  s_waitcnt lgkmcnt(6)
  v_mfma_f32_16x16x32_bf16 v[52:55], v[24:27], v[200:203], v[52:55]
  v_lshlrev_b32 v130, 16, v159
  v_mfma_f32_16x16x32_bf16 v[72:75], v[24:27], v[204:207], v[72:75]
  ds_read_b128 v[20:23], v8 offset:53248
  v_mfma_f32_16x16x32_bf16 v[56:59], v[28:31], v[200:203], v[56:59]
  buffer_load_dwordx4 v[188:191], v3, s[36:39], s14 offen offset:1024 sc1
  v_mfma_f32_16x16x32_bf16 v[76:79], v[28:31], v[204:207], v[76:79]
  ds_read_b128 v[24:27], v8 offset:57344
  s_waitcnt lgkmcnt(5)
  v_mfma_f32_16x16x32_bf16 v[60:63], v[32:35], v[200:203], v[60:63]
  v_and_b32 v131, s40, v159
  v_mfma_f32_16x16x32_bf16 v[80:83], v[32:35], v[204:207], v[80:83]
  ds_read_b128 v[28:31], v8 offset:41984
  v_mfma_f32_16x16x32_bf16 v[64:67], v[36:39], v[200:203], v[64:67]
  v_lshlrev_b32 v108, 16, v170
  v_mfma_f32_16x16x32_bf16 v[84:87], v[36:39], v[204:207], v[84:87]
  ds_read_b128 v[32:35], v8 offset:46080
  s_waitcnt lgkmcnt(5)
  s_waitcnt vmcnt(14)
  v_mfma_f32_16x16x32_bf16 v[48:51], v[40:43], v[208:211], v[48:51]
  s_add_u32 s31, s31, 1
  s_cmp_eq_u32 s31, 12
  s_cselect_b32 s31, 0, s31
  s_lshl_b32 s11, s31, 12
  s_add_u32 s11, s11, s7
  s_add_u32 s14, s11, s15
  buffer_load_dwordx4 v[192:195], v3, s[36:39], s11 offen offset:0 sc1
  v_mfma_f32_16x16x32_bf16 v[68:71], v[40:43], v[212:215], v[68:71]
  ds_read_b128 v[36:39], v8 offset:50176
  v_mfma_f32_16x16x32_bf16 v[52:55], v[44:47], v[208:211], v[52:55]
  v_and_b32 v109, s40, v170
  v_mfma_f32_16x16x32_bf16 v[72:75], v[44:47], v[212:215], v[72:75]
  ds_read_b128 v[40:43], v8 offset:54272
  s_waitcnt lgkmcnt(5)
  v_mfma_f32_16x16x32_bf16 v[56:59], v[16:19], v[208:211], v[56:59]
  buffer_load_dwordx4 v[196:199], v3, s[36:39], s14 offen offset:0 sc1
  v_mfma_f32_16x16x32_bf16 v[76:79], v[16:19], v[212:215], v[76:79]
  ds_read_b128 v[44:47], v8 offset:58368
  v_mfma_f32_16x16x32_bf16 v[60:63], v[20:23], v[208:211], v[60:63]
  v_lshlrev_b32 v132, 16, v160
  v_mfma_f32_16x16x32_bf16 v[80:83], v[20:23], v[212:215], v[80:83]
  s_cmp_ge_u32 s77, 25
  s_cbranch_scc1 GG_ro25
GG_rd25:
  ds_read_b128 v[140:143], v153
  s_add_u32 s76, s76, 1
  s_waitcnt lgkmcnt(0)
  v_min_u32 v140, v140, v141
  v_min3_u32 v140, v140, v142, v143
  s_nop 0
  v_readfirstlane_b32 s77, v140
  s_nop 0
  s_cmp_ge_u32 s77, 25
  s_cbranch_scc1 GG_ro25
  s_cmp_lt_u32 s76, 8388608
  s_cbranch_scc1 GG_rd25
GG_ro25:
  ds_read_b128 v[16:19], v8 offset:61440
  s_waitcnt lgkmcnt(5)
  v_mfma_f32_16x16x32_bf16 v[64:67], v[24:27], v[208:211], v[64:67]
  v_and_b32 v133, s40, v160
  v_mfma_f32_16x16x32_bf16 v[84:87], v[24:27], v[212:215], v[84:87]
  ds_read_b128 v[20:23], v9 offset:0
  s_waitcnt vmcnt(14)
  v_mfma_f32_16x16x32_bf16 v[48:51], v[28:31], v[216:219], v[48:51]
  buffer_load_dwordx4 v[200:203], v3, s[36:39], s11 offen offset:1024 sc1
  v_mfma_f32_16x16x32_bf16 v[68:71], v[28:31], v[220:223], v[68:71]
  ds_read_b128 v[24:27], v9 offset:4096
  s_waitcnt lgkmcnt(5)
  v_mfma_f32_16x16x32_bf16 v[52:55], v[32:35], v[216:219], v[52:55]
  v_lshlrev_b32 v110, 16, v171
  v_mfma_f32_16x16x32_bf16 v[72:75], v[32:35], v[220:223], v[72:75]
  ds_read_b128 v[28:31], v9 offset:8192
  v_mfma_f32_16x16x32_bf16 v[56:59], v[36:39], v[216:219], v[56:59]
  buffer_load_dwordx4 v[204:207], v3, s[36:39], s14 offen offset:1024 sc1
  v_mfma_f32_16x16x32_bf16 v[76:79], v[36:39], v[220:223], v[76:79]
  ds_read_b128 v[32:35], v9 offset:12288
  s_waitcnt lgkmcnt(5)
  v_mfma_f32_16x16x32_bf16 v[60:63], v[40:43], v[216:219], v[60:63]
  v_and_b32 v111, s40, v171
  v_mfma_f32_16x16x32_bf16 v[80:83], v[40:43], v[220:223], v[80:83]
  ds_read_b128 v[36:39], v8 offset:62464
  v_mfma_f32_16x16x32_bf16 v[64:67], v[44:47], v[216:219], v[64:67]
  v_lshlrev_b32 v134, 16, v161
  v_mfma_f32_16x16x32_bf16 v[84:87], v[44:47], v[220:223], v[84:87]
  ds_read_b128 v[40:43], v9 offset:1024
  s_waitcnt lgkmcnt(5)
  s_waitcnt vmcnt(14)
  v_mfma_f32_16x16x32_bf16 v[48:51], v[16:19], v[224:227], v[48:51]
  v_and_b32 v135, s40, v161
  v_mfma_f32_16x16x32_bf16 v[68:71], v[16:19], v[228:231], v[68:71]
  ds_read_b128 v[44:47], v9 offset:5120
  v_mfma_f32_16x16x32_bf16 v[52:55], v[20:23], v[224:227], v[52:55]
  v_lshlrev_b32 v112, 16, v172
  v_mfma_f32_16x16x32_bf16 v[72:75], v[20:23], v[228:231], v[72:75]
  ds_read_b128 v[16:19], v9 offset:9216
  s_waitcnt lgkmcnt(5)
  v_mfma_f32_16x16x32_bf16 v[56:59], v[24:27], v[224:227], v[56:59]
  v_and_b32 v113, s40, v172
  v_mfma_f32_16x16x32_bf16 v[76:79], v[24:27], v[228:231], v[76:79]
  ds_read_b128 v[20:23], v9 offset:13312
  v_mfma_f32_16x16x32_bf16 v[60:63], v[28:31], v[224:227], v[60:63]
  v_lshlrev_b32 v136, 16, v162
  v_mfma_f32_16x16x32_bf16 v[80:83], v[28:31], v[228:231], v[80:83]
  s_cmp_ge_u32 s77, 26
  s_cbranch_scc1 GG_ro26
GG_rd26:
  ds_read_b128 v[140:143], v153
  s_add_u32 s76, s76, 1
  s_waitcnt lgkmcnt(0)
  v_min_u32 v140, v140, v141
  v_min3_u32 v140, v140, v142, v143
  s_nop 0
  v_readfirstlane_b32 s77, v140
  s_nop 0
  s_cmp_ge_u32 s77, 26
  s_cbranch_scc1 GG_ro26
  s_cmp_lt_u32 s76, 8388608
  s_cbranch_scc1 GG_rd26
GG_ro26:
  ds_read_b128 v[24:27], v9 offset:16384
  s_waitcnt lgkmcnt(5)
  v_mfma_f32_16x16x32_bf16 v[64:67], v[32:35], v[224:227], v[64:67]
  v_and_b32 v137, s40, v162
  v_mfma_f32_16x16x32_bf16 v[84:87], v[32:35], v[228:231], v[84:87]
  ds_read_b128 v[28:31], v9 offset:20480
  s_waitcnt vmcnt(12)
  v_mfma_f32_16x16x32_bf16 v[48:51], v[36:39], v[232:235], v[48:51]
  v_lshlrev_b32 v114, 16, v173
  v_mfma_f32_16x16x32_bf16 v[68:71], v[36:39], v[236:239], v[68:71]
  ds_read_b128 v[32:35], v9 offset:24576
  s_waitcnt lgkmcnt(5)
  v_mfma_f32_16x16x32_bf16 v[52:55], v[40:43], v[232:235], v[52:55]
  v_and_b32 v115, s40, v173
  v_mfma_f32_16x16x32_bf16 v[72:75], v[40:43], v[236:239], v[72:75]
  ds_read_b128 v[36:39], v9 offset:28672
  v_mfma_f32_16x16x32_bf16 v[56:59], v[44:47], v[232:235], v[56:59]
  v_lshlrev_b32 v138, 16, v163
  v_mfma_f32_16x16x32_bf16 v[76:79], v[44:47], v[236:239], v[76:79]
  ds_read_b128 v[40:43], v9 offset:32768
  s_waitcnt lgkmcnt(5)
  v_mfma_f32_16x16x32_bf16 v[60:63], v[16:19], v[232:235], v[60:63]
  v_and_b32 v139, s40, v163
  v_mfma_f32_16x16x32_bf16 v[80:83], v[16:19], v[236:239], v[80:83]
  ds_read_b128 v[44:47], v9 offset:17408
  v_mfma_f32_16x16x32_bf16 v[64:67], v[20:23], v[232:235], v[64:67]
  v_mfma_f32_16x16x32_bf16 v[84:87], v[20:23], v[236:239], v[84:87]
  ds_read_b128 v[16:19], v9 offset:21504
  s_waitcnt lgkmcnt(5)
  s_waitcnt vmcnt(10)
  v_mfma_f32_16x16x32_bf16 v[48:51], v[24:27], v[240:243], v[48:51]
  v_mfma_f32_16x16x32_bf16 v[68:71], v[24:27], v[244:247], v[68:71]
  ds_read_b128 v[20:23], v9 offset:25600
  v_mfma_f32_16x16x32_bf16 v[52:55], v[28:31], v[240:243], v[52:55]
  v_mfma_f32_16x16x32_bf16 v[72:75], v[28:31], v[244:247], v[72:75]
  ds_read_b128 v[24:27], v9 offset:29696
  s_waitcnt lgkmcnt(5)
  v_mfma_f32_16x16x32_bf16 v[56:59], v[32:35], v[240:243], v[56:59]
  v_mfma_f32_16x16x32_bf16 v[76:79], v[32:35], v[244:247], v[76:79]
  ds_read_b128 v[28:31], v9 offset:33792
  v_mfma_f32_16x16x32_bf16 v[60:63], v[36:39], v[240:243], v[60:63]
  v_mfma_f32_16x16x32_bf16 v[80:83], v[36:39], v[244:247], v[80:83]
  s_cmp_ge_u32 s77, 27
  s_cbranch_scc1 GG_ro27
GG_rd27:
  ds_read_b128 v[140:143], v153
  s_add_u32 s76, s76, 1
  s_waitcnt lgkmcnt(0)
  v_min_u32 v140, v140, v141
  v_min3_u32 v140, v140, v142, v143
  s_nop 0
  v_readfirstlane_b32 s77, v140
  s_nop 0
  s_cmp_ge_u32 s77, 27
  s_cbranch_scc1 GG_ro27
  s_cmp_lt_u32 s76, 8388608
  s_cbranch_scc1 GG_rd27
GG_ro27:
  ds_read_b128 v[32:35], v9 offset:36864
  s_waitcnt lgkmcnt(5)
  v_mfma_f32_16x16x32_bf16 v[64:67], v[40:43], v[240:243], v[64:67]
  v_mfma_f32_16x16x32_bf16 v[84:87], v[40:43], v[244:247], v[84:87]
  ds_read_b128 v[36:39], v9 offset:40960
  s_waitcnt vmcnt(8)
  v_mfma_f32_16x16x32_bf16 v[48:51], v[44:47], v[248:251], v[48:51]
  v_mfma_f32_16x16x32_bf16 v[68:71], v[44:47], v[252:255], v[68:71]
  ds_read_b128 v[40:43], v9 offset:45056
  s_waitcnt lgkmcnt(5)
  v_mfma_f32_16x16x32_bf16 v[52:55], v[16:19], v[248:251], v[52:55]
  v_mfma_f32_16x16x32_bf16 v[72:75], v[16:19], v[252:255], v[72:75]
  ds_read_b128 v[44:47], v9 offset:49152
  v_mfma_f32_16x16x32_bf16 v[56:59], v[20:23], v[248:251], v[56:59]
  v_mfma_f32_16x16x32_bf16 v[76:79], v[20:23], v[252:255], v[76:79]
  ds_read_b128 v[16:19], v9 offset:53248
  s_waitcnt lgkmcnt(5)
  v_mfma_f32_16x16x32_bf16 v[60:63], v[24:27], v[248:251], v[60:63]
  v_mfma_f32_16x16x32_bf16 v[80:83], v[24:27], v[252:255], v[80:83]
  ds_read_b128 v[20:23], v9 offset:37888
  v_mfma_f32_16x16x32_bf16 v[64:67], v[28:31], v[248:251], v[64:67]
  v_mfma_f32_16x16x32_bf16 v[84:87], v[28:31], v[252:255], v[84:87]
  ds_read_b128 v[24:27], v9 offset:41984
  s_waitcnt lgkmcnt(5)
  s_waitcnt vmcnt(6)
  v_mfma_f32_16x16x32_bf16 v[48:51], v[32:35], v[176:179], v[48:51]
  v_mfma_f32_16x16x32_bf16 v[68:71], v[32:35], v[180:183], v[68:71]
  ds_read_b128 v[28:31], v9 offset:46080
  v_mfma_f32_16x16x32_bf16 v[52:55], v[36:39], v[176:179], v[52:55]
  v_mfma_f32_16x16x32_bf16 v[72:75], v[36:39], v[180:183], v[72:75]
  ds_read_b128 v[32:35], v9 offset:50176
  s_waitcnt lgkmcnt(5)
  v_mfma_f32_16x16x32_bf16 v[56:59], v[40:43], v[176:179], v[56:59]
  v_mfma_f32_16x16x32_bf16 v[76:79], v[40:43], v[180:183], v[76:79]
  ds_read_b128 v[36:39], v9 offset:54272
  v_mfma_f32_16x16x32_bf16 v[60:63], v[44:47], v[176:179], v[60:63]
  v_mfma_f32_16x16x32_bf16 v[80:83], v[44:47], v[180:183], v[80:83]
  s_cmp_ge_u32 s77, 28
  s_cbranch_scc1 GG_ro28
GG_rd28:
  ds_read_b128 v[140:143], v153
  s_add_u32 s76, s76, 1
  s_waitcnt lgkmcnt(0)
  v_min_u32 v140, v140, v141
  v_min3_u32 v140, v140, v142, v143
  s_nop 0
  v_readfirstlane_b32 s77, v140
  s_nop 0
  s_cmp_ge_u32 s77, 28
  s_cbranch_scc1 GG_ro28
  s_cmp_lt_u32 s76, 8388608
  s_cbranch_scc1 GG_rd28
GG_ro28:
  ds_read_b128 v[40:43], v9 offset:57344
  s_waitcnt lgkmcnt(5)
  v_mfma_f32_16x16x32_bf16 v[64:67], v[16:19], v[176:179], v[64:67]
  v_mfma_f32_16x16x32_bf16 v[84:87], v[16:19], v[180:183], v[84:87]
  ds_read_b128 v[44:47], v9 offset:61440
  s_waitcnt vmcnt(4)
  v_mfma_f32_16x16x32_bf16 v[48:51], v[20:23], v[184:187], v[48:51]
  v_mfma_f32_16x16x32_bf16 v[68:71], v[20:23], v[188:191], v[68:71]
  ds_read_b128 v[16:19], v10 offset:0
  s_waitcnt lgkmcnt(5)
  v_mfma_f32_16x16x32_bf16 v[52:55], v[24:27], v[184:187], v[52:55]
  v_mfma_f32_16x16x32_bf16 v[72:75], v[24:27], v[188:191], v[72:75]
  ds_read_b128 v[20:23], v10 offset:4096
  v_mfma_f32_16x16x32_bf16 v[56:59], v[28:31], v[184:187], v[56:59]
  v_mfma_f32_16x16x32_bf16 v[76:79], v[28:31], v[188:191], v[76:79]
  ds_read_b128 v[24:27], v10 offset:8192
  s_waitcnt lgkmcnt(5)
  v_mfma_f32_16x16x32_bf16 v[60:63], v[32:35], v[184:187], v[60:63]
  v_mfma_f32_16x16x32_bf16 v[80:83], v[32:35], v[188:191], v[80:83]
  ds_read_b128 v[28:31], v9 offset:58368
  v_mfma_f32_16x16x32_bf16 v[64:67], v[36:39], v[184:187], v[64:67]
  v_mfma_f32_16x16x32_bf16 v[84:87], v[36:39], v[188:191], v[84:87]
  ds_read_b128 v[32:35], v9 offset:62464
  s_waitcnt lgkmcnt(5)
  s_waitcnt vmcnt(2)
  v_mfma_f32_16x16x32_bf16 v[48:51], v[40:43], v[192:195], v[48:51]
  v_mfma_f32_16x16x32_bf16 v[68:71], v[40:43], v[196:199], v[68:71]
  ds_read_b128 v[36:39], v10 offset:1024
  v_mfma_f32_16x16x32_bf16 v[52:55], v[44:47], v[192:195], v[52:55]
  v_mfma_f32_16x16x32_bf16 v[72:75], v[44:47], v[196:199], v[72:75]
  ds_read_b128 v[40:43], v10 offset:5120
  s_waitcnt lgkmcnt(5)
  v_mfma_f32_16x16x32_bf16 v[56:59], v[16:19], v[192:195], v[56:59]
  v_mfma_f32_16x16x32_bf16 v[76:79], v[16:19], v[196:199], v[76:79]
  ds_read_b128 v[44:47], v10 offset:9216
  v_mfma_f32_16x16x32_bf16 v[60:63], v[20:23], v[192:195], v[60:63]
  v_mfma_f32_16x16x32_bf16 v[80:83], v[20:23], v[196:199], v[80:83]
  s_waitcnt lgkmcnt(4)
  v_mfma_f32_16x16x32_bf16 v[64:67], v[24:27], v[192:195], v[64:67]
  v_mfma_f32_16x16x32_bf16 v[84:87], v[24:27], v[196:199], v[84:87]
  s_waitcnt vmcnt(0)
  v_mfma_f32_16x16x32_bf16 v[48:51], v[28:31], v[200:203], v[48:51]
  v_mfma_f32_16x16x32_bf16 v[68:71], v[28:31], v[204:207], v[68:71]
  s_waitcnt lgkmcnt(2)
  v_mfma_f32_16x16x32_bf16 v[52:55], v[32:35], v[200:203], v[52:55]
  v_mfma_f32_16x16x32_bf16 v[72:75], v[32:35], v[204:207], v[72:75]
  v_mfma_f32_16x16x32_bf16 v[56:59], v[36:39], v[200:203], v[56:59]
  v_mfma_f32_16x16x32_bf16 v[76:79], v[36:39], v[204:207], v[76:79]
  s_waitcnt lgkmcnt(0)
  v_mfma_f32_16x16x32_bf16 v[60:63], v[40:43], v[200:203], v[60:63]
  v_mfma_f32_16x16x32_bf16 v[80:83], v[40:43], v[204:207], v[80:83]
  v_mfma_f32_16x16x32_bf16 v[64:67], v[44:47], v[200:203], v[64:67]
  v_mfma_f32_16x16x32_bf16 v[84:87], v[44:47], v[204:207], v[84:87]
GG_xw:
  ds_read_b128 v[140:143], v153 offset:16
  s_add_u32 s76, s76, 1
  s_waitcnt lgkmcnt(0)
  v_min_u32 v140, v140, v141
  v_min3_u32 v140, v140, v142, v143
  s_nop 0
  v_readfirstlane_b32 s13, v140
  s_nop 0
  s_cmp_ge_u32 s13, 22
  s_cbranch_scc1 GG_xk
  s_cmp_lt_u32 s76, 8388608
  s_cbranch_scc1 GG_xw
GG_xk:
  ds_write_b128 v12, v[68:71] offset:0
  ds_write_b128 v12, v[72:75] offset:1024
  ds_write_b128 v12, v[76:79] offset:2048
  ds_write_b128 v12, v[80:83] offset:3072
  ds_write_b128 v12, v[84:87] offset:4096
  s_waitcnt lgkmcnt(0)
  s_barrier
  ds_read_b128 v[16:19], v13 offset:0
  ds_read_b128 v[20:23], v13 offset:1024
  ds_read_b128 v[24:27], v13 offset:2048
  ds_read_b128 v[28:31], v13 offset:3072
  ds_read_b128 v[32:35], v13 offset:4096
  s_waitcnt lgkmcnt(4)
  v_pk_add_f32 v[48:49], v[48:49], v[16:17]
  v_pk_add_f32 v[50:51], v[50:51], v[18:19]
  v_cvt_pk_bf16_f32 v176, v48, v49
  v_cvt_pk_bf16_f32 v177, v50, v51
  v_lshlrev_b32 v140, 16, v176
  v_lshlrev_b32 v142, 16, v177
  v_and_b32 v141, s40, v176
  v_and_b32 v143, s40, v177
  v_pk_add_f32 v[140:141], v[140:141], v[96:97]
  v_pk_add_f32 v[142:143], v[142:143], v[98:99]
  v_cvt_pk_bf16_f32 v176, v140, v141
  v_cvt_pk_bf16_f32 v177, v142, v143
  v_lshlrev_b32 v140, 16, v176
  v_lshlrev_b32 v142, 16, v177
  v_and_b32 v141, s40, v176
  v_and_b32 v143, s40, v177
  v_pk_add_f32 v[140:141], v[140:141], v[120:121]
  v_pk_add_f32 v[142:143], v[142:143], v[122:123]
  v_cvt_pk_bf16_f32 v176, v140, v141
  v_cvt_pk_bf16_f32 v177, v142, v143
  s_waitcnt lgkmcnt(3)
  v_pk_add_f32 v[52:53], v[52:53], v[20:21]
  v_pk_add_f32 v[54:55], v[54:55], v[22:23]
  v_cvt_pk_bf16_f32 v178, v52, v53
  v_cvt_pk_bf16_f32 v179, v54, v55
  v_lshlrev_b32 v140, 16, v178
  v_lshlrev_b32 v142, 16, v179
  v_and_b32 v141, s40, v178
  v_and_b32 v143, s40, v179
  v_pk_add_f32 v[140:141], v[140:141], v[100:101]
  v_pk_add_f32 v[142:143], v[142:143], v[102:103]
  v_cvt_pk_bf16_f32 v178, v140, v141
  v_cvt_pk_bf16_f32 v179, v142, v143
  v_lshlrev_b32 v140, 16, v178
  v_lshlrev_b32 v142, 16, v179
  v_and_b32 v141, s40, v178
  v_and_b32 v143, s40, v179
  v_pk_add_f32 v[140:141], v[140:141], v[124:125]
  v_pk_add_f32 v[142:143], v[142:143], v[126:127]
  v_cvt_pk_bf16_f32 v178, v140, v141
  v_cvt_pk_bf16_f32 v179, v142, v143
  buffer_store_dwordx4 v[176:179], v11, s[44:47], s57 offen
  s_waitcnt lgkmcnt(2)
  v_pk_add_f32 v[56:57], v[56:57], v[24:25]
  v_pk_add_f32 v[58:59], v[58:59], v[26:27]
  v_cvt_pk_bf16_f32 v180, v56, v57
  v_cvt_pk_bf16_f32 v181, v58, v59
  v_lshlrev_b32 v140, 16, v180
  v_lshlrev_b32 v142, 16, v181
  v_and_b32 v141, s40, v180
  v_and_b32 v143, s40, v181
  v_pk_add_f32 v[140:141], v[140:141], v[104:105]
  v_pk_add_f32 v[142:143], v[142:143], v[106:107]
  v_cvt_pk_bf16_f32 v180, v140, v141
  v_cvt_pk_bf16_f32 v181, v142, v143
  v_lshlrev_b32 v140, 16, v180
  v_lshlrev_b32 v142, 16, v181
  v_and_b32 v141, s40, v180
  v_and_b32 v143, s40, v181
  v_pk_add_f32 v[140:141], v[140:141], v[128:129]
  v_pk_add_f32 v[142:143], v[142:143], v[130:131]
  v_cvt_pk_bf16_f32 v180, v140, v141
  v_cvt_pk_bf16_f32 v181, v142, v143
  s_waitcnt lgkmcnt(1)
  v_pk_add_f32 v[60:61], v[60:61], v[28:29]
  v_pk_add_f32 v[62:63], v[62:63], v[30:31]
  v_cvt_pk_bf16_f32 v182, v60, v61
  v_cvt_pk_bf16_f32 v183, v62, v63
  v_lshlrev_b32 v140, 16, v182
  v_lshlrev_b32 v142, 16, v183
  v_and_b32 v141, s40, v182
  v_and_b32 v143, s40, v183
  v_pk_add_f32 v[140:141], v[140:141], v[108:109]
  v_pk_add_f32 v[142:143], v[142:143], v[110:111]
  v_cvt_pk_bf16_f32 v182, v140, v141
  v_cvt_pk_bf16_f32 v183, v142, v143
  v_lshlrev_b32 v140, 16, v182
  v_lshlrev_b32 v142, 16, v183
  v_and_b32 v141, s40, v182
  v_and_b32 v143, s40, v183
  v_pk_add_f32 v[140:141], v[140:141], v[132:133]
  v_pk_add_f32 v[142:143], v[142:143], v[134:135]
  v_cvt_pk_bf16_f32 v182, v140, v141
  v_cvt_pk_bf16_f32 v183, v142, v143
  buffer_store_dwordx4 v[180:183], v11, s[44:47], s58 offen
  s_waitcnt lgkmcnt(0)
  v_pk_add_f32 v[64:65], v[64:65], v[32:33]
  v_pk_add_f32 v[66:67], v[66:67], v[34:35]
  v_cvt_pk_bf16_f32 v184, v64, v65
  v_cvt_pk_bf16_f32 v185, v66, v67
  v_lshlrev_b32 v140, 16, v184
  v_lshlrev_b32 v142, 16, v185
  v_and_b32 v141, s40, v184
  v_and_b32 v143, s40, v185
  v_pk_add_f32 v[140:141], v[140:141], v[112:113]
  v_pk_add_f32 v[142:143], v[142:143], v[114:115]
  v_cvt_pk_bf16_f32 v184, v140, v141
  v_cvt_pk_bf16_f32 v185, v142, v143
  v_lshlrev_b32 v140, 16, v184
  v_lshlrev_b32 v142, 16, v185
  v_and_b32 v141, s40, v184
  v_and_b32 v143, s40, v185
  v_pk_add_f32 v[140:141], v[140:141], v[136:137]
  v_pk_add_f32 v[142:143], v[142:143], v[138:139]
  v_cvt_pk_bf16_f32 v184, v140, v141
  v_cvt_pk_bf16_f32 v185, v142, v143
  buffer_store_dwordx2 v[184:185], v11, s[44:47], s59 offen
  s_endpgm
.p2align 6
F_tab:
  .short 40, 40, 40, 40, 1774, 1774, 1774, 1774, 1774, 1774, 1774, 1718, 1718, 1718, 1718, 1718
  .short 1718, 1718, 1718, 1718, 1662, 1662, 1662, 1662, 1662, 1662, 1662, 1606, 1606, 1606, 1606, 1606
  .short 1606, 1606, 1606, 1606, 1550, 1550, 1550, 1550, 1550, 1550, 1550, 1494, 1494, 1494, 1494, 1494
  .short 1494, 1494, 1494, 1494, 1438, 1438, 1438, 1438, 1438, 1438, 1438, 1382, 1382, 1382, 1382, 1382
  .short 1382, 1382, 1382, 1382, 1326, 1326, 1326, 1326, 1326, 1326, 1326, 1270, 1270, 1270, 1270, 1270
  .short 1270, 1270, 1270, 1270, 1214, 1214, 1214, 1214, 1214, 1214, 1214, 1158, 1158, 1158, 1158, 1158
  .short 1158, 1158, 1158, 1158, 1102, 1102, 1102, 1102, 1102, 1102, 1102, 1046, 1046, 1046, 1046, 1046
  .short 1046, 1046, 1046, 1046, 990, 990, 990, 990, 990, 990, 990, 934, 934, 934, 934, 934
  .short 934, 934, 934, 934, 878, 878, 878, 878, 878, 878, 878, 822, 822, 822, 822, 822
  .short 822, 822, 822, 822, 766, 766, 766, 766, 766, 766, 766, 710, 710, 710, 710, 710
  .short 710, 710, 710, 710, 654, 654, 654, 654, 654, 654, 654, 598, 598, 598, 598, 598
  .short 598, 598, 598, 598, 542, 542, 542, 542, 542, 542, 542, 486, 486, 486, 486, 486
  .short 486, 486, 486, 486, 430, 430, 430, 430, 430, 430, 430, 374, 374, 374, 374, 374
  .short 374, 374, 374, 374, 318, 318, 318, 318, 318, 318, 318, 262, 262, 262, 262, 262
  .short 262, 262, 262, 262, 206, 206, 206, 206, 206, 206, 206, 150, 150, 150, 150, 150
  .short 150, 150, 150, 150, 94, 94, 94, 94, 94, 94, 94, 38, 38, 38, 38, 38
  .short 38, 38, 38, 38, 1772, 1772, 1772, 1772, 1772, 1772, 1772, 1716, 1716, 1716, 1716, 1716
  .short 1716, 1716, 1716, 1716, 1660, 1660, 1660, 1660, 1660, 1660, 1660, 1604, 1604, 1604, 1604, 1604
  .short 1604, 1604, 1604, 1604, 1548, 1548, 1548, 1548, 1548, 1548, 1548, 1492, 1492, 1492, 1492, 1492
  .short 1492, 1492, 1492, 1492, 1436, 1436, 1436, 1436, 1436, 1436, 1436, 1380, 1380, 1380, 1380, 1380
  .short 1380, 1380, 1380, 1380, 1324, 1324, 1324, 1324, 1324, 1324, 1324, 1268, 1268, 1268, 1268, 1268
  .short 1268, 1268, 1268, 1268, 1212, 1212, 1212, 1212, 1212, 1212, 1212, 1156, 1156, 1156, 1156, 1156
  .short 1156, 1156, 1156, 1156, 1100, 1100, 1100, 1100, 1100, 1100, 1100, 1044, 1044, 1044, 1044, 1044
  .short 1044, 1044, 1044, 1044, 988, 988, 988, 988, 988, 988, 988, 932, 932, 932, 932, 932
  .short 932, 932, 932, 932, 876, 876, 876, 876, 876, 876, 876, 820, 820, 820, 820, 820
  .short 820, 820, 820, 820, 764, 764, 764, 764, 764, 764, 764, 708, 708, 708, 708, 708
  .short 708, 708, 708, 708, 652, 652, 652, 652, 652, 652, 652, 596, 596, 596, 596, 596
  .short 596, 596, 596, 596, 540, 540, 540, 540, 540, 540, 540, 484, 484, 484, 484, 484
  .short 484, 484, 484, 484, 428, 428, 428, 428, 428, 428, 428, 372, 372, 372, 372, 372
  .short 372, 372, 372, 372, 316, 316, 316, 316, 316, 316, 316, 260, 260, 260, 260, 260
  .short 260, 260, 260, 260, 204, 204, 204, 204, 204, 204, 204, 148, 148, 148, 148, 148
  .short 148, 148, 148, 148, 92, 92, 92, 92, 92, 92, 92, 36, 36, 36, 36, 36
  .short 36, 36, 36, 36, 1770, 1770, 1770, 1770, 1770, 1770, 1770, 1714, 1714, 1714, 1714, 1714
  .short 1714, 1714, 1714, 1714, 1658, 1658, 1658, 1658, 1658, 1658, 1658, 1602, 1602, 1602, 1602, 1602
  .short 1602, 1602, 1602, 1602, 1546, 1546, 1546, 1546, 1546, 1546, 1546, 1490, 1490, 1490, 1490, 1490
  .short 1490, 1490, 1490, 1490, 1434, 1434, 1434, 1434, 1434, 1434, 1434, 1378, 1378, 1378, 1378, 1378
  .short 1378, 1378, 1378, 1378, 1322, 1322, 1322, 1322, 1322, 1322, 1322, 1266, 1266, 1266, 1266, 1266
  .short 1266, 1266, 1266, 1266, 1210, 1210, 1210, 1210, 1210, 1210, 1210, 1154, 1154, 1154, 1154, 1154
  .short 1154, 1154, 1154, 1154, 1098, 1098, 1098, 1098, 1098, 1098, 1098, 1042, 1042, 1042, 1042, 1042
  .short 1042, 1042, 1042, 1042, 986, 986, 986, 986, 986, 986, 986, 930, 930, 930, 930, 930
  .short 930, 930, 930, 930, 874, 874, 874, 874, 874, 874, 874, 818, 818, 818, 818, 818
  .short 818, 818, 818, 818, 762, 762, 762, 762, 762, 762, 762, 706, 706, 706, 706, 706
  .short 706, 706, 706, 706, 650, 650, 650, 650, 650, 650, 650, 594, 594, 594, 594, 594
  .short 594, 594, 594, 594, 538, 538, 538, 538, 538, 538, 538, 482, 482, 482, 482, 482
  .short 482, 482, 482, 482, 426, 426, 426, 426, 426, 426, 426, 370, 370, 370, 370, 370
  .short 370, 370, 370, 370, 314, 314, 314, 314, 314, 314, 314, 258, 258, 258, 258, 258
  .short 258, 258, 258, 258, 202, 202, 202, 202, 202, 202, 202, 146, 146, 146, 146, 146
  .short 146, 146, 146, 146, 90, 90, 90, 90, 90, 90, 90, 34, 34, 34, 34, 34
  .short 34, 34, 34, 34, 1768, 1768, 1768, 1768, 1768, 1768, 1768, 1712, 1712, 1712, 1712, 1712
  .short 1712, 1712, 1712, 1712, 1656, 1656, 1656, 1656, 1656, 1656, 1656, 1600, 1600, 1600, 1600, 1600
  .short 1600, 1600, 1600, 1600, 1544, 1544, 1544, 1544, 1544, 1544, 1544, 1488, 1488, 1488, 1488, 1488
  .short 1488, 1488, 1488, 1488, 1432, 1432, 1432, 1432, 1432, 1432, 1432, 1376, 1376, 1376, 1376, 1376
  .short 1376, 1376, 1376, 1376, 1320, 1320, 1320, 1320, 1320, 1320, 1320, 1264, 1264, 1264, 1264, 1264
  .short 1264, 1264, 1264, 1264, 1208, 1208, 1208, 1208, 1208, 1208, 1208, 1152, 1152, 1152, 1152, 1152
  .short 1152, 1152, 1152, 1152, 1096, 1096, 1096, 1096, 1096, 1096, 1096, 1040, 1040, 1040, 1040, 1040
  .short 1040, 1040, 1040, 1040, 984, 984, 984, 984, 984, 984, 984, 928, 928, 928, 928, 928
  .short 928, 928, 928, 928, 872, 872, 872, 872, 872, 872, 872, 816, 816, 816, 816, 816
  .short 816, 816, 816, 816, 760, 760, 760, 760, 760, 760, 760, 704, 704, 704, 704, 704
  .short 704, 704, 704, 704, 648, 648, 648, 648, 648, 648, 648, 592, 592, 592, 592, 592
  .short 592, 592, 592, 592, 536, 536, 536, 536, 536, 536, 536, 480, 480, 480, 480, 480
  .short 480, 480, 480, 480, 424, 424, 424, 424, 424, 424, 424, 368, 368, 368, 368, 368
  .short 368, 368, 368, 368, 312, 312, 312, 312, 312, 312, 312, 256, 256, 256, 256, 256
  .short 256, 256, 256, 256, 200, 200, 200, 200, 200, 200, 200, 144, 144, 144, 144, 144
  .short 144, 144, 144, 144, 88, 88, 88, 88, 88, 88, 88, 32, 32, 32, 32, 32
  .short 32, 32, 1766, 1766, 1766, 1764, 1764, 1764, 1764, 1764, 1710, 1710, 1710, 1708, 1708, 1708
  .short 1708, 1708, 1654, 1654, 1654, 1652, 1652, 1652, 1652, 1652, 1598, 1598, 1598, 1596, 1596, 1596
  .short 1596, 1596, 1542, 1542, 1542, 1540, 1540, 1540, 1540, 1540, 1486, 1486, 1486, 1484, 1484, 1484
  .short 1484, 1484, 1430, 1430, 1430, 1428, 1428, 1428, 1428, 1428, 1374, 1374, 1374, 1372, 1372, 1372
  .short 1372, 1372, 1318, 1318, 1318, 1316, 1316, 1316, 1316, 1316, 1262, 1262, 1262, 1260, 1260, 1260
  .short 1260, 1260, 1206, 1206, 1206, 1204, 1204, 1204, 1204, 1204, 1150, 1150, 1150, 1148, 1148, 1148
  .short 1148, 1148, 1094, 1094, 1094, 1092, 1092, 1092, 1092, 1092, 1038, 1038, 1038, 1036, 1036, 1036
  .short 1036, 1036, 982, 982, 982, 980, 980, 980, 980, 980, 926, 926, 926, 924, 924, 924
  .short 924, 924, 870, 870, 870, 868, 868, 868, 868, 868, 814, 814, 814, 812, 812, 812
  .short 812, 812, 758, 758, 758, 756, 756, 756, 756, 756, 702, 702, 702, 700, 700, 700
  .short 700, 700, 646, 646, 646, 644, 644, 644, 644, 644, 590, 590, 590, 588, 588, 588
  .short 588, 588, 534, 534, 534, 532, 532, 532, 532, 532, 478, 478, 478, 476, 476, 476
  .short 476, 476, 422, 422, 422, 420, 420, 420, 420, 420, 366, 366, 366, 364, 364, 364
  .short 364, 364, 310, 310, 310, 308, 308, 308, 308, 308, 254, 254, 254, 252, 252, 252
  .short 252, 252, 198, 198, 198, 196, 196, 196, 196, 196, 142, 142, 142, 140, 140, 140
  .short 140, 140, 86, 86, 86, 84, 84, 84, 84, 84, 30, 30, 30, 28, 28, 28
  .short 28, 28, 1762, 1762, 1762, 1760, 1760, 1760, 1760, 1760, 1706, 1706, 1706, 1704, 1704, 1704
  .short 1704, 1704, 1650, 1650, 1650, 1648, 1648, 1648, 1648, 1648, 1594, 1594, 1594, 1592, 1592, 1592
  .short 1592, 1592, 1538, 1538, 1538, 1536, 1536, 1536, 1536, 1536, 1482, 1482, 1482, 1480, 1480, 1480
  .short 1480, 1480, 1426, 1426, 1426, 1424, 1424, 1424, 1424, 1424, 1370, 1370, 1370, 1368, 1368, 1368
  .short 1368, 1368, 1314, 1314, 1314, 1312, 1312, 1312, 1312, 1312, 1258, 1258, 1258, 1256, 1256, 1256
  .short 1256, 1256, 1202, 1202, 1202, 1200, 1200, 1200, 1200, 1200, 1146, 1146, 1146, 1144, 1144, 1144
  .short 1144, 1144, 1090, 1090, 1090, 1088, 1088, 1088, 1088, 1088, 1034, 1034, 1034, 1032, 1032, 1032
  .short 1032, 1032, 978, 978, 978, 976, 976, 976, 976, 976, 922, 922, 922, 920, 920, 920
  .short 920, 920, 866, 866, 866, 864, 864, 864, 864, 864, 810, 810, 810, 808, 808, 808
  .short 808, 808, 754, 754, 754, 752, 752, 752, 752, 752, 698, 698, 698, 696, 696, 696
  .short 696, 696, 642, 642, 642, 640, 640, 640, 640, 640, 586, 586, 586, 584, 584, 584
  .short 584, 584, 530, 530, 530, 528, 528, 528, 528, 528, 474, 474, 474, 472, 472, 472
  .short 472, 472, 418, 418, 418, 416, 416, 416, 416, 416, 362, 362, 362, 360, 360, 360
  .short 360, 360, 306, 306, 306, 304, 304, 304, 304, 304, 250, 250, 250, 248, 248, 248
  .short 248, 248, 194, 194, 194, 192, 192, 192, 192, 192, 138, 138, 138, 136, 136, 136
  .short 136, 136, 82, 82, 82, 80, 80, 80, 80, 80, 26, 26, 26, 24, 24, 24
  .short 24, 1758, 1756, 1756, 1756, 1754, 1752, 1752, 1752, 1702, 1700, 1700, 1700, 1698, 1696, 1696
  .short 1696, 1646, 1644, 1644, 1644, 1642, 1640, 1640, 1640, 1590, 1588, 1588, 1588, 1586, 1584, 1584
  .short 1584, 1534, 1532, 1532, 1532, 1530, 1528, 1528, 1528, 1478, 1476, 1476, 1476, 1474, 1472, 1472
  .short 1472, 1422, 1420, 1420, 1420, 1418, 1416, 1416, 1416, 1366, 1364, 1364, 1364, 1362, 1360, 1360
  .short 1360, 1310, 1308, 1308, 1308, 1306, 1304, 1304, 1304, 1254, 1252, 1252, 1252, 1250, 1248, 1248
  .short 1248, 1198, 1196, 1196, 1196, 1194, 1192, 1192, 1192, 1142, 1140, 1140, 1140, 1138, 1136, 1136
  .short 1136, 1086, 1084, 1084, 1084, 1082, 1080, 1080, 1080, 1030, 1028, 1028, 1028, 1026, 1024, 1024
  .short 1024, 974, 972, 972, 972, 970, 968, 968, 968, 918, 916, 916, 916, 914, 912, 912
  .short 912, 862, 860, 860, 860, 858, 856, 856, 856, 806, 804, 804, 804, 802, 800, 800
  .short 800, 750, 748, 748, 748, 746, 744, 744, 744, 694, 692, 692, 692, 690, 688, 688
  .short 688, 638, 636, 636, 636, 634, 632, 632, 632, 582, 580, 580, 580, 578, 576, 576
  .short 576, 526, 524, 524, 524, 522, 520, 520, 520, 470, 468, 468, 468, 466, 464, 464
  .short 464, 414, 412, 412, 412, 410, 408, 408, 408, 358, 356, 356, 356, 354, 352, 352
  .short 352, 302, 300, 300, 300, 298, 296, 296, 296, 246, 244, 244, 244, 242, 240, 240
  .short 240, 190, 188, 188, 188, 186, 184, 184, 184, 134, 132, 132, 132, 130, 128, 128
  .short 128, 78, 76, 76, 76, 74, 72, 72, 72, 22, 20, 20, 20, 18, 16, 16
  .short 1750, 1748, 1746, 1744, 1742, 1740, 1738, 1736, 1694, 1692, 1690, 1688, 1686, 1684, 1682, 1680
  .short 1638, 1636, 1634, 1632, 1630, 1628, 1626, 1624, 1582, 1580, 1578, 1576, 1574, 1572, 1570, 1568
  .short 1526, 1524, 1522, 1520, 1518, 1516, 1514, 1512, 1470, 1468, 1466, 1464, 1462, 1460, 1458, 1456
  .short 1414, 1412, 1410, 1408, 1406, 1404, 1402, 1400, 1358, 1356, 1354, 1352, 1350, 1348, 1346, 1344
  .short 1302, 1300, 1298, 1296, 1294, 1292, 1290, 1288, 1246, 1244, 1242, 1240, 1238, 1236, 1234, 1232
  .short 1190, 1188, 1186, 1184, 1182, 1180, 1178, 1176, 1134, 1132, 1130, 1128, 1126, 1124, 1122, 1120
  .short 1078, 1076, 1074, 1072, 1070, 1068, 1066, 1064, 1022, 1020, 1018, 1016, 1014, 1012, 1010, 1008
  .short 966, 964, 962, 960, 958, 956, 954, 952, 910, 908, 906, 904, 902, 900, 898, 896
  .short 854, 852, 850, 848, 846, 844, 842, 840, 798, 796, 794, 792, 790, 788, 786, 784
  .short 742, 740, 738, 736, 734, 732, 730, 728, 686, 684, 682, 680, 678, 676, 674, 672
  .short 630, 628, 626, 624, 622, 620, 618, 616, 574, 572, 570, 568, 566, 564, 562, 560
  .short 518, 516, 514, 512, 510, 508, 506, 504, 462, 460, 458, 456, 454, 452, 450, 448
  .short 406, 404, 402, 400, 398, 396, 394, 392, 350, 348, 346, 344, 342, 340, 338, 336
  .short 294, 292, 290, 288, 286, 284, 282, 280, 238, 236, 234, 232, 230, 228, 226, 224
  .short 182, 180, 178, 176, 174, 172, 170, 168, 126, 124, 122, 120, 118, 116, 114, 112
  .short 70, 68, 66, 64, 62, 60, 58, 56, 14, 12, 10, 8, 6, 4, 2, 0
  .short 1792, 1792, 1792, 1792, 1792, 1792, 1792, 1792, 1792, 1792, 1792, 1792, 1792, 1792, 1792, 1792
.section .rodata,"a"
.p2align 6
.amdhsa_kernel sequential_preLN__ssm_conv_s4__mixer_s_mlp__prompt_kernel
  .amdhsa_next_free_vgpr 256
  .amdhsa_next_free_sgpr 80
  .amdhsa_accum_offset 256
  .amdhsa_group_segment_fixed_size 0
  .amdhsa_kernarg_size 136
  .amdhsa_user_sgpr_count 2
  .amdhsa_user_sgpr_kernarg_segment_ptr 1
  .amdhsa_system_sgpr_workgroup_id_x 1
.end_amdhsa_kernel
```
